```python
import torch

def _softmax(x, axis=-1):
    return torch.softmax(x, dim=axis)
def _gelu(x):
    return torch.nn.functional.gelu(x, approximate="tanh")
def _silu(x):
    return torch.nn.functional.silu(x)
def _sigmoid(x):
    return torch.sigmoid(x)
def _layernorm(x, axis=-1, eps=1e-5):
    m = x.mean(dim=axis, keepdim=True)
    v = x.var(dim=axis, keepdim=True, unbiased=False)
    return (x - m) / torch.sqrt(v + eps)
def _scatter_add(tgt, idx, src, axis=0):
    return tgt.clone().index_add_(axis, idx, src)
def _segment_sum(src, seg, n):
    out = torch.zeros((n,) + src.shape[1:], dtype=src.dtype)
    return out.index_add_(0, seg, src)
def _pad(x, pw):
    flat = tuple(v for pair in reversed(pw) for v in pair)
    return torch.nn.functional.pad(x, flat)

kernel_name = 'recurrent_scan__mha_block_cached__mixer_channel_mlp__prompt'

def setup_inputs():

    _w = (lambda a: (lambda t: t.to(torch.bfloat16) if t.is_floating_point() else t)(torch.as_tensor(a)))
    def _A_setup():
        B, Sq, D = 1, 2048, 512
        H, Sk, Dh = 32, 2048, 128
        return {
            "x": _w((lambda *s: torch.randn(*s, dtype=torch.bfloat16) * 0.05)(B, Sq, D)),
            "k_cache": _w((lambda *s: torch.randn(*s, dtype=torch.bfloat16) * 1.6)(B, H, Sk, Dh)),
            "v_cache": _w((lambda *s: torch.randn(*s, dtype=torch.bfloat16) * 0.8)(B, H, Sk, Dh)),
            "wq": _w((lambda *s: torch.randn(*s, dtype=torch.bfloat16) * 1.6)(D, H * Dh) * (D ** -0.5)),
            "wo": _w((lambda *s: torch.randn(*s, dtype=torch.bfloat16) * 0.8)(H * Dh, D) * ((H * Dh) ** -0.5)),
        }
    _A_in = _A_setup()

    def _B_setup():
        B, S, D, F = 1, 2048, 512, 1376
        return {
            "x": _w((lambda *s: torch.randn(*s, dtype=torch.bfloat16) * 0.05)(B, S, D)),
            "w1": _w((lambda *s: torch.randn(*s, dtype=torch.bfloat16) * 1.6)(D, F) * (D ** -0.5)),
            "b1": _w((lambda *s: torch.randn(*s, dtype=torch.bfloat16) * 0.8)(F)),
            "w2": _w((lambda *s: torch.randn(*s, dtype=torch.bfloat16) * 0.2)(F, D) * (F ** -0.5)),
            "b2": _w((lambda *s: torch.randn(*s, dtype=torch.bfloat16) * 0.2)(D)),
        }
    _B_in = _B_setup()

    return {
        "A_x": _A_in["x"],
        "A_k_cache": _A_in["k_cache"],
        "A_v_cache": _A_in["v_cache"],
        "A_wq": _A_in["wq"],
        "A_wo": _A_in["wo"],
        "B_x": _B_in["x"],
        "B_w1": _B_in["w1"],
        "B_b1": _B_in["b1"],
        "B_w2": _B_in["w2"],
        "B_b2": _B_in["b2"],
    }

def reference(A_x, A_k_cache, A_v_cache, A_wq, A_wo, B_x, B_w1, B_b1, B_w2, B_b2):
    def _A_ref(x, k_cache, v_cache, wq, wo):
        B, Sq, D = x.shape
        H, Dh = 32, 128
        q = (lambda x, *d: x.permute(*d))((x @ wq).reshape(B, Sq, H, Dh), 0, 2, 1, 3)
        scores = torch.einsum("bhqd,bhkd->bhqk", q, k_cache) * (Dh ** -0.5)
        p = _softmax(scores, axis=-1)
        o = torch.einsum("bhqk,bhkd->bhqd", p, v_cache)
        return (lambda x, *d: x.permute(*d))(o, 0, 2, 1, 3).reshape(B, Sq, H * Dh) @ wo

    def _B_ref(x, w1, b1, w2, b2):
        y = _layernorm(x, axis=-1)
        h = _gelu(torch.einsum("bsd,df->bsf", y, w1) + b1)
        return torch.einsum("bsf,fd->bsd", h, w2) + b2

    x = A_x
    xn = _layernorm(x, axis=-1)
    s = _A_ref(xn, A_k_cache, A_v_cache, A_wq, A_wo)
    g = _silu(_B_ref(xn, B_w1, B_b1, B_w2, B_b2))
    return x + s * g
```

```asm
; @launch grid=(256,1,1) block=(256,1,1) lds=163840
.amdgcn_target "amdgcn-amd-amdhsa--gfx950"
.text
.globl recurrent_scan__mha_block_cached__mixer_channel_mlp__prompt_kernel
.p2align 8
.type recurrent_scan__mha_block_cached__mixer_channel_mlp__prompt_kernel,@function
recurrent_scan__mha_block_cached__mixer_channel_mlp__prompt_kernel:
    s_cmp_ge_u32 s2, 256
    s_cbranch_scc1 attn_done
    s_load_dwordx2 s[50:51], s[0:1], 0
    s_load_dwordx2 s[48:49], s[0:1], 24
    s_load_dwordx4 s[52:55], s[0:1], 88
    s_load_dwordx4 s[56:59], s[0:1], 48
    s_load_dwordx4 s[44:47], s[0:1], 8
    v_lshrrev_b32 v1, 6, v0
    v_and_b32 v2, 63, v0
    v_and_b32 v3, 15, v2
    v_lshrrev_b32 v4, 4, v2
    v_lshrrev_b32 v7, 2, v3
    v_and_b32 v8, 3, v2
    v_and_b32 v9, 1, v4
    v_lshl_add_u32 v9, v9, 2, v7
    v_readfirstlane_b32 s28, v1
    v_lshlrev_b32 v11, 7, v2
    s_getpc_b64 s[96:97]
pc_self:
    s_sub_u32 s96, s96, pc_self-recurrent_scan__mha_block_cached__mixer_channel_mlp__prompt_kernel
    s_subb_u32 s97, s97, 0
    s_mul_i32 s98, s28, 8192
    v_add_u32 v124, s98, v11
    v_min_u32 v124, attn_proj-recurrent_scan__mha_block_cached__mixer_channel_mlp__prompt_kernel, v124
    v_mov_b32 v125, s97
    v_add_co_u32 v124, vcc, s96, v124
    s_nop 1
    v_addc_co_u32 v125, vcc, 0, v125, vcc
    global_load_dword v127, v[124:125], off
    s_and_b32 s37, s2, 7
    s_lshl_b32 s37, s37, 2
    s_lshr_b32 s38, s2, 3
    s_and_b32 s29, s38, 3
    s_add_u32 s29, s29, s37
    s_lshr_b32 s30, s2, 5
    v_lshlrev_b32 v5, 1, v4
    v_xor_b32 v5, v5, v3
    v_xor_b32 v6, 8, v5
    v_lshlrev_b32 v5, 4, v5
    v_lshlrev_b32 v6, 4, v6
    v_lshl_add_u32 v248, v4, 13, v5
    v_lshl_add_u32 v249, v4, 13, v5
    v_add_u32 v249, 31744, v249
    v_lshl_add_u32 v250, v4, 13, v6
    v_add_u32 v250, 63488, v250
    v_lshl_add_u32 v251, v4, 13, v6
    v_add_u32 v251, 95232, v251
    v_lshlrev_b32 v54, 4, v2
    v_mov_b32 v255, 0
    s_and_b32 s80, s29, 1
    s_lshl_b32 s80, s80, 1
    s_xor_b32 s81, s80, 2
    s_lshr_b32 s82, s29, 1
    s_add_u32 s82, s82, 32
    s_cmp_lt_u32 s82, 43
    s_cselect_b32 s82, s82, s29
    v_lshrrev_b32 v10, 3, v2
    v_and_b32 v11, 2, v10
    v_and_b32 v12, 7, v2
    v_xor_b32 v12, v12, v11
    v_and_b32 v11, 3, v12
    v_lshlrev_b32 v11, 4, v11
    v_mul_u32_u24 v10, 2752, v10
    v_add_u32 v15, v10, v11
    s_lshl_b32 s37, s29, 6
    s_lshl_b32 s38, s82, 6
    v_add_u32 v13, s37, v15
    v_add_u32 v14, s38, v15
    v_cmp_lt_u32 vcc, 3, v12
    s_lshl_b32 s33, s28, 12
    s_add_u32 s34, s33, 65536
    v_cndmask_b32 v252, v13, v14, vcc
    v_cndmask_b32 v253, v14, v13, vcc
    v_add_u32 v253, 20992, v253
    s_lshl_b32 s86, s28, 11
    s_add_u32 s86, s86, 131072
    s_lshl_b32 s83, s28, 17
    s_mul_i32 s85, s28, 44032
    s_lshl_b32 s37, s30, 18
    s_lshl_b32 s38, s28, 16
    s_add_u32 s38, s37, s38
    s_mov_b32 s60, s38
    s_lshl_b32 s61, s28, 13
    s_add_u32 s61, s61, 16384
    v_lshrrev_b32 v10, 3, v2
    v_and_b32 v11, 7, v2
    v_xor_b32 v11, v11, v4
    v_lshlrev_b32 v10, 10, v10
    v_lshl_add_u32 v12, v11, 4, v10
    v_xor_b32 v11, 4, v11
    v_lshl_add_u32 v13, v11, 4, v10
    v_add_u32 v13, 7168, v13
    s_lshl_b32 s87, s30, 5
    s_add_u32 s87, s87, s29
    s_lshl_b32 s64, s87, 2
    s_add_u32 s64, s64, s28
    s_lshl_b32 s65, s64, 11
    s_lshl_b32 s37, s29, 8
    s_waitcnt lgkmcnt(0)
    s_add_u32 s20, s50, 0
    s_addc_u32 s21, s51, 0
    s_mov_b32 s22, 2097152
    s_mov_b32 s23, 0x20000
    buffer_load_dwordx4 v[64:67], v54, s[20:23], s65 offen offset:0
    buffer_load_dwordx4 v[68:71], v54, s[20:23], s65 offen offset:1024
    s_add_u32 s16, s48, s37
    s_addc_u32 s17, s49, 0
    s_mov_b32 s18, 4186368
    s_mov_b32 s19, 0x20000
    s_add_u32 s72, s56, 0
    s_addc_u32 s73, s57, 0
    s_mov_b32 s74, 1409024
    s_mov_b32 s75, 0x20000
    s_add_u32 m0, s33, 81920
    s_add_u32 s84, s83, 0
    buffer_load_dwordx4 v248, s[16:19], s84 offen offset:0 lds
    s_mov_b32 s76, s44
    s_mov_b32 s77, s45
    s_mov_b32 s78, s46
    s_mov_b32 s79, s47
    s_add_u32 s44, s54, 2097152
    s_addc_u32 s45, s55, 0
    buffer_load_dwordx4 v249, s[16:19], s84 offen offset:1024 lds
    s_mov_b32 s46, 32768
    s_mov_b32 s47, 0x20000
    s_lshl_b32 s64, s64, 5
    v_lshl_add_u32 v113, v4, 3, v7
    v_lshlrev_b32 v114, 7, v113
    buffer_load_dwordx4 v250, s[16:19], s84 offen offset:2048 lds
    v_lshlrev_b32 v113, 8, v113
    v_add_u32 v113, 81920, v113
    v_lshlrev_b32 v112, 1, v9
    v_add_u32 v10, 0, v8
    v_xor_b32 v10, v10, v112
    buffer_load_dwordx4 v251, s[16:19], s84 offen offset:3072 lds
    v_lshl_add_u32 v240, v10, 4, v113
    v_add_u32 v10, 4, v8
    v_xor_b32 v10, v10, v112
    v_lshl_add_u32 v241, v10, 4, v113
    v_add_u32 v10, 8, v8
    s_add_u32 m0, s86, 0
    s_add_u32 s84, s85, 0
    buffer_load_dwordx4 v252, s[72:75], s84 offen offset:0 lds
    v_xor_b32 v10, v10, v112
    v_lshl_add_u32 v242, v10, 4, v113
    v_add_u32 v10, 12, v8
    v_xor_b32 v10, v10, v112
    v_lshl_add_u32 v243, v10, 4, v113
    buffer_load_dwordx4 v253, s[72:75], s84 offen offset:1024 lds
    s_lshl_b32 s37, s28, 2
    v_add_u32 v10, s37, v8
    v_xor_b32 v10, v10, v112
    v_lshl_add_u32 v121, v10, 4, v113
    v_add_u32 v114, 131072, v114
    s_add_u32 m0, s61, 0
    s_add_u32 s62, s60, 0
    buffer_load_dwordx4 v12, s[20:23], s62 offen offset:0 lds
    v_and_b32 v11, 1, v8
    v_lshl_add_u32 v114, v11, 3, v114
    v_lshrrev_b32 v11, 1, v8
    v_and_b32 v112, 6, v9
    v_add_u32 v10, 0, v11
    buffer_load_dwordx4 v13, s[20:23], s62 offen offset:1024 lds
    v_xor_b32 v10, v10, v112
    v_lshl_add_u32 v244, v10, 4, v114
    v_add_u32 v10, 2, v11
    v_xor_b32 v10, v10, v112
    v_lshl_add_u32 v245, v10, 4, v114
    s_add_u32 m0, s61, 2048
    s_add_u32 s62, s60, 16384
    buffer_load_dwordx4 v12, s[20:23], s62 offen offset:0 lds
    v_add_u32 v10, 4, v11
    v_xor_b32 v10, v10, v112
    v_lshl_add_u32 v246, v10, 4, v114
    v_add_u32 v10, 6, v11
    v_xor_b32 v10, v10, v112
    buffer_load_dwordx4 v13, s[20:23], s62 offen offset:1024 lds
    v_lshl_add_u32 v247, v10, 4, v114
    s_lshl_b32 s37, s28, 1
    v_add_u32 v10, s37, v11
    v_xor_b32 v10, v10, v112
    v_lshl_add_u32 v254, v10, 4, v114
    s_add_u32 m0, s61, 4096
    s_add_u32 s62, s60, 32768
    buffer_load_dwordx4 v12, s[20:23], s62 offen offset:0 lds
    v_mov_b32 v46, 0x3f803f80
    v_mov_b32 v47, 0x3f803f80
    v_mov_b32 v48, 0x3f803f80
    v_mov_b32 v49, 0x3f803f80
    v_mov_b32 v56, v7
    buffer_load_dwordx4 v13, s[20:23], s62 offen offset:1024 lds
    v_mov_b32 v57, v8
    v_mov_b32 v58, v9
    v_mov_b32 v8, v121
    v_lshrrev_b32 v10, 1, v3
    v_xor_b32 v10, v10, v4
    s_add_u32 m0, s61, 6144
    s_add_u32 s62, s60, 49152
    buffer_load_dwordx4 v12, s[20:23], s62 offen offset:0 lds
    v_lshlrev_b32 v10, 4, v10
    v_lshl_add_u32 v10, v3, 7, v10
    v_add_u32 v10, s61, v10
    s_lshl_b32 s37, s80, 11
    s_lshl_b32 s38, s81, 11
    buffer_load_dwordx4 v13, s[20:23], s62 offen offset:1024 lds
    v_add_u32 v9, s37, v10
    v_add_u32 v10, s38, v10
    v_xor_b32 v11, 64, v9
    v_xor_b32 v7, 64, v10
    s_add_u32 s92, s52, 0
    s_addc_u32 s93, s53, 0
    s_mov_b32 s94, 256
    s_mov_b32 s95, 0x20000
    s_or_b32 s37, s2, s28
    s_cbranch_scc1 attn_notag
    s_memrealtime s[66:67]
    s_memtime s[100:101]
    s_waitcnt lgkmcnt(0)
    s_or_b32 s66, s66, 1
    v_mov_b32 v122, s66
    v_mov_b32 v123, s100
    s_mov_b64 exec, 1
    buffer_store_dwordx2 v[122:123], v255, s[92:95], 0 offen sc1
    s_mov_b64 exec, -1
attn_notag:
    s_waitcnt vmcnt(14)
    s_add_u32 m0, s33, 98304
    s_add_u32 s84, s83, 524288
    buffer_load_dwordx4 v248, s[16:19], s84 offen offset:0 lds
    v_lshlrev_b32 v80, 16, v64
    v_and_b32 v81, 0xffff0000, v64
    v_lshlrev_b32 v82, 16, v65
    v_and_b32 v83, 0xffff0000, v65
    v_lshlrev_b32 v84, 16, v66
    v_and_b32 v85, 0xffff0000, v66
    v_lshlrev_b32 v86, 16, v67
    v_and_b32 v87, 0xffff0000, v67
    v_lshlrev_b32 v88, 16, v68
    v_and_b32 v89, 0xffff0000, v68
    v_lshlrev_b32 v90, 16, v69
    v_and_b32 v91, 0xffff0000, v69
    buffer_load_dwordx4 v249, s[16:19], s84 offen offset:1024 lds
    v_lshlrev_b32 v92, 16, v70
    v_and_b32 v93, 0xffff0000, v70
    v_lshlrev_b32 v94, 16, v71
    v_and_b32 v95, 0xffff0000, v71
    v_readfirstlane_b32 s66, v80
    v_readfirstlane_b32 s100, v88
    s_mov_b32 s67, s66
    s_mov_b32 s101, s100
    v_pk_add_f32 v[96:97], v[80:81], s[66:67] neg_lo:[0,1] neg_hi:[0,1]
    v_pk_add_f32 v[98:99], v[82:83], s[66:67] neg_lo:[0,1] neg_hi:[0,1]
    v_pk_add_f32 v[100:101], v[84:85], s[66:67] neg_lo:[0,1] neg_hi:[0,1]
    v_pk_add_f32 v[102:103], v[86:87], s[66:67] neg_lo:[0,1] neg_hi:[0,1]
    buffer_load_dwordx4 v250, s[16:19], s84 offen offset:2048 lds
    v_pk_add_f32 v[104:105], v[88:89], s[100:101] neg_lo:[0,1] neg_hi:[0,1]
    v_pk_add_f32 v[106:107], v[90:91], s[100:101] neg_lo:[0,1] neg_hi:[0,1]
    v_pk_add_f32 v[108:109], v[92:93], s[100:101] neg_lo:[0,1] neg_hi:[0,1]
    v_pk_add_f32 v[110:111], v[94:95], s[100:101] neg_lo:[0,1] neg_hi:[0,1]
    v_pk_add_f32 v[112:113], v[96:97], v[98:99]
    v_pk_mul_f32 v[114:115], v[96:97], v[96:97]
    v_pk_add_f32 v[116:117], v[104:105], v[106:107]
    v_pk_mul_f32 v[118:119], v[104:105], v[104:105]
    v_pk_fma_f32 v[114:115], v[98:99], v[98:99], v[114:115]
    v_pk_fma_f32 v[118:119], v[106:107], v[106:107], v[118:119]
    v_pk_add_f32 v[112:113], v[112:113], v[100:101]
    v_pk_fma_f32 v[114:115], v[100:101], v[100:101], v[114:115]
    buffer_load_dwordx4 v251, s[16:19], s84 offen offset:3072 lds
    v_pk_add_f32 v[116:117], v[116:117], v[108:109]
    v_pk_fma_f32 v[118:119], v[108:109], v[108:109], v[118:119]
    v_pk_add_f32 v[112:113], v[112:113], v[102:103]
    v_pk_fma_f32 v[114:115], v[102:103], v[102:103], v[114:115]
    v_pk_add_f32 v[116:117], v[116:117], v[110:111]
    v_pk_fma_f32 v[118:119], v[110:111], v[110:111], v[118:119]
    v_add_f32 v112, v112, v113
    v_add_f32 v114, v114, v115
    v_add_f32 v113, v116, v117
    v_add_f32 v115, v118, v119
    s_nop 0
    v_add_f32_dpp v112, v112, v112 quad_perm:[1,0,3,2] row_mask:0xf bank_mask:0xf
    s_add_u32 m0, s86, 8192
    s_add_u32 s84, s85, 176128
    buffer_load_dwordx4 v252, s[72:75], s84 offen offset:0 lds
    v_add_f32_dpp v113, v113, v113 quad_perm:[1,0,3,2] row_mask:0xf bank_mask:0xf
    v_add_f32_dpp v114, v114, v114 quad_perm:[1,0,3,2] row_mask:0xf bank_mask:0xf
    v_add_f32_dpp v115, v115, v115 quad_perm:[1,0,3,2] row_mask:0xf bank_mask:0xf
    s_nop 0
    v_add_f32_dpp v112, v112, v112 quad_perm:[2,3,0,1] row_mask:0xf bank_mask:0xf
    v_add_f32_dpp v113, v113, v113 quad_perm:[2,3,0,1] row_mask:0xf bank_mask:0xf
    v_add_f32_dpp v114, v114, v114 quad_perm:[2,3,0,1] row_mask:0xf bank_mask:0xf
    v_add_f32_dpp v115, v115, v115 quad_perm:[2,3,0,1] row_mask:0xf bank_mask:0xf
    s_nop 0
    v_add_f32_dpp v112, v112, v112 row_half_mirror row_mask:0xf bank_mask:0xf
    v_add_f32_dpp v113, v113, v113 row_half_mirror row_mask:0xf bank_mask:0xf
    v_add_f32_dpp v114, v114, v114 row_half_mirror row_mask:0xf bank_mask:0xf
    buffer_load_dwordx4 v253, s[72:75], s84 offen offset:1024 lds
    v_add_f32_dpp v115, v115, v115 row_half_mirror row_mask:0xf bank_mask:0xf
    s_nop 0
    v_add_f32_dpp v112, v112, v112 row_mirror row_mask:0xf bank_mask:0xf
    v_add_f32_dpp v113, v113, v113 row_mirror row_mask:0xf bank_mask:0xf
    v_add_f32_dpp v114, v114, v114 row_mirror row_mask:0xf bank_mask:0xf
    v_add_f32_dpp v115, v115, v115 row_mirror row_mask:0xf bank_mask:0xf
    v_mov_b32 v116, v112
    v_mov_b32 v117, v113
    v_mov_b32 v118, v114
    v_mov_b32 v119, v115
    s_nop 0
    v_permlane16_swap_b32 v112, v116
    s_add_u32 m0, s61, 32768
    s_add_u32 s62, s60, 128
    buffer_load_dwordx4 v12, s[20:23], s62 offen offset:0 lds
    v_permlane16_swap_b32 v113, v117
    v_permlane16_swap_b32 v114, v118
    v_permlane16_swap_b32 v115, v119
    v_add_f32 v112, v112, v116
    v_add_f32 v113, v113, v117
    v_add_f32 v114, v114, v118
    v_add_f32 v115, v115, v119
    v_mov_b32 v116, v112
    v_mov_b32 v117, v113
    v_mov_b32 v118, v114
    v_mov_b32 v119, v115
    s_nop 0
    buffer_load_dwordx4 v13, s[20:23], s62 offen offset:1024 lds
    v_permlane32_swap_b32 v112, v116
    v_permlane32_swap_b32 v113, v117
    v_permlane32_swap_b32 v114, v118
    v_permlane32_swap_b32 v115, v119
    v_add_f32 v112, v112, v116
    v_add_f32 v113, v113, v117
    v_add_f32 v114, v114, v118
    v_add_f32 v115, v115, v119
    v_mul_f32 v112, 0x3b000000, v112
    v_mul_f32 v113, 0x3b000000, v113
    v_mul_f32 v114, 0x3b000000, v114
    v_mul_f32 v115, 0x3b000000, v115
    s_add_u32 m0, s61, 34816
    s_add_u32 s62, s60, 16512
    buffer_load_dwordx4 v12, s[20:23], s62 offen offset:0 lds
    v_fma_f32 v114, -v112, v112, v114
    v_fma_f32 v115, -v113, v113, v115
    v_add_f32 v112, s66, v112
    v_add_f32 v113, s100, v113
    v_max_f32 v114, 0, v114
    v_max_f32 v115, 0, v115
    v_mov_b32 v116, v112
    v_mov_b32 v117, v113
    v_mov_b32 v118, v114
    v_mov_b32 v119, v115
    v_cvt_pk_bf16_f32 v116, v116, v116
    v_cvt_pk_bf16_f32 v117, v117, v117
    buffer_load_dwordx4 v13, s[20:23], s62 offen offset:1024 lds
    v_lshlrev_b32 v116, 16, v116
    v_lshlrev_b32 v117, 16, v117
    v_cvt_pk_bf16_f32 v118, v118, v118
    v_cvt_pk_bf16_f32 v119, v119, v119
    v_lshlrev_b32 v118, 16, v118
    v_lshlrev_b32 v119, 16, v119
    v_add_f32 v118, 0x3727c5ac, v118
    v_add_f32 v119, 0x3727c5ac, v119
    v_cvt_pk_bf16_f32 v118, v118, v118
    v_cvt_pk_bf16_f32 v119, v119, v119
    v_lshlrev_b32 v118, 16, v118
    v_lshlrev_b32 v119, 16, v119
    s_add_u32 m0, s61, 36864
    s_add_u32 s62, s60, 32896
    buffer_load_dwordx4 v12, s[20:23], s62 offen offset:0 lds
    v_sqrt_f32 v118, v118
    v_sqrt_f32 v119, v119
    v_cvt_pk_bf16_f32 v118, v118, v118
    v_cvt_pk_bf16_f32 v119, v119, v119
    v_lshlrev_b32 v118, 16, v118
    v_lshlrev_b32 v119, 16, v119
    v_rcp_f32 v118, v118
    v_rcp_f32 v119, v119
    v_sub_f32 v72, 0, v116
    v_sub_f32 v76, 0, v117
    v_sub_f32 v112, v112, v116
    v_sub_f32 v113, v113, v117
    buffer_load_dwordx4 v13, s[20:23], s62 offen offset:1024 lds
    v_mul_f32 v73, 0x3e0293ee, v118
    v_mul_f32 v77, 0x3e0293ee, v119
    v_mul_f32 v114, v114, v118
    v_mul_f32 v115, v115, v119
    v_mul_f32 v112, v112, v118
    v_mul_f32 v113, v113, v119
    v_mul_f32 v114, v114, v118
    v_mul_f32 v115, v115, v119
    v_cvt_pk_bf16_f32 v112, v112, v112
    v_cvt_pk_bf16_f32 v113, v113, v113
    v_lshlrev_b32 v112, 16, v112
    v_lshlrev_b32 v113, 16, v113
    s_add_u32 m0, s61, 38912
    s_add_u32 s62, s60, 49280
    buffer_load_dwordx4 v12, s[20:23], s62 offen offset:0 lds
    v_cvt_pk_bf16_f32 v114, v114, v114
    v_cvt_pk_bf16_f32 v115, v115, v115
    v_lshlrev_b32 v114, 16, v114
    v_lshlrev_b32 v115, 16, v115
    v_add_f32 v114, 0x3727c5ac, v114
    v_add_f32 v115, 0x3727c5ac, v115
    v_cvt_pk_bf16_f32 v114, v114, v114
    v_cvt_pk_bf16_f32 v115, v115, v115
    v_lshlrev_b32 v114, 16, v114
    v_lshlrev_b32 v115, 16, v115
    v_sqrt_f32 v114, v114
    v_sqrt_f32 v115, v115
    buffer_load_dwordx4 v13, s[20:23], s62 offen offset:1024 lds
    v_cvt_pk_bf16_f32 v114, v114, v114
    v_cvt_pk_bf16_f32 v115, v115, v115
    v_lshlrev_b32 v114, 16, v114
    v_lshlrev_b32 v115, 16, v115
    v_rcp_f32 v114, v114
    v_rcp_f32 v115, v115
    v_fma_f32 v112, v116, v118, v112
    v_fma_f32 v113, v117, v119, v113
    v_mul_f32 v74, v118, v114
    v_mul_f32 v78, v119, v115
    v_mul_f32 v75, -v112, v114
    v_mul_f32 v79, -v113, v115
    s_mov_b64 exec, 1
    buffer_store_dwordx4 v[72:75], v255, s[44:47], s64 offen offset:0 sc1
    buffer_store_dwordx4 v[76:79], v255, s[44:47], s64 offen offset:16 sc1
    s_mov_b64 exec, -1
    buffer_load_dwordx2 v[14:15], v255, s[92:95], 0 offen sc1
    s_waitcnt vmcnt(17)
    s_barrier
    ds_read_b128 a[96:99], v9 offset:0
    ds_read_b128 a[100:103], v9 offset:2048
    ds_read_b128 a[104:107], v10 offset:0
    ds_read_b128 a[108:111], v10 offset:2048
    ds_read_b64_tr_b16 a[128:129], v240 offset:0
    ds_read_b64_tr_b16 a[130:131], v240 offset:1024
    ds_read_b64_tr_b16 a[132:133], v240 offset:8
    ds_read_b64_tr_b16 a[134:135], v240 offset:1032
    ds_read_b64_tr_b16 a[136:137], v241 offset:0
    ds_read_b64_tr_b16 a[138:139], v241 offset:1024
    ds_read_b64_tr_b16 a[140:141], v241 offset:8
    ds_read_b64_tr_b16 a[142:143], v241 offset:1032
    ds_read_b64_tr_b16 a[144:145], v242 offset:0
    ds_read_b64_tr_b16 a[146:147], v242 offset:1024
    ds_read_b64_tr_b16 a[148:149], v242 offset:8
    ds_read_b64_tr_b16 a[150:151], v242 offset:1032
    ds_read_b64_tr_b16 a[152:153], v243 offset:0
    ds_read_b64_tr_b16 a[154:155], v243 offset:1024
    ds_read_b64_tr_b16 a[156:157], v243 offset:8
    ds_read_b64_tr_b16 a[158:159], v243 offset:1032
    ds_read_b64_tr_b16 a[224:225], v8 offset:0
    ds_read_b64_tr_b16 a[226:227], v8 offset:1024
    ds_read_b64_tr_b16 a[228:229], v8 offset:8
    ds_read_b64_tr_b16 a[230:231], v8 offset:1032
    ds_read_b64_tr_b16 a[192:193], v244 offset:0
    ds_read_b64_tr_b16 a[194:195], v244 offset:512
    ds_read_b64_tr_b16 a[196:197], v245 offset:0
    ds_read_b64_tr_b16 a[198:199], v245 offset:512
    ds_read_b64_tr_b16 a[200:201], v246 offset:0
    ds_read_b64_tr_b16 a[202:203], v246 offset:512
    ds_read_b64_tr_b16 a[204:205], v247 offset:0
    ds_read_b64_tr_b16 a[206:207], v247 offset:512
    ds_read_b64_tr_b16 a[232:233], v254 offset:0
    ds_read_b64_tr_b16 a[234:235], v254 offset:512
    s_waitcnt lgkmcnt(10)
    v_mfma_f32_16x16x32_bf16 v[64:67], a[128:131], a[96:99], 0
    ds_read_b128 a[112:115], v11 offset:0
    v_accvgpr_write_b32 a0, 0
    v_mfma_f32_16x16x32_bf16 v[96:99], a[128:131], a[100:103], 0
    s_add_u32 m0, s33, 114688
    s_add_u32 s84, s83, 1048576
    v_mfma_f32_16x16x32_bf16 v[128:131], a[128:131], a[104:107], 0
    ds_read_b128 a[116:119], v11 offset:2048
    v_accvgpr_write_b32 a1, 0
    v_mfma_f32_16x16x32_bf16 v[160:163], a[128:131], a[108:111], 0
    buffer_load_dwordx4 v248, s[16:19], s84 offen offset:0 lds
    v_mfma_f32_16x16x32_bf16 v[68:71], a[132:135], a[96:99], 0
    ds_read_b128 a[120:123], v7 offset:0
    v_accvgpr_write_b32 a2, 0
    v_mfma_f32_16x16x32_bf16 v[100:103], a[132:135], a[100:103], 0
    s_lshl_b32 s37, s29, 19
    v_mfma_f32_16x16x32_bf16 v[132:135], a[132:135], a[104:107], 0
    ds_read_b128 a[124:127], v7 offset:2048
    v_accvgpr_write_b32 a3, 0
    v_mfma_f32_16x16x32_bf16 v[164:167], a[132:135], a[108:111], 0
    buffer_load_dwordx4 v249, s[16:19], s84 offen offset:1024 lds
    v_mfma_f32_16x16x32_bf16 v[72:75], a[136:139], a[96:99], 0
    ds_read_b64_tr_b16 a[160:161], v240 offset:8192
    v_accvgpr_write_b32 a4, 0
    v_mfma_f32_16x16x32_bf16 v[104:107], a[136:139], a[100:103], 0
    s_add_u32 s8, s76, s37
    s_addc_u32 s9, s77, 0
    v_mfma_f32_16x16x32_bf16 v[136:139], a[136:139], a[104:107], 0
    ds_read_b64_tr_b16 a[162:163], v240 offset:9216
    v_accvgpr_write_b32 a5, 0
    v_mfma_f32_16x16x32_bf16 v[168:171], a[136:139], a[108:111], 0
    buffer_load_dwordx4 v250, s[16:19], s84 offen offset:2048 lds
    v_mfma_f32_16x16x32_bf16 v[76:79], a[140:143], a[96:99], 0
    ds_read_b64_tr_b16 a[164:165], v240 offset:8200
    v_accvgpr_write_b32 a6, 0
    v_mfma_f32_16x16x32_bf16 v[108:111], a[140:143], a[100:103], 0
    s_mov_b32 s10, 524288
    s_mov_b32 s11, 0x20000
    v_mfma_f32_16x16x32_bf16 v[140:143], a[140:143], a[104:107], 0
    ds_read_b64_tr_b16 a[166:167], v240 offset:9224
    v_accvgpr_write_b32 a7, 0
    v_mfma_f32_16x16x32_bf16 v[172:175], a[140:143], a[108:111], 0
    buffer_load_dwordx4 v251, s[16:19], s84 offen offset:3072 lds
    v_mfma_f32_16x16x32_bf16 v[80:83], a[144:147], a[96:99], 0
    ds_read_b64_tr_b16 a[168:169], v241 offset:8192
    s_add_u32 s12, s78, s37
    s_addc_u32 s13, s79, 0
    v_mfma_f32_16x16x32_bf16 v[112:115], a[144:147], a[100:103], 0
    s_add_u32 m0, s86, 16384
    s_add_u32 s84, s85, 352256
    v_mfma_f32_16x16x32_bf16 v[144:147], a[144:147], a[104:107], 0
    ds_read_b64_tr_b16 a[170:171], v241 offset:9216
    s_mov_b32 s14, 524288
    v_mfma_f32_16x16x32_bf16 v[176:179], a[144:147], a[108:111], 0
    buffer_load_dwordx4 v252, s[72:75], s84 offen offset:0 lds
    v_mfma_f32_16x16x32_bf16 v[84:87], a[148:151], a[96:99], 0
    ds_read_b64_tr_b16 a[172:173], v241 offset:8200
    s_mov_b32 s15, 0x20000
    v_mfma_f32_16x16x32_bf16 v[116:119], a[148:151], a[100:103], 0
    v_lshlrev_b32 v50, 4, v3
    v_lshlrev_b32 v51, 3, v4
    v_mfma_f32_16x16x32_bf16 v[148:151], a[148:151], a[104:107], 0
    ds_read_b64_tr_b16 a[174:175], v241 offset:9224
    v_lshlrev_b32 v53, 4, v4
    v_mfma_f32_16x16x32_bf16 v[180:183], a[148:151], a[108:111], 0
    buffer_load_dwordx4 v253, s[72:75], s84 offen offset:1024 lds
    v_mfma_f32_16x16x32_bf16 v[88:91], a[152:155], a[96:99], 0
    ds_read_b64_tr_b16 a[176:177], v242 offset:8192
    v_add_u32 v53, 131072, v53
    v_mfma_f32_16x16x32_bf16 v[120:123], a[152:155], a[100:103], 0
    s_lshl_b32 s37, s28, 7
    v_add_u32 v52, s37, v53
    v_mfma_f32_16x16x32_bf16 v[152:155], a[152:155], a[104:107], 0
    ds_read_b64_tr_b16 a[178:179], v242 offset:9216
    s_lshl_b32 s37, s30, 4
    v_mfma_f32_16x16x32_bf16 v[184:187], a[152:155], a[108:111], 0
    s_lshl_b32 s38, s28, 2
    v_mfma_f32_16x16x32_bf16 v[92:95], a[156:159], a[96:99], 0
    ds_read_b64_tr_b16 a[180:181], v242 offset:8200
    ds_read_b64_tr_b16 a[182:183], v242 offset:9224
    v_mfma_f32_16x16x32_bf16 v[124:127], a[156:159], a[100:103], 0
    s_add_u32 s50, s37, s38
    s_mul_i32 s37, s50, 132096
    v_mfma_f32_16x16x32_bf16 v[156:159], a[156:159], a[104:107], 0
    ds_read_b64_tr_b16 a[184:185], v243 offset:8192
    ds_read_b64_tr_b16 a[186:187], v243 offset:9216
    s_waitcnt lgkmcnt(15)
    v_mfma_f32_16x16x32_bf16 v[188:191], a[156:159], a[108:111], 0
    s_lshl_b32 s38, s29, 12
    v_mfma_f32_16x16x32_bf16 v[192:195], a[192:195], a[96:99], 0
    ds_read_b64_tr_b16 a[188:189], v243 offset:8200
    ds_read_b64_tr_b16 a[190:191], v243 offset:9224
    v_mfma_f32_16x16x32_bf16 v[200:203], a[192:195], a[100:103], 0
    s_add_u32 s37, s37, s38
    v_mfma_f32_16x16x32_bf16 v[208:211], a[192:195], a[104:107], 0
    ds_read_b64_tr_b16 a[236:237], v8 offset:8192
    ds_read_b64_tr_b16 a[238:239], v8 offset:9216
    v_mfma_f32_16x16x32_bf16 v[216:219], a[192:195], a[108:111], 0
    s_add_u32 s37, s37, 16777216
    v_mfma_f32_16x16x32_bf16 v[196:199], a[196:199], a[96:99], 0
    ds_read_b64_tr_b16 a[240:241], v8 offset:8200
    ds_read_b64_tr_b16 a[242:243], v8 offset:9224
    v_mfma_f32_16x16x32_bf16 v[204:207], a[196:199], a[100:103], 0
    s_add_u32 s24, s54, s37
    s_addc_u32 s25, s55, 0
    v_mfma_f32_16x16x32_bf16 v[212:215], a[196:199], a[104:107], 0
    ds_read_b64_tr_b16 a[208:209], v244 offset:4096
    ds_read_b64_tr_b16 a[210:211], v244 offset:4608
    v_mfma_f32_16x16x32_bf16 v[220:223], a[196:199], a[108:111], 0
    s_mov_b32 s26, 400384
    s_mov_b32 s27, 0x20000
    v_mfma_f32_16x16x32_bf16 v[224:227], a[200:203], a[96:99], 0
    ds_read_b64_tr_b16 a[212:213], v245 offset:4096
    ds_read_b64_tr_b16 a[214:215], v245 offset:4608
    v_mfma_f32_16x16x32_bf16 v[232:235], a[200:203], a[100:103], 0
    s_mul_i32 s37, s50, 44032
    v_mfma_f32_16x16x32_bf16 v[228:231], a[204:207], a[96:99], 0
    ds_read_b64_tr_b16 a[216:217], v246 offset:4096
    ds_read_b64_tr_b16 a[218:219], v246 offset:4608
    v_mfma_f32_16x16x32_bf16 v[236:239], a[204:207], a[100:103], 0
    s_add_u32 s37, s37, 4194304
    v_mfma_f32_16x16x32_bf16 v[34:37], a[224:227], v[46:49], 0
    ds_read_b64_tr_b16 a[220:221], v247 offset:4096
    ds_read_b64_tr_b16 a[222:223], v247 offset:4608
    v_mfma_f32_16x16x32_bf16 v[38:41], a[228:231], v[46:49], 0
    s_add_u32 s76, s54, s37
    s_addc_u32 s77, s55, 0
    v_mfma_f32_16x16x32_bf16 v[42:45], a[232:235], v[46:49], 0
    ds_read_b64_tr_b16 a[244:245], v254 offset:4096
    ds_read_b64_tr_b16 a[246:247], v254 offset:4608
    s_waitcnt vmcnt(9) lgkmcnt(10)
    s_barrier
    v_mfma_f32_16x16x32_bf16 v[64:67], a[160:163], a[112:115], v[64:67]
    ds_read_b128 a[96:99], v9 offset:32768
    v_accvgpr_write_b32 a8, 0
    v_mfma_f32_16x16x32_bf16 v[96:99], a[160:163], a[116:119], v[96:99]
    s_add_u32 m0, s61, 0
    s_add_u32 s62, s60, 256
    v_mfma_f32_16x16x32_bf16 v[128:131], a[160:163], a[120:123], v[128:131]
    ds_read_b128 a[100:103], v9 offset:34816
    v_accvgpr_write_b32 a9, 0
    v_mfma_f32_16x16x32_bf16 v[160:163], a[160:163], a[124:127], v[160:163]
    buffer_load_dwordx4 v12, s[20:23], s62 offen offset:0 lds
    v_mfma_f32_16x16x32_bf16 v[68:71], a[164:167], a[112:115], v[68:71]
    ds_read_b128 a[104:107], v10 offset:32768
    v_accvgpr_write_b32 a10, 0
    v_mfma_f32_16x16x32_bf16 v[100:103], a[164:167], a[116:119], v[100:103]
    s_mov_b32 s78, 176128
    s_mov_b32 s79, 0x20000
    v_mfma_f32_16x16x32_bf16 v[132:135], a[164:167], a[120:123], v[132:135]
    ds_read_b128 a[108:111], v10 offset:34816
    v_accvgpr_write_b32 a11, 0
    v_mfma_f32_16x16x32_bf16 v[164:167], a[164:167], a[124:127], v[164:167]
    buffer_load_dwordx4 v13, s[20:23], s62 offen offset:1024 lds
    v_mfma_f32_16x16x32_bf16 v[72:75], a[168:171], a[112:115], v[72:75]
    ds_read_b64_tr_b16 a[128:129], v240 offset:16384
    v_accvgpr_write_b32 a12, 0
    v_mfma_f32_16x16x32_bf16 v[104:107], a[168:171], a[116:119], v[104:107]
    s_add_u32 m0, s61, 2048
    s_add_u32 s62, s60, 16640
    v_mfma_f32_16x16x32_bf16 v[136:139], a[168:171], a[120:123], v[136:139]
    ds_read_b64_tr_b16 a[130:131], v240 offset:17408
    v_accvgpr_write_b32 a13, 0
    v_mfma_f32_16x16x32_bf16 v[168:171], a[168:171], a[124:127], v[168:171]
    buffer_load_dwordx4 v12, s[20:23], s62 offen offset:0 lds
    v_mfma_f32_16x16x32_bf16 v[76:79], a[172:175], a[112:115], v[76:79]
    ds_read_b64_tr_b16 a[132:133], v240 offset:16392
    v_accvgpr_write_b32 a14, 0
    v_mfma_f32_16x16x32_bf16 v[108:111], a[172:175], a[116:119], v[108:111]
    s_add_u32 s68, s58, 0
    s_addc_u32 s69, s59, 0
    v_mfma_f32_16x16x32_bf16 v[140:143], a[172:175], a[120:123], v[140:143]
    ds_read_b64_tr_b16 a[134:135], v240 offset:17416
    v_accvgpr_write_b32 a15, 0
    v_mfma_f32_16x16x32_bf16 v[172:175], a[172:175], a[124:127], v[172:175]
    buffer_load_dwordx4 v13, s[20:23], s62 offen offset:1024 lds
    v_mfma_f32_16x16x32_bf16 v[80:83], a[176:179], a[112:115], v[80:83]
    ds_read_b64_tr_b16 a[136:137], v241 offset:16384
    s_mov_b32 s70, 2752
    v_mfma_f32_16x16x32_bf16 v[112:115], a[176:179], a[116:119], v[112:115]
    s_add_u32 m0, s61, 4096
    s_add_u32 s62, s60, 33024
    v_mfma_f32_16x16x32_bf16 v[144:147], a[176:179], a[120:123], v[144:147]
    ds_read_b64_tr_b16 a[138:139], v241 offset:17408
    s_mov_b32 s71, 0x20000
    v_mfma_f32_16x16x32_bf16 v[176:179], a[176:179], a[124:127], v[176:179]
    buffer_load_dwordx4 v12, s[20:23], s62 offen offset:0 lds
    v_mfma_f32_16x16x32_bf16 v[84:87], a[180:183], a[112:115], v[84:87]
    ds_read_b64_tr_b16 a[140:141], v241 offset:16392
    s_add_u32 s48, s50, s80
    v_mfma_f32_16x16x32_bf16 v[116:119], a[180:183], a[116:119], v[116:119]
    s_lshl_b32 s48, s48, 8
    v_mfma_f32_16x16x32_bf16 v[148:151], a[180:183], a[120:123], v[148:151]
    ds_read_b64_tr_b16 a[142:143], v241 offset:17416
    s_add_u32 s49, s50, s81
    v_mfma_f32_16x16x32_bf16 v[180:183], a[180:183], a[124:127], v[180:183]
    buffer_load_dwordx4 v13, s[20:23], s62 offen offset:1024 lds
    v_mfma_f32_16x16x32_bf16 v[88:91], a[184:187], a[112:115], v[88:91]
    ds_read_b64_tr_b16 a[144:145], v242 offset:16384
    s_lshl_b32 s49, s49, 8
    v_mfma_f32_16x16x32_bf16 v[120:123], a[184:187], a[116:119], v[120:123]
    s_add_u32 m0, s61, 6144
    s_add_u32 s62, s60, 49408
    v_mfma_f32_16x16x32_bf16 v[152:155], a[184:187], a[120:123], v[152:155]
    ds_read_b64_tr_b16 a[146:147], v242 offset:17408
    s_lshl_b32 s50, s29, 6
    v_mfma_f32_16x16x32_bf16 v[184:187], a[184:187], a[124:127], v[184:187]
    buffer_load_dwordx4 v12, s[20:23], s62 offen offset:0 lds
    v_mfma_f32_16x16x32_bf16 v[92:95], a[188:191], a[112:115], v[92:95]
    ds_read_b64_tr_b16 a[148:149], v242 offset:16392
    ds_read_b64_tr_b16 a[150:151], v242 offset:17416
    v_mfma_f32_16x16x32_bf16 v[124:127], a[188:191], a[116:119], v[124:127]
    s_lshl_b32 s51, s82, 6
    s_mov_b32 s36, 0x4b800000
    v_mfma_f32_16x16x32_bf16 v[156:159], a[188:191], a[120:123], v[156:159]
    ds_read_b64_tr_b16 a[152:153], v243 offset:16384
    ds_read_b64_tr_b16 a[154:155], v243 offset:17408
    s_waitcnt lgkmcnt(15)
    v_mfma_f32_16x16x32_bf16 v[188:191], a[188:191], a[124:127], v[188:191]
    buffer_load_dwordx4 v13, s[20:23], s62 offen offset:1024 lds
    v_mfma_f32_16x16x32_bf16 v[192:195], a[208:211], a[112:115], v[192:195]
    ds_read_b64_tr_b16 a[156:157], v243 offset:16392
    ds_read_b64_tr_b16 a[158:159], v243 offset:17416
    v_mfma_f32_16x16x32_bf16 v[200:203], a[208:211], a[116:119], v[200:203]
    s_and_b32 s39, s2, 7
    s_lshr_b32 s39, s39, 1
    v_mfma_f32_16x16x32_bf16 v[208:211], a[208:211], a[120:123], v[208:211]
    ds_read_b64_tr_b16 a[224:225], v8 offset:16384
    ds_read_b64_tr_b16 a[226:227], v8 offset:17408
    v_mfma_f32_16x16x32_bf16 v[216:219], a[208:211], a[124:127], v[216:219]
    s_and_b32 s42, s2, 1
    s_lshl_b32 s37, s30, 1
    v_mfma_f32_16x16x32_bf16 v[196:199], a[212:215], a[112:115], v[196:199]
    ds_read_b64_tr_b16 a[228:229], v8 offset:16392
    ds_read_b64_tr_b16 a[230:231], v8 offset:17416
    v_mfma_f32_16x16x32_bf16 v[204:207], a[212:215], a[116:119], v[204:207]
    s_add_u32 s42, s42, s37
    s_and_b32 s43, s29, 3
    v_mfma_f32_16x16x32_bf16 v[212:215], a[212:215], a[120:123], v[212:215]
    ds_read_b64_tr_b16 a[192:193], v244 offset:8192
    ds_read_b64_tr_b16 a[194:195], v244 offset:8704
    v_mfma_f32_16x16x32_bf16 v[220:223], a[212:215], a[124:127], v[220:223]
    s_lshl_b32 s3, s42, 2
    v_mfma_f32_16x16x32_bf16 v[224:227], a[216:219], a[112:115], v[224:227]
    ds_read_b64_tr_b16 a[196:197], v245 offset:8192
    ds_read_b64_tr_b16 a[198:199], v245 offset:8704
    v_mfma_f32_16x16x32_bf16 v[232:235], a[216:219], a[116:119], v[232:235]
    s_add_u32 s3, s3, s43
    s_lshl_b32 s37, s3, 2
    v_mfma_f32_16x16x32_bf16 v[228:231], a[220:223], a[112:115], v[228:231]
    ds_read_b64_tr_b16 a[200:201], v246 offset:8192
    ds_read_b64_tr_b16 a[202:203], v246 offset:8704
    v_mfma_f32_16x16x32_bf16 v[236:239], a[220:223], a[116:119], v[236:239]
    s_add_u32 s37, s37, s39
    s_lshl_b32 s37, s37, 2
    v_mfma_f32_16x16x32_bf16 v[34:37], a[236:239], v[46:49], v[34:37]
    ds_read_b64_tr_b16 a[204:205], v247 offset:8192
    ds_read_b64_tr_b16 a[206:207], v247 offset:8704
    v_mfma_f32_16x16x32_bf16 v[38:41], a[240:243], v[46:49], v[38:41]
    s_add_u32 s37, s37, s28
    s_mul_i32 s37, s37, 12288
    v_mfma_f32_16x16x32_bf16 v[42:45], a[244:247], v[46:49], v[42:45]
    ds_read_b64_tr_b16 a[232:233], v254 offset:8192
    ds_read_b64_tr_b16 a[234:235], v254 offset:8704
    s_waitcnt lgkmcnt(10)
    v_mfma_f32_16x16x32_bf16 v[64:67], a[128:131], a[96:99], v[64:67]
    ds_read_b128 a[112:115], v11 offset:32768
    v_accvgpr_write_b32 a16, 0
    v_mfma_f32_16x16x32_bf16 v[96:99], a[128:131], a[100:103], v[96:99]
    s_add_u32 m0, s33, 81920
    s_add_u32 s84, s83, 1572864
    v_mfma_f32_16x16x32_bf16 v[128:131], a[128:131], a[104:107], v[128:131]
    ds_read_b128 a[116:119], v11 offset:34816
    v_accvgpr_write_b32 a17, 0
    v_mfma_f32_16x16x32_bf16 v[160:163], a[128:131], a[108:111], v[160:163]
    buffer_load_dwordx4 v248, s[16:19], s84 offen offset:0 lds
    v_mfma_f32_16x16x32_bf16 v[68:71], a[132:135], a[96:99], v[68:71]
    ds_read_b128 a[120:123], v7 offset:32768
    v_accvgpr_write_b32 a18, 0
    v_mfma_f32_16x16x32_bf16 v[100:103], a[132:135], a[100:103], v[100:103]
    s_add_u32 s37, s37, 41943040
    v_mfma_f32_16x16x32_bf16 v[132:135], a[132:135], a[104:107], v[132:135]
    ds_read_b128 a[124:127], v7 offset:34816
    v_accvgpr_write_b32 a19, 0
    v_mfma_f32_16x16x32_bf16 v[164:167], a[132:135], a[108:111], v[164:167]
    buffer_load_dwordx4 v249, s[16:19], s84 offen offset:1024 lds
    v_mfma_f32_16x16x32_bf16 v[72:75], a[136:139], a[96:99], v[72:75]
    ds_read_b64_tr_b16 a[160:161], v240 offset:24576
    v_accvgpr_write_b32 a20, 0
    v_mfma_f32_16x16x32_bf16 v[104:107], a[136:139], a[100:103], v[104:107]
    s_add_u32 s4, s54, s37
    s_addc_u32 s5, s55, 0
    v_mfma_f32_16x16x32_bf16 v[136:139], a[136:139], a[104:107], v[136:139]
    ds_read_b64_tr_b16 a[162:163], v240 offset:25600
    v_accvgpr_write_b32 a21, 0
    v_mfma_f32_16x16x32_bf16 v[168:171], a[136:139], a[108:111], v[168:171]
    buffer_load_dwordx4 v250, s[16:19], s84 offen offset:2048 lds
    v_mfma_f32_16x16x32_bf16 v[76:79], a[140:143], a[96:99], v[76:79]
    ds_read_b64_tr_b16 a[164:165], v240 offset:24584
    v_accvgpr_write_b32 a22, 0
    v_mfma_f32_16x16x32_bf16 v[108:111], a[140:143], a[100:103], v[108:111]
    s_mov_b32 s6, 12288
    s_mov_b32 s7, 0x20000
    v_mfma_f32_16x16x32_bf16 v[140:143], a[140:143], a[104:107], v[140:143]
    ds_read_b64_tr_b16 a[166:167], v240 offset:25608
    v_accvgpr_write_b32 a23, 0
    v_mfma_f32_16x16x32_bf16 v[172:175], a[140:143], a[108:111], v[172:175]
    buffer_load_dwordx4 v251, s[16:19], s84 offen offset:3072 lds
    v_mfma_f32_16x16x32_bf16 v[80:83], a[144:147], a[96:99], v[80:83]
    ds_read_b64_tr_b16 a[168:169], v241 offset:24576
    v_add_u32 v59, 0, v4
    v_mfma_f32_16x16x32_bf16 v[112:115], a[144:147], a[100:103], v[112:115]
    s_add_u32 m0, s86, 24576
    s_add_u32 s84, s85, 528384
    v_mfma_f32_16x16x32_bf16 v[144:147], a[144:147], a[104:107], v[144:147]
    ds_read_b64_tr_b16 a[170:171], v241 offset:25600
    v_xor_b32 v59, v59, v3
    v_mfma_f32_16x16x32_bf16 v[176:179], a[144:147], a[108:111], v[176:179]
    buffer_load_dwordx4 v252, s[72:75], s84 offen offset:0 lds
    v_mfma_f32_16x16x32_bf16 v[84:87], a[148:151], a[96:99], v[84:87]
    ds_read_b64_tr_b16 a[172:173], v241 offset:24584
    v_lshlrev_b32 v59, 4, v59
    v_mfma_f32_16x16x32_bf16 v[116:119], a[148:151], a[100:103], v[116:119]
    v_lshl_add_u32 v16, v3, 8, v59
    v_add_u32 v59, 4, v4
    v_mfma_f32_16x16x32_bf16 v[148:151], a[148:151], a[104:107], v[148:151]
    ds_read_b64_tr_b16 a[174:175], v241 offset:25608
    v_xor_b32 v59, v59, v3
    v_mfma_f32_16x16x32_bf16 v[180:183], a[148:151], a[108:111], v[180:183]
    buffer_load_dwordx4 v253, s[72:75], s84 offen offset:1024 lds
    v_mfma_f32_16x16x32_bf16 v[88:91], a[152:155], a[96:99], v[88:91]
    ds_read_b64_tr_b16 a[176:177], v242 offset:24576
    v_lshlrev_b32 v59, 4, v59
    v_mfma_f32_16x16x32_bf16 v[120:123], a[152:155], a[100:103], v[120:123]
    v_lshl_add_u32 v17, v3, 8, v59
    v_add_u32 v59, 8, v4
    v_mfma_f32_16x16x32_bf16 v[152:155], a[152:155], a[104:107], v[152:155]
    ds_read_b64_tr_b16 a[178:179], v242 offset:25600
    v_xor_b32 v59, v59, v3
    v_mfma_f32_16x16x32_bf16 v[184:187], a[152:155], a[108:111], v[184:187]
    v_lshlrev_b32 v59, 4, v59
    v_lshl_add_u32 v18, v3, 8, v59
    v_mfma_f32_16x16x32_bf16 v[92:95], a[156:159], a[96:99], v[92:95]
    ds_read_b64_tr_b16 a[180:181], v242 offset:24584
    ds_read_b64_tr_b16 a[182:183], v242 offset:25608
    v_mfma_f32_16x16x32_bf16 v[124:127], a[156:159], a[100:103], v[124:127]
    v_add_u32 v59, 12, v4
    v_xor_b32 v59, v59, v3
    v_mfma_f32_16x16x32_bf16 v[156:159], a[156:159], a[104:107], v[156:159]
    ds_read_b64_tr_b16 a[184:185], v243 offset:24576
    ds_read_b64_tr_b16 a[186:187], v243 offset:25600
    s_waitcnt lgkmcnt(15)
    v_mfma_f32_16x16x32_bf16 v[188:191], a[156:159], a[108:111], v[188:191]
    v_lshlrev_b32 v59, 4, v59
    v_lshl_add_u32 v19, v3, 8, v59
    v_mfma_f32_16x16x32_bf16 v[192:195], a[192:195], a[96:99], v[192:195]
    ds_read_b64_tr_b16 a[188:189], v243 offset:24584
    ds_read_b64_tr_b16 a[190:191], v243 offset:25608
    v_mfma_f32_16x16x32_bf16 v[200:203], a[192:195], a[100:103], v[200:203]
    v_lshl_add_u32 v62, v4, 2, v56
    v_lshlrev_b32 v62, 8, v62
    v_mfma_f32_16x16x32_bf16 v[208:211], a[192:195], a[104:107], v[208:211]
    ds_read_b64_tr_b16 a[236:237], v8 offset:24576
    ds_read_b64_tr_b16 a[238:239], v8 offset:25600
    v_mfma_f32_16x16x32_bf16 v[216:219], a[192:195], a[108:111], v[216:219]
    v_lshrrev_b32 v60, 1, v57
    v_lshl_add_u32 v62, v60, 4, v62
    v_mfma_f32_16x16x32_bf16 v[196:199], a[196:199], a[96:99], v[196:199]
    ds_read_b64_tr_b16 a[240:241], v8 offset:24584
    ds_read_b64_tr_b16 a[242:243], v8 offset:25608
    v_mfma_f32_16x16x32_bf16 v[204:207], a[196:199], a[100:103], v[204:207]
    v_and_b32 v60, 1, v57
    v_lshl_add_u32 v62, v60, 3, v62
    v_mfma_f32_16x16x32_bf16 v[212:215], a[196:199], a[104:107], v[212:215]
    ds_read_b64_tr_b16 a[208:209], v244 offset:12288
    ds_read_b64_tr_b16 a[210:211], v244 offset:12800
    v_mfma_f32_16x16x32_bf16 v[220:223], a[196:199], a[108:111], v[220:223]
    v_add_u32 v62, 65536, v62
    v_xor_b32 v59, 0, v58
    v_mfma_f32_16x16x32_bf16 v[224:227], a[200:203], a[96:99], v[224:227]
    ds_read_b64_tr_b16 a[212:213], v245 offset:12288
    ds_read_b64_tr_b16 a[214:215], v245 offset:12800
    v_mfma_f32_16x16x32_bf16 v[232:235], a[200:203], a[100:103], v[232:235]
    v_lshl_add_u32 v20, v59, 5, v62
    v_xor_b32 v59, 1, v58
    v_mfma_f32_16x16x32_bf16 v[228:231], a[204:207], a[96:99], v[228:231]
    ds_read_b64_tr_b16 a[216:217], v246 offset:12288
    ds_read_b64_tr_b16 a[218:219], v246 offset:12800
    v_mfma_f32_16x16x32_bf16 v[236:239], a[204:207], a[100:103], v[236:239]
    v_lshl_add_u32 v21, v59, 5, v62
    v_xor_b32 v59, 2, v58
    v_mfma_f32_16x16x32_bf16 v[34:37], a[224:227], v[46:49], v[34:37]
    ds_read_b64_tr_b16 a[220:221], v247 offset:12288
    ds_read_b64_tr_b16 a[222:223], v247 offset:12800
    v_mfma_f32_16x16x32_bf16 v[38:41], a[228:231], v[46:49], v[38:41]
    v_lshl_add_u32 v22, v59, 5, v62
    v_xor_b32 v59, 3, v58
    v_mfma_f32_16x16x32_bf16 v[42:45], a[232:235], v[46:49], v[42:45]
    ds_read_b64_tr_b16 a[244:245], v254 offset:12288
    ds_read_b64_tr_b16 a[246:247], v254 offset:12800
    s_waitcnt vmcnt(20)
attn_tag:
    v_cmp_eq_u32 vcc, 0, v14
    s_cbranch_vccz attn_tagged
    buffer_load_dwordx2 v[14:15], v255, s[92:95], 0 offen sc1
    s_waitcnt vmcnt(0)
    s_branch attn_tag
attn_tagged:
    v_readfirstlane_b32 s100, v14
    v_readfirstlane_b32 s101, v15
    s_add_u32 s92, s54, 3145728
    s_addc_u32 s93, s55, 0
    s_mov_b32 s94, 98304
    s_mov_b32 s95, 0x20000
    s_lshl_b32 s87, s87, 7
    s_waitcnt vmcnt(6) lgkmcnt(10)
    s_barrier
    s_cmp_lg_u32 s28, 0
    s_cbranch_scc1 attn_flagged
    s_mov_b64 exec, 1
    buffer_store_dwordx2 v[14:15], v255, s[92:95], s87 offen sc1
    s_mov_b64 exec, -1
attn_flagged:
    s_lshl_b32 s87, s30, 12
    v_mfma_f32_16x16x32_bf16 v[64:67], a[160:163], a[112:115], v[64:67]
    ds_read_b128 a[96:99], v9 offset:0
    v_accvgpr_write_b32 a24, 0
    v_mfma_f32_16x16x32_bf16 v[96:99], a[160:163], a[116:119], v[96:99]
    s_add_u32 m0, s61, 32768
    s_add_u32 s62, s60, 384
    v_mfma_f32_16x16x32_bf16 v[128:131], a[160:163], a[120:123], v[128:131]
    ds_read_b128 a[100:103], v9 offset:2048
    v_accvgpr_write_b32 a25, 0
    v_mfma_f32_16x16x32_bf16 v[160:163], a[160:163], a[124:127], v[160:163]
    buffer_load_dwordx4 v12, s[20:23], s62 offen offset:0 lds
    v_mfma_f32_16x16x32_bf16 v[68:71], a[164:167], a[112:115], v[68:71]
    ds_read_b128 a[104:107], v10 offset:0
    v_accvgpr_write_b32 a26, 0
    v_mfma_f32_16x16x32_bf16 v[100:103], a[164:167], a[116:119], v[100:103]
    v_lshl_add_u32 v23, v59, 5, v62
    v_xor_b32 v59, 4, v58
    v_mfma_f32_16x16x32_bf16 v[132:135], a[164:167], a[120:123], v[132:135]
    ds_read_b128 a[108:111], v10 offset:2048
    v_accvgpr_write_b32 a27, 0
    v_mfma_f32_16x16x32_bf16 v[164:167], a[164:167], a[124:127], v[164:167]
    buffer_load_dwordx4 v13, s[20:23], s62 offen offset:1024 lds
    v_mfma_f32_16x16x32_bf16 v[72:75], a[168:171], a[112:115], v[72:75]
    ds_read_b64_tr_b16 a[128:129], v240 offset:32768
    v_accvgpr_write_b32 a28, 0
    v_mfma_f32_16x16x32_bf16 v[104:107], a[168:171], a[116:119], v[104:107]
    s_add_u32 m0, s61, 34816
    s_add_u32 s62, s60, 16768
    v_mfma_f32_16x16x32_bf16 v[136:139], a[168:171], a[120:123], v[136:139]
    ds_read_b64_tr_b16 a[130:131], v240 offset:33792
    v_accvgpr_write_b32 a29, 0
    v_mfma_f32_16x16x32_bf16 v[168:171], a[168:171], a[124:127], v[168:171]
    buffer_load_dwordx4 v12, s[20:23], s62 offen offset:0 lds
    v_mfma_f32_16x16x32_bf16 v[76:79], a[172:175], a[112:115], v[76:79]
    ds_read_b64_tr_b16 a[132:133], v240 offset:32776
    v_accvgpr_write_b32 a30, 0
    v_mfma_f32_16x16x32_bf16 v[108:111], a[172:175], a[116:119], v[108:111]
    v_lshl_add_u32 v24, v59, 5, v62
    v_xor_b32 v59, 5, v58
    v_mfma_f32_16x16x32_bf16 v[140:143], a[172:175], a[120:123], v[140:143]
    ds_read_b64_tr_b16 a[134:135], v240 offset:33800
    v_accvgpr_write_b32 a31, 0
    v_mfma_f32_16x16x32_bf16 v[172:175], a[172:175], a[124:127], v[172:175]
    buffer_load_dwordx4 v13, s[20:23], s62 offen offset:1024 lds
    v_mfma_f32_16x16x32_bf16 v[80:83], a[176:179], a[112:115], v[80:83]
    ds_read_b64_tr_b16 a[136:137], v241 offset:32768
    v_lshl_add_u32 v25, v59, 5, v62
    v_mfma_f32_16x16x32_bf16 v[112:115], a[176:179], a[116:119], v[112:115]
    s_add_u32 m0, s61, 36864
    s_add_u32 s62, s60, 33152
    v_mfma_f32_16x16x32_bf16 v[144:147], a[176:179], a[120:123], v[144:147]
    ds_read_b64_tr_b16 a[138:139], v241 offset:33792
    v_xor_b32 v59, 6, v58
    v_mfma_f32_16x16x32_bf16 v[176:179], a[176:179], a[124:127], v[176:179]
    buffer_load_dwordx4 v12, s[20:23], s62 offen offset:0 lds
    v_mfma_f32_16x16x32_bf16 v[84:87], a[180:183], a[112:115], v[84:87]
    ds_read_b64_tr_b16 a[140:141], v241 offset:32776
    v_lshl_add_u32 v26, v59, 5, v62
    v_mfma_f32_16x16x32_bf16 v[116:119], a[180:183], a[116:119], v[116:119]
    v_xor_b32 v59, 7, v58
    v_lshl_add_u32 v27, v59, 5, v62
    v_mfma_f32_16x16x32_bf16 v[148:151], a[180:183], a[120:123], v[148:151]
    ds_read_b64_tr_b16 a[142:143], v241 offset:33800
    v_mov_b32 v63, s33
    v_mfma_f32_16x16x32_bf16 v[180:183], a[180:183], a[124:127], v[180:183]
    buffer_load_dwordx4 v13, s[20:23], s62 offen offset:1024 lds
    v_mfma_f32_16x16x32_bf16 v[88:91], a[184:187], a[112:115], v[88:91]
    ds_read_b64_tr_b16 a[144:145], v242 offset:32768
    v_lshl_add_u32 v63, v4, 8, v63
    v_mfma_f32_16x16x32_bf16 v[120:123], a[184:187], a[116:119], v[120:123]
    s_add_u32 m0, s61, 38912
    s_add_u32 s62, s60, 49536
    v_mfma_f32_16x16x32_bf16 v[152:155], a[184:187], a[120:123], v[152:155]
    ds_read_b64_tr_b16 a[146:147], v242 offset:33792
    v_add_u32 v56, 0, v4
    v_mfma_f32_16x16x32_bf16 v[184:187], a[184:187], a[124:127], v[184:187]
    buffer_load_dwordx4 v12, s[20:23], s62 offen offset:0 lds
    v_mfma_f32_16x16x32_bf16 v[92:95], a[188:191], a[112:115], v[92:95]
    ds_read_b64_tr_b16 a[148:149], v242 offset:32776
    ds_read_b64_tr_b16 a[150:151], v242 offset:33800
    v_mfma_f32_16x16x32_bf16 v[124:127], a[188:191], a[116:119], v[124:127]
    v_xor_b32 v56, v56, v3
    v_lshl_add_u32 v28, v56, 4, v63
    v_mfma_f32_16x16x32_bf16 v[156:159], a[188:191], a[120:123], v[156:159]
    ds_read_b64_tr_b16 a[152:153], v243 offset:32768
    ds_read_b64_tr_b16 a[154:155], v243 offset:33792
    s_waitcnt lgkmcnt(15)
    v_mfma_f32_16x16x32_bf16 v[188:191], a[188:191], a[124:127], v[188:191]
    buffer_load_dwordx4 v13, s[20:23], s62 offen offset:1024 lds
    v_mfma_f32_16x16x32_bf16 v[192:195], a[208:211], a[112:115], v[192:195]
    ds_read_b64_tr_b16 a[156:157], v243 offset:32776
    ds_read_b64_tr_b16 a[158:159], v243 offset:33800
    v_mfma_f32_16x16x32_bf16 v[200:203], a[208:211], a[116:119], v[200:203]
    v_add_u32 v56, 4, v4
    v_xor_b32 v56, v56, v3
    v_mfma_f32_16x16x32_bf16 v[208:211], a[208:211], a[120:123], v[208:211]
    ds_read_b64_tr_b16 a[224:225], v8 offset:32768
    ds_read_b64_tr_b16 a[226:227], v8 offset:33792
    v_mfma_f32_16x16x32_bf16 v[216:219], a[208:211], a[124:127], v[216:219]
    v_lshl_add_u32 v29, v56, 4, v63
    v_add_u32 v56, 8, v4
    v_mfma_f32_16x16x32_bf16 v[196:199], a[212:215], a[112:115], v[196:199]
    ds_read_b64_tr_b16 a[228:229], v8 offset:32776
    ds_read_b64_tr_b16 a[230:231], v8 offset:33800
    v_mfma_f32_16x16x32_bf16 v[204:207], a[212:215], a[116:119], v[204:207]
    v_xor_b32 v56, v56, v3
    v_lshl_add_u32 v30, v56, 4, v63
    v_mfma_f32_16x16x32_bf16 v[212:215], a[212:215], a[120:123], v[212:215]
    ds_read_b64_tr_b16 a[192:193], v244 offset:16384
    ds_read_b64_tr_b16 a[194:195], v244 offset:16896
    v_mfma_f32_16x16x32_bf16 v[220:223], a[212:215], a[124:127], v[220:223]
    v_add_u32 v56, 12, v4
    v_xor_b32 v56, v56, v3
    v_mfma_f32_16x16x32_bf16 v[224:227], a[216:219], a[112:115], v[224:227]
    ds_read_b64_tr_b16 a[196:197], v245 offset:16384
    ds_read_b64_tr_b16 a[198:199], v245 offset:16896
    v_mfma_f32_16x16x32_bf16 v[232:235], a[216:219], a[116:119], v[232:235]
    v_lshl_add_u32 v31, v56, 4, v63
    v_add_u32 v32, v5, v63
    v_mfma_f32_16x16x32_bf16 v[228:231], a[220:223], a[112:115], v[228:231]
    ds_read_b64_tr_b16 a[200:201], v246 offset:16384
    ds_read_b64_tr_b16 a[202:203], v246 offset:16896
    v_mfma_f32_16x16x32_bf16 v[236:239], a[220:223], a[116:119], v[236:239]
    v_add_u32 v33, v6, v63
    v_lshlrev_b32 v1, 3, v54
    v_mfma_f32_16x16x32_bf16 v[34:37], a[236:239], v[46:49], v[34:37]
    ds_read_b64_tr_b16 a[204:205], v247 offset:16384
    ds_read_b64_tr_b16 a[206:207], v247 offset:16896
    v_mfma_f32_16x16x32_bf16 v[38:41], a[240:243], v[46:49], v[38:41]
    v_mfma_f32_16x16x32_bf16 v[42:45], a[244:247], v[46:49], v[42:45]
    ds_read_b64_tr_b16 a[232:233], v254 offset:16384
    ds_read_b64_tr_b16 a[234:235], v254 offset:16896
    s_waitcnt lgkmcnt(10)
    v_mfma_f32_16x16x32_bf16 v[64:67], a[128:131], a[96:99], v[64:67]
    ds_read_b128 a[112:115], v11 offset:0
    v_accvgpr_write_b32 a32, 0
    v_mfma_f32_16x16x32_bf16 v[96:99], a[128:131], a[100:103], v[96:99]
    s_add_u32 m0, s33, 98304
    s_add_u32 s84, s83, 2097152
    v_mfma_f32_16x16x32_bf16 v[128:131], a[128:131], a[104:107], v[128:131]
    ds_read_b128 a[116:119], v11 offset:2048
    v_accvgpr_write_b32 a33, 0
    v_mfma_f32_16x16x32_bf16 v[160:163], a[128:131], a[108:111], v[160:163]
    buffer_load_dwordx4 v248, s[16:19], s84 offen offset:0 lds
    v_mfma_f32_16x16x32_bf16 v[68:71], a[132:135], a[96:99], v[68:71]
    ds_read_b128 a[120:123], v7 offset:0
    v_accvgpr_write_b32 a34, 0
    v_mfma_f32_16x16x32_bf16 v[100:103], a[132:135], a[100:103], v[100:103]
    v_mfma_f32_16x16x32_bf16 v[132:135], a[132:135], a[104:107], v[132:135]
    ds_read_b128 a[124:127], v7 offset:2048
    v_accvgpr_write_b32 a35, 0
    v_mfma_f32_16x16x32_bf16 v[164:167], a[132:135], a[108:111], v[164:167]
    buffer_load_dwordx4 v249, s[16:19], s84 offen offset:1024 lds
    v_mfma_f32_16x16x32_bf16 v[72:75], a[136:139], a[96:99], v[72:75]
    ds_read_b64_tr_b16 a[160:161], v240 offset:40960
    v_accvgpr_write_b32 a36, 0
    v_mfma_f32_16x16x32_bf16 v[104:107], a[136:139], a[100:103], v[104:107]
    v_mfma_f32_16x16x32_bf16 v[136:139], a[136:139], a[104:107], v[136:139]
    ds_read_b64_tr_b16 a[162:163], v240 offset:41984
    v_accvgpr_write_b32 a37, 0
    v_mfma_f32_16x16x32_bf16 v[168:171], a[136:139], a[108:111], v[168:171]
    buffer_load_dwordx4 v250, s[16:19], s84 offen offset:2048 lds
    v_mfma_f32_16x16x32_bf16 v[76:79], a[140:143], a[96:99], v[76:79]
    ds_read_b64_tr_b16 a[164:165], v240 offset:40968
    v_accvgpr_write_b32 a38, 0
    v_mfma_f32_16x16x32_bf16 v[108:111], a[140:143], a[100:103], v[108:111]
    v_mfma_f32_16x16x32_bf16 v[140:143], a[140:143], a[104:107], v[140:143]
    ds_read_b64_tr_b16 a[166:167], v240 offset:41992
    v_accvgpr_write_b32 a39, 0
    v_mfma_f32_16x16x32_bf16 v[172:175], a[140:143], a[108:111], v[172:175]
    buffer_load_dwordx4 v251, s[16:19], s84 offen offset:3072 lds
    v_mfma_f32_16x16x32_bf16 v[80:83], a[144:147], a[96:99], v[80:83]
    ds_read_b64_tr_b16 a[168:169], v241 offset:40960
    v_mfma_f32_16x16x32_bf16 v[112:115], a[144:147], a[100:103], v[112:115]
    s_add_u32 m0, s86, 0
    s_add_u32 s84, s85, 704512
    v_mfma_f32_16x16x32_bf16 v[144:147], a[144:147], a[104:107], v[144:147]
    ds_read_b64_tr_b16 a[170:171], v241 offset:41984
    v_mfma_f32_16x16x32_bf16 v[176:179], a[144:147], a[108:111], v[176:179]
    buffer_load_dwordx4 v252, s[72:75], s84 offen offset:0 lds
    v_mfma_f32_16x16x32_bf16 v[84:87], a[148:151], a[96:99], v[84:87]
    ds_read_b64_tr_b16 a[172:173], v241 offset:40968
    v_mfma_f32_16x16x32_bf16 v[116:119], a[148:151], a[100:103], v[116:119]
    v_mfma_f32_16x16x32_bf16 v[148:151], a[148:151], a[104:107], v[148:151]
    ds_read_b64_tr_b16 a[174:175], v241 offset:41992
    v_mfma_f32_16x16x32_bf16 v[180:183], a[148:151], a[108:111], v[180:183]
    buffer_load_dwordx4 v253, s[72:75], s84 offen offset:1024 lds
    v_mfma_f32_16x16x32_bf16 v[88:91], a[152:155], a[96:99], v[88:91]
    ds_read_b64_tr_b16 a[176:177], v242 offset:40960
    v_mfma_f32_16x16x32_bf16 v[120:123], a[152:155], a[100:103], v[120:123]
    v_mfma_f32_16x16x32_bf16 v[152:155], a[152:155], a[104:107], v[152:155]
    ds_read_b64_tr_b16 a[178:179], v242 offset:41984
    v_mfma_f32_16x16x32_bf16 v[184:187], a[152:155], a[108:111], v[184:187]
    buffer_load_dwordx2 a[248:249], v51, s[68:71], s50 offen offset:0
    v_mfma_f32_16x16x32_bf16 v[92:95], a[156:159], a[96:99], v[92:95]
    ds_read_b64_tr_b16 a[180:181], v242 offset:40968
    ds_read_b64_tr_b16 a[182:183], v242 offset:41992
    v_mfma_f32_16x16x32_bf16 v[124:127], a[156:159], a[100:103], v[124:127]
    v_mfma_f32_16x16x32_bf16 v[156:159], a[156:159], a[104:107], v[156:159]
    ds_read_b64_tr_b16 a[184:185], v243 offset:40960
    ds_read_b64_tr_b16 a[186:187], v243 offset:41984
    s_waitcnt lgkmcnt(15)
    v_mfma_f32_16x16x32_bf16 v[188:191], a[156:159], a[108:111], v[188:191]
    buffer_load_dwordx2 a[250:251], v51, s[68:71], s50 offen offset:32
    v_mfma_f32_16x16x32_bf16 v[192:195], a[192:195], a[96:99], v[192:195]
    ds_read_b64_tr_b16 a[188:189], v243 offset:40968
    ds_read_b64_tr_b16 a[190:191], v243 offset:41992
    v_mfma_f32_16x16x32_bf16 v[200:203], a[192:195], a[100:103], v[200:203]
    v_mfma_f32_16x16x32_bf16 v[208:211], a[192:195], a[104:107], v[208:211]
    ds_read_b64_tr_b16 a[236:237], v8 offset:40960
    ds_read_b64_tr_b16 a[238:239], v8 offset:41984
    v_mfma_f32_16x16x32_bf16 v[216:219], a[192:195], a[108:111], v[216:219]
    buffer_load_dwordx2 a[252:253], v51, s[68:71], s51 offen offset:0
    v_mfma_f32_16x16x32_bf16 v[196:199], a[196:199], a[96:99], v[196:199]
    ds_read_b64_tr_b16 a[240:241], v8 offset:40968
    ds_read_b64_tr_b16 a[242:243], v8 offset:41992
    v_mfma_f32_16x16x32_bf16 v[204:207], a[196:199], a[100:103], v[204:207]
    v_mfma_f32_16x16x32_bf16 v[212:215], a[196:199], a[104:107], v[212:215]
    ds_read_b64_tr_b16 a[208:209], v244 offset:20480
    ds_read_b64_tr_b16 a[210:211], v244 offset:20992
    v_mfma_f32_16x16x32_bf16 v[220:223], a[196:199], a[108:111], v[220:223]
    buffer_load_dwordx2 a[254:255], v51, s[68:71], s51 offen offset:32
    v_mfma_f32_16x16x32_bf16 v[224:227], a[200:203], a[96:99], v[224:227]
    ds_read_b64_tr_b16 a[212:213], v245 offset:20480
    ds_read_b64_tr_b16 a[214:215], v245 offset:20992
    v_mfma_f32_16x16x32_bf16 v[232:235], a[200:203], a[100:103], v[232:235]
    v_mfma_f32_16x16x32_bf16 v[228:231], a[204:207], a[96:99], v[228:231]
    ds_read_b64_tr_b16 a[216:217], v246 offset:20480
    ds_read_b64_tr_b16 a[218:219], v246 offset:20992
    v_mfma_f32_16x16x32_bf16 v[236:239], a[204:207], a[100:103], v[236:239]
    v_mfma_f32_16x16x32_bf16 v[34:37], a[224:227], v[46:49], v[34:37]
    ds_read_b64_tr_b16 a[220:221], v247 offset:20480
    ds_read_b64_tr_b16 a[222:223], v247 offset:20992
    v_mfma_f32_16x16x32_bf16 v[38:41], a[228:231], v[46:49], v[38:41]
    v_mfma_f32_16x16x32_bf16 v[42:45], a[232:235], v[46:49], v[42:45]
    ds_read_b64_tr_b16 a[244:245], v254 offset:20480
    ds_read_b64_tr_b16 a[246:247], v254 offset:20992
    s_waitcnt vmcnt(10) lgkmcnt(10)
    s_barrier
    v_mfma_f32_16x16x32_bf16 v[64:67], a[160:163], a[112:115], v[64:67]
    ds_read_b128 a[96:99], v9 offset:32768
    v_accvgpr_write_b32 a40, 0
    v_mfma_f32_16x16x32_bf16 v[96:99], a[160:163], a[116:119], v[96:99]
    s_add_u32 m0, s61, 0
    s_add_u32 s62, s60, 512
    v_mfma_f32_16x16x32_bf16 v[128:131], a[160:163], a[120:123], v[128:131]
    ds_read_b128 a[100:103], v9 offset:34816
    v_accvgpr_write_b32 a41, 0
    v_mfma_f32_16x16x32_bf16 v[160:163], a[160:163], a[124:127], v[160:163]
    buffer_load_dwordx4 v12, s[20:23], s62 offen offset:0 lds
    v_mfma_f32_16x16x32_bf16 v[68:71], a[164:167], a[112:115], v[68:71]
    ds_read_b128 a[104:107], v10 offset:32768
    v_accvgpr_write_b32 a42, 0
    v_mfma_f32_16x16x32_bf16 v[100:103], a[164:167], a[116:119], v[100:103]
    v_mfma_f32_16x16x32_bf16 v[132:135], a[164:167], a[120:123], v[132:135]
    ds_read_b128 a[108:111], v10 offset:34816
    v_accvgpr_write_b32 a43, 0
    v_mfma_f32_16x16x32_bf16 v[164:167], a[164:167], a[124:127], v[164:167]
    buffer_load_dwordx4 v13, s[20:23], s62 offen offset:1024 lds
    v_mfma_f32_16x16x32_bf16 v[72:75], a[168:171], a[112:115], v[72:75]
    ds_read_b64_tr_b16 a[128:129], v240 offset:0
    v_accvgpr_write_b32 a44, 0
    v_mfma_f32_16x16x32_bf16 v[104:107], a[168:171], a[116:119], v[104:107]
    s_add_u32 m0, s61, 2048
    s_add_u32 s62, s60, 16896
    v_mfma_f32_16x16x32_bf16 v[136:139], a[168:171], a[120:123], v[136:139]
    ds_read_b64_tr_b16 a[130:131], v240 offset:1024
    v_accvgpr_write_b32 a45, 0
    v_mfma_f32_16x16x32_bf16 v[168:171], a[168:171], a[124:127], v[168:171]
    buffer_load_dwordx4 v12, s[20:23], s62 offen offset:0 lds
    v_mfma_f32_16x16x32_bf16 v[76:79], a[172:175], a[112:115], v[76:79]
    ds_read_b64_tr_b16 a[132:133], v240 offset:8
    v_accvgpr_write_b32 a46, 0
    v_mfma_f32_16x16x32_bf16 v[108:111], a[172:175], a[116:119], v[108:111]
    v_mfma_f32_16x16x32_bf16 v[140:143], a[172:175], a[120:123], v[140:143]
    ds_read_b64_tr_b16 a[134:135], v240 offset:1032
    v_accvgpr_write_b32 a47, 0
    v_mfma_f32_16x16x32_bf16 v[172:175], a[172:175], a[124:127], v[172:175]
    buffer_load_dwordx4 v13, s[20:23], s62 offen offset:1024 lds
    v_mfma_f32_16x16x32_bf16 v[80:83], a[176:179], a[112:115], v[80:83]
    ds_read_b64_tr_b16 a[136:137], v241 offset:0
    v_mfma_f32_16x16x32_bf16 v[112:115], a[176:179], a[116:119], v[112:115]
    s_add_u32 m0, s61, 4096
    s_add_u32 s62, s60, 33280
    v_mfma_f32_16x16x32_bf16 v[144:147], a[176:179], a[120:123], v[144:147]
    ds_read_b64_tr_b16 a[138:139], v241 offset:1024
    v_mfma_f32_16x16x32_bf16 v[176:179], a[176:179], a[124:127], v[176:179]
    buffer_load_dwordx4 v12, s[20:23], s62 offen offset:0 lds
    v_mfma_f32_16x16x32_bf16 v[84:87], a[180:183], a[112:115], v[84:87]
    ds_read_b64_tr_b16 a[140:141], v241 offset:8
    v_mfma_f32_16x16x32_bf16 v[116:119], a[180:183], a[116:119], v[116:119]
    v_mfma_f32_16x16x32_bf16 v[148:151], a[180:183], a[120:123], v[148:151]
    ds_read_b64_tr_b16 a[142:143], v241 offset:1032
    v_mfma_f32_16x16x32_bf16 v[180:183], a[180:183], a[124:127], v[180:183]
    buffer_load_dwordx4 v13, s[20:23], s62 offen offset:1024 lds
    v_mfma_f32_16x16x32_bf16 v[88:91], a[184:187], a[112:115], v[88:91]
    ds_read_b64_tr_b16 a[144:145], v242 offset:0
    v_mfma_f32_16x16x32_bf16 v[120:123], a[184:187], a[116:119], v[120:123]
    s_add_u32 m0, s61, 6144
    s_add_u32 s62, s60, 49664
    v_mfma_f32_16x16x32_bf16 v[152:155], a[184:187], a[120:123], v[152:155]
    ds_read_b64_tr_b16 a[146:147], v242 offset:1024
    v_mfma_f32_16x16x32_bf16 v[184:187], a[184:187], a[124:127], v[184:187]
    buffer_load_dwordx4 v12, s[20:23], s62 offen offset:0 lds
    v_mfma_f32_16x16x32_bf16 v[92:95], a[188:191], a[112:115], v[92:95]
    ds_read_b64_tr_b16 a[148:149], v242 offset:8
    ds_read_b64_tr_b16 a[150:151], v242 offset:1032
    v_mfma_f32_16x16x32_bf16 v[124:127], a[188:191], a[116:119], v[124:127]
    v_mfma_f32_16x16x32_bf16 v[156:159], a[188:191], a[120:123], v[156:159]
    ds_read_b64_tr_b16 a[152:153], v243 offset:0
    ds_read_b64_tr_b16 a[154:155], v243 offset:1024
    s_waitcnt lgkmcnt(15)
    v_mfma_f32_16x16x32_bf16 v[188:191], a[188:191], a[124:127], v[188:191]
    buffer_load_dwordx4 v13, s[20:23], s62 offen offset:1024 lds
    v_mfma_f32_16x16x32_bf16 v[192:195], a[208:211], a[112:115], v[192:195]
    ds_read_b64_tr_b16 a[156:157], v243 offset:8
    ds_read_b64_tr_b16 a[158:159], v243 offset:1032
    v_mfma_f32_16x16x32_bf16 v[200:203], a[208:211], a[116:119], v[200:203]
    v_mfma_f32_16x16x32_bf16 v[208:211], a[208:211], a[120:123], v[208:211]
    ds_read_b64_tr_b16 a[224:225], v8 offset:0
    ds_read_b64_tr_b16 a[226:227], v8 offset:1024
    v_mfma_f32_16x16x32_bf16 v[216:219], a[208:211], a[124:127], v[216:219]
    v_mfma_f32_16x16x32_bf16 v[196:199], a[212:215], a[112:115], v[196:199]
    ds_read_b64_tr_b16 a[228:229], v8 offset:8
    ds_read_b64_tr_b16 a[230:231], v8 offset:1032
    v_mfma_f32_16x16x32_bf16 v[204:207], a[212:215], a[116:119], v[204:207]
    v_mfma_f32_16x16x32_bf16 v[212:215], a[212:215], a[120:123], v[212:215]
    ds_read_b64_tr_b16 a[192:193], v244 offset:24576
    ds_read_b64_tr_b16 a[194:195], v244 offset:25088
    v_mfma_f32_16x16x32_bf16 v[220:223], a[212:215], a[124:127], v[220:223]
    v_mfma_f32_16x16x32_bf16 v[224:227], a[216:219], a[112:115], v[224:227]
    ds_read_b64_tr_b16 a[196:197], v245 offset:24576
    ds_read_b64_tr_b16 a[198:199], v245 offset:25088
    v_mfma_f32_16x16x32_bf16 v[232:235], a[216:219], a[116:119], v[232:235]
    v_mfma_f32_16x16x32_bf16 v[228:231], a[220:223], a[112:115], v[228:231]
    ds_read_b64_tr_b16 a[200:201], v246 offset:24576
    ds_read_b64_tr_b16 a[202:203], v246 offset:25088
    v_mfma_f32_16x16x32_bf16 v[236:239], a[220:223], a[116:119], v[236:239]
    v_mfma_f32_16x16x32_bf16 v[34:37], a[236:239], v[46:49], v[34:37]
    ds_read_b64_tr_b16 a[204:205], v247 offset:24576
    ds_read_b64_tr_b16 a[206:207], v247 offset:25088
    v_mfma_f32_16x16x32_bf16 v[38:41], a[240:243], v[46:49], v[38:41]
    v_mfma_f32_16x16x32_bf16 v[42:45], a[244:247], v[46:49], v[42:45]
    ds_read_b64_tr_b16 a[232:233], v254 offset:24576
    ds_read_b64_tr_b16 a[234:235], v254 offset:25088
    s_waitcnt lgkmcnt(10)
    v_mfma_f32_16x16x32_bf16 v[64:67], a[128:131], a[96:99], v[64:67]
    ds_read_b128 a[112:115], v11 offset:32768
    v_accvgpr_write_b32 a48, 0
    v_mfma_f32_16x16x32_bf16 v[96:99], a[128:131], a[100:103], v[96:99]
    s_add_u32 m0, s33, 114688
    s_add_u32 s84, s83, 2621440
    v_mfma_f32_16x16x32_bf16 v[128:131], a[128:131], a[104:107], v[128:131]
    ds_read_b128 a[116:119], v11 offset:34816
    v_accvgpr_write_b32 a49, 0
    v_mfma_f32_16x16x32_bf16 v[160:163], a[128:131], a[108:111], v[160:163]
    buffer_load_dwordx4 v248, s[16:19], s84 offen offset:0 lds
    v_mfma_f32_16x16x32_bf16 v[68:71], a[132:135], a[96:99], v[68:71]
    ds_read_b128 a[120:123], v7 offset:32768
    v_accvgpr_write_b32 a50, 0
    v_mfma_f32_16x16x32_bf16 v[100:103], a[132:135], a[100:103], v[100:103]
    v_mfma_f32_16x16x32_bf16 v[132:135], a[132:135], a[104:107], v[132:135]
    ds_read_b128 a[124:127], v7 offset:34816
    v_accvgpr_write_b32 a51, 0
    v_mfma_f32_16x16x32_bf16 v[164:167], a[132:135], a[108:111], v[164:167]
    buffer_load_dwordx4 v249, s[16:19], s84 offen offset:1024 lds
    v_mfma_f32_16x16x32_bf16 v[72:75], a[136:139], a[96:99], v[72:75]
    ds_read_b64_tr_b16 a[160:161], v240 offset:8192
    v_accvgpr_write_b32 a52, 0
    v_mfma_f32_16x16x32_bf16 v[104:107], a[136:139], a[100:103], v[104:107]
    v_mfma_f32_16x16x32_bf16 v[136:139], a[136:139], a[104:107], v[136:139]
    ds_read_b64_tr_b16 a[162:163], v240 offset:9216
    v_accvgpr_write_b32 a53, 0
    v_mfma_f32_16x16x32_bf16 v[168:171], a[136:139], a[108:111], v[168:171]
    buffer_load_dwordx4 v250, s[16:19], s84 offen offset:2048 lds
    v_mfma_f32_16x16x32_bf16 v[76:79], a[140:143], a[96:99], v[76:79]
    ds_read_b64_tr_b16 a[164:165], v240 offset:8200
    v_accvgpr_write_b32 a54, 0
    v_mfma_f32_16x16x32_bf16 v[108:111], a[140:143], a[100:103], v[108:111]
    v_mfma_f32_16x16x32_bf16 v[140:143], a[140:143], a[104:107], v[140:143]
    ds_read_b64_tr_b16 a[166:167], v240 offset:9224
    v_accvgpr_write_b32 a55, 0
    v_mfma_f32_16x16x32_bf16 v[172:175], a[140:143], a[108:111], v[172:175]
    buffer_load_dwordx4 v251, s[16:19], s84 offen offset:3072 lds
    v_mfma_f32_16x16x32_bf16 v[80:83], a[144:147], a[96:99], v[80:83]
    ds_read_b64_tr_b16 a[168:169], v241 offset:8192
    v_mfma_f32_16x16x32_bf16 v[112:115], a[144:147], a[100:103], v[112:115]
    s_add_u32 m0, s86, 8192
    s_add_u32 s84, s85, 880640
    v_mfma_f32_16x16x32_bf16 v[144:147], a[144:147], a[104:107], v[144:147]
    ds_read_b64_tr_b16 a[170:171], v241 offset:9216
    v_mfma_f32_16x16x32_bf16 v[176:179], a[144:147], a[108:111], v[176:179]
    buffer_load_dwordx4 v252, s[72:75], s84 offen offset:0 lds
    v_mfma_f32_16x16x32_bf16 v[84:87], a[148:151], a[96:99], v[84:87]
    ds_read_b64_tr_b16 a[172:173], v241 offset:8200
    v_mfma_f32_16x16x32_bf16 v[116:119], a[148:151], a[100:103], v[116:119]
    v_mfma_f32_16x16x32_bf16 v[148:151], a[148:151], a[104:107], v[148:151]
    ds_read_b64_tr_b16 a[174:175], v241 offset:9224
    v_mfma_f32_16x16x32_bf16 v[180:183], a[148:151], a[108:111], v[180:183]
    buffer_load_dwordx4 v253, s[72:75], s84 offen offset:1024 lds
    v_mfma_f32_16x16x32_bf16 v[88:91], a[152:155], a[96:99], v[88:91]
    ds_read_b64_tr_b16 a[176:177], v242 offset:8192
    v_mfma_f32_16x16x32_bf16 v[120:123], a[152:155], a[100:103], v[120:123]
    v_mfma_f32_16x16x32_bf16 v[152:155], a[152:155], a[104:107], v[152:155]
    ds_read_b64_tr_b16 a[178:179], v242 offset:9216
    v_mfma_f32_16x16x32_bf16 v[184:187], a[152:155], a[108:111], v[184:187]
    v_mfma_f32_16x16x32_bf16 v[92:95], a[156:159], a[96:99], v[92:95]
    ds_read_b64_tr_b16 a[180:181], v242 offset:8200
    ds_read_b64_tr_b16 a[182:183], v242 offset:9224
    v_mfma_f32_16x16x32_bf16 v[124:127], a[156:159], a[100:103], v[124:127]
    v_mfma_f32_16x16x32_bf16 v[156:159], a[156:159], a[104:107], v[156:159]
    ds_read_b64_tr_b16 a[184:185], v243 offset:8192
    ds_read_b64_tr_b16 a[186:187], v243 offset:9216
    s_waitcnt lgkmcnt(15)
    v_mfma_f32_16x16x32_bf16 v[188:191], a[156:159], a[108:111], v[188:191]
    v_mfma_f32_16x16x32_bf16 v[192:195], a[192:195], a[96:99], v[192:195]
    ds_read_b64_tr_b16 a[188:189], v243 offset:8200
    ds_read_b64_tr_b16 a[190:191], v243 offset:9224
    v_mfma_f32_16x16x32_bf16 v[200:203], a[192:195], a[100:103], v[200:203]
    v_mfma_f32_16x16x32_bf16 v[208:211], a[192:195], a[104:107], v[208:211]
    ds_read_b64_tr_b16 a[236:237], v8 offset:8192
    ds_read_b64_tr_b16 a[238:239], v8 offset:9216
    v_mfma_f32_16x16x32_bf16 v[216:219], a[192:195], a[108:111], v[216:219]
    v_mfma_f32_16x16x32_bf16 v[196:199], a[196:199], a[96:99], v[196:199]
    ds_read_b64_tr_b16 a[240:241], v8 offset:8200
    ds_read_b64_tr_b16 a[242:243], v8 offset:9224
    v_mfma_f32_16x16x32_bf16 v[204:207], a[196:199], a[100:103], v[204:207]
    v_mfma_f32_16x16x32_bf16 v[212:215], a[196:199], a[104:107], v[212:215]
    ds_read_b64_tr_b16 a[208:209], v244 offset:28672
    ds_read_b64_tr_b16 a[210:211], v244 offset:29184
    v_mfma_f32_16x16x32_bf16 v[220:223], a[196:199], a[108:111], v[220:223]
    v_mfma_f32_16x16x32_bf16 v[224:227], a[200:203], a[96:99], v[224:227]
    ds_read_b64_tr_b16 a[212:213], v245 offset:28672
    ds_read_b64_tr_b16 a[214:215], v245 offset:29184
    v_mfma_f32_16x16x32_bf16 v[232:235], a[200:203], a[100:103], v[232:235]
    v_mfma_f32_16x16x32_bf16 v[228:231], a[204:207], a[96:99], v[228:231]
    ds_read_b64_tr_b16 a[216:217], v246 offset:28672
    ds_read_b64_tr_b16 a[218:219], v246 offset:29184
    v_mfma_f32_16x16x32_bf16 v[236:239], a[204:207], a[100:103], v[236:239]
    v_mfma_f32_16x16x32_bf16 v[34:37], a[224:227], v[46:49], v[34:37]
    ds_read_b64_tr_b16 a[220:221], v247 offset:28672
    ds_read_b64_tr_b16 a[222:223], v247 offset:29184
    v_mfma_f32_16x16x32_bf16 v[38:41], a[228:231], v[46:49], v[38:41]
    v_mfma_f32_16x16x32_bf16 v[42:45], a[232:235], v[46:49], v[42:45]
    ds_read_b64_tr_b16 a[244:245], v254 offset:28672
    ds_read_b64_tr_b16 a[246:247], v254 offset:29184
    s_waitcnt vmcnt(6) lgkmcnt(10)
    s_barrier
    v_mfma_f32_16x16x32_bf16 v[64:67], a[160:163], a[112:115], v[64:67]
    ds_read_b128 a[96:99], v9 offset:0
    v_accvgpr_write_b32 a56, 0
    v_mfma_f32_16x16x32_bf16 v[96:99], a[160:163], a[116:119], v[96:99]
    s_add_u32 m0, s61, 32768
    s_add_u32 s62, s60, 640
    v_mfma_f32_16x16x32_bf16 v[128:131], a[160:163], a[120:123], v[128:131]
    ds_read_b128 a[100:103], v9 offset:2048
    v_accvgpr_write_b32 a57, 0
    v_mfma_f32_16x16x32_bf16 v[160:163], a[160:163], a[124:127], v[160:163]
    buffer_load_dwordx4 v12, s[20:23], s62 offen offset:0 lds
    v_mfma_f32_16x16x32_bf16 v[68:71], a[164:167], a[112:115], v[68:71]
    ds_read_b128 a[104:107], v10 offset:0
    v_accvgpr_write_b32 a58, 0
    v_mfma_f32_16x16x32_bf16 v[100:103], a[164:167], a[116:119], v[100:103]
    v_mfma_f32_16x16x32_bf16 v[132:135], a[164:167], a[120:123], v[132:135]
    ds_read_b128 a[108:111], v10 offset:2048
    v_accvgpr_write_b32 a59, 0
    v_mfma_f32_16x16x32_bf16 v[164:167], a[164:167], a[124:127], v[164:167]
    buffer_load_dwordx4 v13, s[20:23], s62 offen offset:1024 lds
    v_mfma_f32_16x16x32_bf16 v[72:75], a[168:171], a[112:115], v[72:75]
    ds_read_b64_tr_b16 a[128:129], v240 offset:16384
    v_accvgpr_write_b32 a60, 0
    v_mfma_f32_16x16x32_bf16 v[104:107], a[168:171], a[116:119], v[104:107]
    s_add_u32 m0, s61, 34816
    s_add_u32 s62, s60, 17024
    v_mfma_f32_16x16x32_bf16 v[136:139], a[168:171], a[120:123], v[136:139]
    ds_read_b64_tr_b16 a[130:131], v240 offset:17408
    v_accvgpr_write_b32 a61, 0
    v_mfma_f32_16x16x32_bf16 v[168:171], a[168:171], a[124:127], v[168:171]
    buffer_load_dwordx4 v12, s[20:23], s62 offen offset:0 lds
    v_mfma_f32_16x16x32_bf16 v[76:79], a[172:175], a[112:115], v[76:79]
    ds_read_b64_tr_b16 a[132:133], v240 offset:16392
    v_accvgpr_write_b32 a62, 0
    v_mfma_f32_16x16x32_bf16 v[108:111], a[172:175], a[116:119], v[108:111]
    v_mfma_f32_16x16x32_bf16 v[140:143], a[172:175], a[120:123], v[140:143]
    ds_read_b64_tr_b16 a[134:135], v240 offset:17416
    v_accvgpr_write_b32 a63, 0
    v_mfma_f32_16x16x32_bf16 v[172:175], a[172:175], a[124:127], v[172:175]
    buffer_load_dwordx4 v13, s[20:23], s62 offen offset:1024 lds
    v_mfma_f32_16x16x32_bf16 v[80:83], a[176:179], a[112:115], v[80:83]
    ds_read_b64_tr_b16 a[136:137], v241 offset:16384
    v_mfma_f32_16x16x32_bf16 v[112:115], a[176:179], a[116:119], v[112:115]
    s_add_u32 m0, s61, 36864
    s_add_u32 s62, s60, 33408
    v_mfma_f32_16x16x32_bf16 v[144:147], a[176:179], a[120:123], v[144:147]
    ds_read_b64_tr_b16 a[138:139], v241 offset:17408
    v_mfma_f32_16x16x32_bf16 v[176:179], a[176:179], a[124:127], v[176:179]
    buffer_load_dwordx4 v12, s[20:23], s62 offen offset:0 lds
    v_mfma_f32_16x16x32_bf16 v[84:87], a[180:183], a[112:115], v[84:87]
    ds_read_b64_tr_b16 a[140:141], v241 offset:16392
    v_mfma_f32_16x16x32_bf16 v[116:119], a[180:183], a[116:119], v[116:119]
    v_mfma_f32_16x16x32_bf16 v[148:151], a[180:183], a[120:123], v[148:151]
    ds_read_b64_tr_b16 a[142:143], v241 offset:17416
    v_mfma_f32_16x16x32_bf16 v[180:183], a[180:183], a[124:127], v[180:183]
    buffer_load_dwordx4 v13, s[20:23], s62 offen offset:1024 lds
    v_mfma_f32_16x16x32_bf16 v[88:91], a[184:187], a[112:115], v[88:91]
    ds_read_b64_tr_b16 a[144:145], v242 offset:16384
    v_mfma_f32_16x16x32_bf16 v[120:123], a[184:187], a[116:119], v[120:123]
    s_add_u32 m0, s61, 38912
    s_add_u32 s62, s60, 49792
    v_mfma_f32_16x16x32_bf16 v[152:155], a[184:187], a[120:123], v[152:155]
    ds_read_b64_tr_b16 a[146:147], v242 offset:17408
    v_mfma_f32_16x16x32_bf16 v[184:187], a[184:187], a[124:127], v[184:187]
    buffer_load_dwordx4 v12, s[20:23], s62 offen offset:0 lds
    v_mfma_f32_16x16x32_bf16 v[92:95], a[188:191], a[112:115], v[92:95]
    ds_read_b64_tr_b16 a[148:149], v242 offset:16392
    ds_read_b64_tr_b16 a[150:151], v242 offset:17416
    v_mfma_f32_16x16x32_bf16 v[124:127], a[188:191], a[116:119], v[124:127]
    v_mfma_f32_16x16x32_bf16 v[156:159], a[188:191], a[120:123], v[156:159]
    ds_read_b64_tr_b16 a[152:153], v243 offset:16384
    ds_read_b64_tr_b16 a[154:155], v243 offset:17408
    s_waitcnt lgkmcnt(15)
    v_mfma_f32_16x16x32_bf16 v[188:191], a[188:191], a[124:127], v[188:191]
    buffer_load_dwordx4 v13, s[20:23], s62 offen offset:1024 lds
    v_mfma_f32_16x16x32_bf16 v[192:195], a[208:211], a[112:115], v[192:195]
    ds_read_b64_tr_b16 a[156:157], v243 offset:16392
    ds_read_b64_tr_b16 a[158:159], v243 offset:17416
    v_mfma_f32_16x16x32_bf16 v[200:203], a[208:211], a[116:119], v[200:203]
    v_mfma_f32_16x16x32_bf16 v[208:211], a[208:211], a[120:123], v[208:211]
    ds_read_b64_tr_b16 a[224:225], v8 offset:16384
    ds_read_b64_tr_b16 a[226:227], v8 offset:17408
    v_mfma_f32_16x16x32_bf16 v[216:219], a[208:211], a[124:127], v[216:219]
    v_mfma_f32_16x16x32_bf16 v[196:199], a[212:215], a[112:115], v[196:199]
    ds_read_b64_tr_b16 a[228:229], v8 offset:16392
    ds_read_b64_tr_b16 a[230:231], v8 offset:17416
    v_mfma_f32_16x16x32_bf16 v[204:207], a[212:215], a[116:119], v[204:207]
    v_mfma_f32_16x16x32_bf16 v[212:215], a[212:215], a[120:123], v[212:215]
    ds_read_b64_tr_b16 a[192:193], v244 offset:0
    ds_read_b64_tr_b16 a[194:195], v244 offset:512
    v_mfma_f32_16x16x32_bf16 v[220:223], a[212:215], a[124:127], v[220:223]
    v_mfma_f32_16x16x32_bf16 v[224:227], a[216:219], a[112:115], v[224:227]
    ds_read_b64_tr_b16 a[196:197], v245 offset:0
    ds_read_b64_tr_b16 a[198:199], v245 offset:512
    v_mfma_f32_16x16x32_bf16 v[232:235], a[216:219], a[116:119], v[232:235]
    v_mfma_f32_16x16x32_bf16 v[228:231], a[220:223], a[112:115], v[228:231]
    ds_read_b64_tr_b16 a[200:201], v246 offset:0
    ds_read_b64_tr_b16 a[202:203], v246 offset:512
    v_mfma_f32_16x16x32_bf16 v[236:239], a[220:223], a[116:119], v[236:239]
    v_mfma_f32_16x16x32_bf16 v[34:37], a[236:239], v[46:49], v[34:37]
    ds_read_b64_tr_b16 a[204:205], v247 offset:0
    ds_read_b64_tr_b16 a[206:207], v247 offset:512
    v_mfma_f32_16x16x32_bf16 v[38:41], a[240:243], v[46:49], v[38:41]
    v_mfma_f32_16x16x32_bf16 v[42:45], a[244:247], v[46:49], v[42:45]
    ds_read_b64_tr_b16 a[232:233], v254 offset:0
    ds_read_b64_tr_b16 a[234:235], v254 offset:512
    s_waitcnt lgkmcnt(10)
    v_mfma_f32_16x16x32_bf16 v[64:67], a[128:131], a[96:99], v[64:67]
    ds_read_b128 a[112:115], v11 offset:0
    v_accvgpr_write_b32 a64, 0
    v_mfma_f32_16x16x32_bf16 v[96:99], a[128:131], a[100:103], v[96:99]
    s_add_u32 m0, s33, 81920
    s_add_u32 s84, s83, 3145728
    v_mfma_f32_16x16x32_bf16 v[128:131], a[128:131], a[104:107], v[128:131]
    ds_read_b128 a[116:119], v11 offset:2048
    v_accvgpr_write_b32 a65, 0
    v_mfma_f32_16x16x32_bf16 v[160:163], a[128:131], a[108:111], v[160:163]
    buffer_load_dwordx4 v248, s[16:19], s84 offen offset:0 lds
    v_mfma_f32_16x16x32_bf16 v[68:71], a[132:135], a[96:99], v[68:71]
    ds_read_b128 a[120:123], v7 offset:0
    v_accvgpr_write_b32 a66, 0
    v_mfma_f32_16x16x32_bf16 v[100:103], a[132:135], a[100:103], v[100:103]
    v_mfma_f32_16x16x32_bf16 v[132:135], a[132:135], a[104:107], v[132:135]
    ds_read_b128 a[124:127], v7 offset:2048
    v_accvgpr_write_b32 a67, 0
    v_mfma_f32_16x16x32_bf16 v[164:167], a[132:135], a[108:111], v[164:167]
    buffer_load_dwordx4 v249, s[16:19], s84 offen offset:1024 lds
    v_mfma_f32_16x16x32_bf16 v[72:75], a[136:139], a[96:99], v[72:75]
    ds_read_b64_tr_b16 a[160:161], v240 offset:24576
    v_accvgpr_write_b32 a68, 0
    v_mfma_f32_16x16x32_bf16 v[104:107], a[136:139], a[100:103], v[104:107]
    v_mfma_f32_16x16x32_bf16 v[136:139], a[136:139], a[104:107], v[136:139]
    ds_read_b64_tr_b16 a[162:163], v240 offset:25600
    v_accvgpr_write_b32 a69, 0
    v_mfma_f32_16x16x32_bf16 v[168:171], a[136:139], a[108:111], v[168:171]
    buffer_load_dwordx4 v250, s[16:19], s84 offen offset:2048 lds
    v_mfma_f32_16x16x32_bf16 v[76:79], a[140:143], a[96:99], v[76:79]
    ds_read_b64_tr_b16 a[164:165], v240 offset:24584
    v_accvgpr_write_b32 a70, 0
    v_mfma_f32_16x16x32_bf16 v[108:111], a[140:143], a[100:103], v[108:111]
    v_mfma_f32_16x16x32_bf16 v[140:143], a[140:143], a[104:107], v[140:143]
    ds_read_b64_tr_b16 a[166:167], v240 offset:25608
    v_accvgpr_write_b32 a71, 0
    v_mfma_f32_16x16x32_bf16 v[172:175], a[140:143], a[108:111], v[172:175]
    buffer_load_dwordx4 v251, s[16:19], s84 offen offset:3072 lds
    v_mfma_f32_16x16x32_bf16 v[80:83], a[144:147], a[96:99], v[80:83]
    ds_read_b64_tr_b16 a[168:169], v241 offset:24576
    v_mfma_f32_16x16x32_bf16 v[112:115], a[144:147], a[100:103], v[112:115]
    s_add_u32 m0, s86, 16384
    s_add_u32 s84, s85, 1056768
    v_mfma_f32_16x16x32_bf16 v[144:147], a[144:147], a[104:107], v[144:147]
    ds_read_b64_tr_b16 a[170:171], v241 offset:25600
    v_mfma_f32_16x16x32_bf16 v[176:179], a[144:147], a[108:111], v[176:179]
    buffer_load_dwordx4 v252, s[72:75], s84 offen offset:0 lds
    v_mfma_f32_16x16x32_bf16 v[84:87], a[148:151], a[96:99], v[84:87]
    ds_read_b64_tr_b16 a[172:173], v241 offset:24584
    v_mfma_f32_16x16x32_bf16 v[116:119], a[148:151], a[100:103], v[116:119]
    v_mfma_f32_16x16x32_bf16 v[148:151], a[148:151], a[104:107], v[148:151]
    ds_read_b64_tr_b16 a[174:175], v241 offset:25608
    v_mfma_f32_16x16x32_bf16 v[180:183], a[148:151], a[108:111], v[180:183]
    buffer_load_dwordx4 v253, s[72:75], s84 offen offset:1024 lds
    v_mfma_f32_16x16x32_bf16 v[88:91], a[152:155], a[96:99], v[88:91]
    ds_read_b64_tr_b16 a[176:177], v242 offset:24576
    v_mfma_f32_16x16x32_bf16 v[120:123], a[152:155], a[100:103], v[120:123]
    v_mfma_f32_16x16x32_bf16 v[152:155], a[152:155], a[104:107], v[152:155]
    ds_read_b64_tr_b16 a[178:179], v242 offset:25600
    v_mfma_f32_16x16x32_bf16 v[184:187], a[152:155], a[108:111], v[184:187]
    v_mfma_f32_16x16x32_bf16 v[92:95], a[156:159], a[96:99], v[92:95]
    ds_read_b64_tr_b16 a[180:181], v242 offset:24584
    ds_read_b64_tr_b16 a[182:183], v242 offset:25608
    v_mfma_f32_16x16x32_bf16 v[124:127], a[156:159], a[100:103], v[124:127]
    v_mfma_f32_16x16x32_bf16 v[156:159], a[156:159], a[104:107], v[156:159]
    ds_read_b64_tr_b16 a[184:185], v243 offset:24576
    ds_read_b64_tr_b16 a[186:187], v243 offset:25600
    s_waitcnt lgkmcnt(15)
    v_mfma_f32_16x16x32_bf16 v[188:191], a[156:159], a[108:111], v[188:191]
    v_mfma_f32_16x16x32_bf16 v[192:195], a[192:195], a[96:99], v[192:195]
    ds_read_b64_tr_b16 a[188:189], v243 offset:24584
    ds_read_b64_tr_b16 a[190:191], v243 offset:25608
    v_mfma_f32_16x16x32_bf16 v[200:203], a[192:195], a[100:103], v[200:203]
    v_mfma_f32_16x16x32_bf16 v[208:211], a[192:195], a[104:107], v[208:211]
    ds_read_b64_tr_b16 a[236:237], v8 offset:24576
    ds_read_b64_tr_b16 a[238:239], v8 offset:25600
    v_mfma_f32_16x16x32_bf16 v[216:219], a[192:195], a[108:111], v[216:219]
    v_mfma_f32_16x16x32_bf16 v[196:199], a[196:199], a[96:99], v[196:199]
    ds_read_b64_tr_b16 a[240:241], v8 offset:24584
    ds_read_b64_tr_b16 a[242:243], v8 offset:25608
    v_mfma_f32_16x16x32_bf16 v[204:207], a[196:199], a[100:103], v[204:207]
    v_mfma_f32_16x16x32_bf16 v[212:215], a[196:199], a[104:107], v[212:215]
    ds_read_b64_tr_b16 a[208:209], v244 offset:4096
    ds_read_b64_tr_b16 a[210:211], v244 offset:4608
    v_mfma_f32_16x16x32_bf16 v[220:223], a[196:199], a[108:111], v[220:223]
    v_mfma_f32_16x16x32_bf16 v[224:227], a[200:203], a[96:99], v[224:227]
    ds_read_b64_tr_b16 a[212:213], v245 offset:4096
    ds_read_b64_tr_b16 a[214:215], v245 offset:4608
    v_mfma_f32_16x16x32_bf16 v[232:235], a[200:203], a[100:103], v[232:235]
    v_mfma_f32_16x16x32_bf16 v[228:231], a[204:207], a[96:99], v[228:231]
    ds_read_b64_tr_b16 a[216:217], v246 offset:4096
    ds_read_b64_tr_b16 a[218:219], v246 offset:4608
    v_mfma_f32_16x16x32_bf16 v[236:239], a[204:207], a[100:103], v[236:239]
    v_mfma_f32_16x16x32_bf16 v[34:37], a[224:227], v[46:49], v[34:37]
    ds_read_b64_tr_b16 a[220:221], v247 offset:4096
    ds_read_b64_tr_b16 a[222:223], v247 offset:4608
    v_mfma_f32_16x16x32_bf16 v[38:41], a[228:231], v[46:49], v[38:41]
    v_mfma_f32_16x16x32_bf16 v[42:45], a[232:235], v[46:49], v[42:45]
    ds_read_b64_tr_b16 a[244:245], v254 offset:4096
    ds_read_b64_tr_b16 a[246:247], v254 offset:4608
    s_waitcnt vmcnt(6) lgkmcnt(10)
    s_barrier
    s_cmp_lg_u32 s28, 3
    s_cbranch_scc1 attn_nopoll
    buffer_load_dwordx2 v[14:15], v1, s[92:95], s87 offen sc1
attn_nopoll:
    v_mfma_f32_16x16x32_bf16 v[64:67], a[160:163], a[112:115], v[64:67]
    ds_read_b128 a[96:99], v9 offset:32768
    v_accvgpr_write_b32 a72, 0
    v_mfma_f32_16x16x32_bf16 v[96:99], a[160:163], a[116:119], v[96:99]
    s_add_u32 m0, s61, 0
    s_add_u32 s62, s60, 768
    v_mfma_f32_16x16x32_bf16 v[128:131], a[160:163], a[120:123], v[128:131]
    ds_read_b128 a[100:103], v9 offset:34816
    v_accvgpr_write_b32 a73, 0
    v_mfma_f32_16x16x32_bf16 v[160:163], a[160:163], a[124:127], v[160:163]
    buffer_load_dwordx4 v12, s[20:23], s62 offen offset:0 lds
    v_mfma_f32_16x16x32_bf16 v[68:71], a[164:167], a[112:115], v[68:71]
    ds_read_b128 a[104:107], v10 offset:32768
    v_accvgpr_write_b32 a74, 0
    v_mfma_f32_16x16x32_bf16 v[100:103], a[164:167], a[116:119], v[100:103]
    v_mfma_f32_16x16x32_bf16 v[132:135], a[164:167], a[120:123], v[132:135]
    ds_read_b128 a[108:111], v10 offset:34816
    v_accvgpr_write_b32 a75, 0
    v_mfma_f32_16x16x32_bf16 v[164:167], a[164:167], a[124:127], v[164:167]
    buffer_load_dwordx4 v13, s[20:23], s62 offen offset:1024 lds
    v_mfma_f32_16x16x32_bf16 v[72:75], a[168:171], a[112:115], v[72:75]
    ds_read_b64_tr_b16 a[128:129], v240 offset:32768
    v_accvgpr_write_b32 a76, 0
    v_mfma_f32_16x16x32_bf16 v[104:107], a[168:171], a[116:119], v[104:107]
    s_add_u32 m0, s61, 2048
    s_add_u32 s62, s60, 17152
    v_mfma_f32_16x16x32_bf16 v[136:139], a[168:171], a[120:123], v[136:139]
    ds_read_b64_tr_b16 a[130:131], v240 offset:33792
    v_accvgpr_write_b32 a77, 0
    v_mfma_f32_16x16x32_bf16 v[168:171], a[168:171], a[124:127], v[168:171]
    buffer_load_dwordx4 v12, s[20:23], s62 offen offset:0 lds
    v_mfma_f32_16x16x32_bf16 v[76:79], a[172:175], a[112:115], v[76:79]
    ds_read_b64_tr_b16 a[132:133], v240 offset:32776
    v_accvgpr_write_b32 a78, 0
    v_mfma_f32_16x16x32_bf16 v[108:111], a[172:175], a[116:119], v[108:111]
    v_mfma_f32_16x16x32_bf16 v[140:143], a[172:175], a[120:123], v[140:143]
    ds_read_b64_tr_b16 a[134:135], v240 offset:33800
    v_accvgpr_write_b32 a79, 0
    v_mfma_f32_16x16x32_bf16 v[172:175], a[172:175], a[124:127], v[172:175]
    buffer_load_dwordx4 v13, s[20:23], s62 offen offset:1024 lds
    v_mfma_f32_16x16x32_bf16 v[80:83], a[176:179], a[112:115], v[80:83]
    ds_read_b64_tr_b16 a[136:137], v241 offset:32768
    v_mfma_f32_16x16x32_bf16 v[112:115], a[176:179], a[116:119], v[112:115]
    s_add_u32 m0, s61, 4096
    s_add_u32 s62, s60, 33536
    v_mfma_f32_16x16x32_bf16 v[144:147], a[176:179], a[120:123], v[144:147]
    ds_read_b64_tr_b16 a[138:139], v241 offset:33792
    v_mfma_f32_16x16x32_bf16 v[176:179], a[176:179], a[124:127], v[176:179]
    buffer_load_dwordx4 v12, s[20:23], s62 offen offset:0 lds
    v_mfma_f32_16x16x32_bf16 v[84:87], a[180:183], a[112:115], v[84:87]
    ds_read_b64_tr_b16 a[140:141], v241 offset:32776
    v_mfma_f32_16x16x32_bf16 v[116:119], a[180:183], a[116:119], v[116:119]
    v_mfma_f32_16x16x32_bf16 v[148:151], a[180:183], a[120:123], v[148:151]
    ds_read_b64_tr_b16 a[142:143], v241 offset:33800
    v_mfma_f32_16x16x32_bf16 v[180:183], a[180:183], a[124:127], v[180:183]
    buffer_load_dwordx4 v13, s[20:23], s62 offen offset:1024 lds
    v_mfma_f32_16x16x32_bf16 v[88:91], a[184:187], a[112:115], v[88:91]
    ds_read_b64_tr_b16 a[144:145], v242 offset:32768
    v_mfma_f32_16x16x32_bf16 v[120:123], a[184:187], a[116:119], v[120:123]
    s_add_u32 m0, s61, 6144
    s_add_u32 s62, s60, 49920
    v_mfma_f32_16x16x32_bf16 v[152:155], a[184:187], a[120:123], v[152:155]
    ds_read_b64_tr_b16 a[146:147], v242 offset:33792
    v_mfma_f32_16x16x32_bf16 v[184:187], a[184:187], a[124:127], v[184:187]
    buffer_load_dwordx4 v12, s[20:23], s62 offen offset:0 lds
    v_mfma_f32_16x16x32_bf16 v[92:95], a[188:191], a[112:115], v[92:95]
    ds_read_b64_tr_b16 a[148:149], v242 offset:32776
    ds_read_b64_tr_b16 a[150:151], v242 offset:33800
    v_mfma_f32_16x16x32_bf16 v[124:127], a[188:191], a[116:119], v[124:127]
    v_mfma_f32_16x16x32_bf16 v[156:159], a[188:191], a[120:123], v[156:159]
    ds_read_b64_tr_b16 a[152:153], v243 offset:32768
    ds_read_b64_tr_b16 a[154:155], v243 offset:33792
    s_waitcnt lgkmcnt(15)
    v_mfma_f32_16x16x32_bf16 v[188:191], a[188:191], a[124:127], v[188:191]
    buffer_load_dwordx4 v13, s[20:23], s62 offen offset:1024 lds
    v_mfma_f32_16x16x32_bf16 v[192:195], a[208:211], a[112:115], v[192:195]
    ds_read_b64_tr_b16 a[156:157], v243 offset:32776
    ds_read_b64_tr_b16 a[158:159], v243 offset:33800
    v_mfma_f32_16x16x32_bf16 v[200:203], a[208:211], a[116:119], v[200:203]
    v_mfma_f32_16x16x32_bf16 v[208:211], a[208:211], a[120:123], v[208:211]
    ds_read_b64_tr_b16 a[224:225], v8 offset:32768
    ds_read_b64_tr_b16 a[226:227], v8 offset:33792
    v_mfma_f32_16x16x32_bf16 v[216:219], a[208:211], a[124:127], v[216:219]
    v_mfma_f32_16x16x32_bf16 v[196:199], a[212:215], a[112:115], v[196:199]
    ds_read_b64_tr_b16 a[228:229], v8 offset:32776
    ds_read_b64_tr_b16 a[230:231], v8 offset:33800
    v_mfma_f32_16x16x32_bf16 v[204:207], a[212:215], a[116:119], v[204:207]
    v_mfma_f32_16x16x32_bf16 v[212:215], a[212:215], a[120:123], v[212:215]
    ds_read_b64_tr_b16 a[192:193], v244 offset:8192
    ds_read_b64_tr_b16 a[194:195], v244 offset:8704
    v_mfma_f32_16x16x32_bf16 v[220:223], a[212:215], a[124:127], v[220:223]
    v_mfma_f32_16x16x32_bf16 v[224:227], a[216:219], a[112:115], v[224:227]
    ds_read_b64_tr_b16 a[196:197], v245 offset:8192
    ds_read_b64_tr_b16 a[198:199], v245 offset:8704
    v_mfma_f32_16x16x32_bf16 v[232:235], a[216:219], a[116:119], v[232:235]
    v_mfma_f32_16x16x32_bf16 v[228:231], a[220:223], a[112:115], v[228:231]
    ds_read_b64_tr_b16 a[200:201], v246 offset:8192
    ds_read_b64_tr_b16 a[202:203], v246 offset:8704
    v_mfma_f32_16x16x32_bf16 v[236:239], a[220:223], a[116:119], v[236:239]
    v_mfma_f32_16x16x32_bf16 v[34:37], a[236:239], v[46:49], v[34:37]
    ds_read_b64_tr_b16 a[204:205], v247 offset:8192
    ds_read_b64_tr_b16 a[206:207], v247 offset:8704
    v_mfma_f32_16x16x32_bf16 v[38:41], a[240:243], v[46:49], v[38:41]
    v_mfma_f32_16x16x32_bf16 v[42:45], a[244:247], v[46:49], v[42:45]
    ds_read_b64_tr_b16 a[232:233], v254 offset:8192
    ds_read_b64_tr_b16 a[234:235], v254 offset:8704
    s_waitcnt lgkmcnt(10)
    v_mfma_f32_16x16x32_bf16 v[64:67], a[128:131], a[96:99], v[64:67]
    ds_read_b128 a[112:115], v11 offset:32768
    v_accvgpr_write_b32 a80, 0
    v_mfma_f32_16x16x32_bf16 v[96:99], a[128:131], a[100:103], v[96:99]
    s_add_u32 m0, s33, 98304
    s_add_u32 s84, s83, 3670016
    v_mfma_f32_16x16x32_bf16 v[128:131], a[128:131], a[104:107], v[128:131]
    ds_read_b128 a[116:119], v11 offset:34816
    v_accvgpr_write_b32 a81, 0
    v_mfma_f32_16x16x32_bf16 v[160:163], a[128:131], a[108:111], v[160:163]
    buffer_load_dwordx4 v248, s[16:19], s84 offen offset:0 lds
    v_mfma_f32_16x16x32_bf16 v[68:71], a[132:135], a[96:99], v[68:71]
    ds_read_b128 a[120:123], v7 offset:32768
    v_accvgpr_write_b32 a82, 0
    v_mfma_f32_16x16x32_bf16 v[100:103], a[132:135], a[100:103], v[100:103]
    v_mfma_f32_16x16x32_bf16 v[132:135], a[132:135], a[104:107], v[132:135]
    ds_read_b128 a[124:127], v7 offset:34816
    v_accvgpr_write_b32 a83, 0
    v_mfma_f32_16x16x32_bf16 v[164:167], a[132:135], a[108:111], v[164:167]
    buffer_load_dwordx4 v249, s[16:19], s84 offen offset:1024 lds
    v_mfma_f32_16x16x32_bf16 v[72:75], a[136:139], a[96:99], v[72:75]
    ds_read_b64_tr_b16 a[160:161], v240 offset:40960
    v_accvgpr_write_b32 a84, 0
    v_mfma_f32_16x16x32_bf16 v[104:107], a[136:139], a[100:103], v[104:107]
    v_mfma_f32_16x16x32_bf16 v[136:139], a[136:139], a[104:107], v[136:139]
    ds_read_b64_tr_b16 a[162:163], v240 offset:41984
    v_accvgpr_write_b32 a85, 0
    v_mfma_f32_16x16x32_bf16 v[168:171], a[136:139], a[108:111], v[168:171]
    buffer_load_dwordx4 v250, s[16:19], s84 offen offset:2048 lds
    v_mfma_f32_16x16x32_bf16 v[76:79], a[140:143], a[96:99], v[76:79]
    ds_read_b64_tr_b16 a[164:165], v240 offset:40968
    v_accvgpr_write_b32 a86, 0
    v_mfma_f32_16x16x32_bf16 v[108:111], a[140:143], a[100:103], v[108:111]
    v_mfma_f32_16x16x32_bf16 v[140:143], a[140:143], a[104:107], v[140:143]
    ds_read_b64_tr_b16 a[166:167], v240 offset:41992
    v_accvgpr_write_b32 a87, 0
    v_mfma_f32_16x16x32_bf16 v[172:175], a[140:143], a[108:111], v[172:175]
    buffer_load_dwordx4 v251, s[16:19], s84 offen offset:3072 lds
    v_mfma_f32_16x16x32_bf16 v[80:83], a[144:147], a[96:99], v[80:83]
    ds_read_b64_tr_b16 a[168:169], v241 offset:40960
    v_mfma_f32_16x16x32_bf16 v[112:115], a[144:147], a[100:103], v[112:115]
    s_add_u32 m0, s86, 24576
    s_add_u32 s84, s85, 1232896
    v_mfma_f32_16x16x32_bf16 v[144:147], a[144:147], a[104:107], v[144:147]
    ds_read_b64_tr_b16 a[170:171], v241 offset:41984
    v_mfma_f32_16x16x32_bf16 v[176:179], a[144:147], a[108:111], v[176:179]
    buffer_load_dwordx4 v252, s[72:75], s84 offen offset:0 lds
    v_mfma_f32_16x16x32_bf16 v[84:87], a[148:151], a[96:99], v[84:87]
    ds_read_b64_tr_b16 a[172:173], v241 offset:40968
    v_mfma_f32_16x16x32_bf16 v[116:119], a[148:151], a[100:103], v[116:119]
    v_mfma_f32_16x16x32_bf16 v[148:151], a[148:151], a[104:107], v[148:151]
    ds_read_b64_tr_b16 a[174:175], v241 offset:41992
    v_mfma_f32_16x16x32_bf16 v[180:183], a[148:151], a[108:111], v[180:183]
    buffer_load_dwordx4 v253, s[72:75], s84 offen offset:1024 lds
    v_mfma_f32_16x16x32_bf16 v[88:91], a[152:155], a[96:99], v[88:91]
    ds_read_b64_tr_b16 a[176:177], v242 offset:40960
    v_mfma_f32_16x16x32_bf16 v[120:123], a[152:155], a[100:103], v[120:123]
    v_mfma_f32_16x16x32_bf16 v[152:155], a[152:155], a[104:107], v[152:155]
    ds_read_b64_tr_b16 a[178:179], v242 offset:41984
    v_mfma_f32_16x16x32_bf16 v[184:187], a[152:155], a[108:111], v[184:187]
    v_mfma_f32_16x16x32_bf16 v[92:95], a[156:159], a[96:99], v[92:95]
    ds_read_b64_tr_b16 a[180:181], v242 offset:40968
    ds_read_b64_tr_b16 a[182:183], v242 offset:41992
    v_mfma_f32_16x16x32_bf16 v[124:127], a[156:159], a[100:103], v[124:127]
    v_mfma_f32_16x16x32_bf16 v[156:159], a[156:159], a[104:107], v[156:159]
    ds_read_b64_tr_b16 a[184:185], v243 offset:40960
    ds_read_b64_tr_b16 a[186:187], v243 offset:41984
    s_waitcnt lgkmcnt(15)
    v_mfma_f32_16x16x32_bf16 v[188:191], a[156:159], a[108:111], v[188:191]
    v_mfma_f32_16x16x32_bf16 v[192:195], a[192:195], a[96:99], v[192:195]
    ds_read_b64_tr_b16 a[188:189], v243 offset:40968
    ds_read_b64_tr_b16 a[190:191], v243 offset:41992
    v_mfma_f32_16x16x32_bf16 v[200:203], a[192:195], a[100:103], v[200:203]
    v_mfma_f32_16x16x32_bf16 v[208:211], a[192:195], a[104:107], v[208:211]
    ds_read_b64_tr_b16 a[236:237], v8 offset:40960
    ds_read_b64_tr_b16 a[238:239], v8 offset:41984
    v_mfma_f32_16x16x32_bf16 v[216:219], a[192:195], a[108:111], v[216:219]
    v_mfma_f32_16x16x32_bf16 v[196:199], a[196:199], a[96:99], v[196:199]
    ds_read_b64_tr_b16 a[240:241], v8 offset:40968
    ds_read_b64_tr_b16 a[242:243], v8 offset:41992
    v_mfma_f32_16x16x32_bf16 v[204:207], a[196:199], a[100:103], v[204:207]
    v_mfma_f32_16x16x32_bf16 v[212:215], a[196:199], a[104:107], v[212:215]
    ds_read_b64_tr_b16 a[208:209], v244 offset:12288
    ds_read_b64_tr_b16 a[210:211], v244 offset:12800
    v_mfma_f32_16x16x32_bf16 v[220:223], a[196:199], a[108:111], v[220:223]
    v_mfma_f32_16x16x32_bf16 v[224:227], a[200:203], a[96:99], v[224:227]
    ds_read_b64_tr_b16 a[212:213], v245 offset:12288
    ds_read_b64_tr_b16 a[214:215], v245 offset:12800
    v_mfma_f32_16x16x32_bf16 v[232:235], a[200:203], a[100:103], v[232:235]
    v_mfma_f32_16x16x32_bf16 v[228:231], a[204:207], a[96:99], v[228:231]
    ds_read_b64_tr_b16 a[216:217], v246 offset:12288
    ds_read_b64_tr_b16 a[218:219], v246 offset:12800
    v_mfma_f32_16x16x32_bf16 v[236:239], a[204:207], a[100:103], v[236:239]
    v_mfma_f32_16x16x32_bf16 v[34:37], a[224:227], v[46:49], v[34:37]
    ds_read_b64_tr_b16 a[220:221], v247 offset:12288
    ds_read_b64_tr_b16 a[222:223], v247 offset:12800
    v_mfma_f32_16x16x32_bf16 v[38:41], a[228:231], v[46:49], v[38:41]
    v_mfma_f32_16x16x32_bf16 v[42:45], a[232:235], v[46:49], v[42:45]
    ds_read_b64_tr_b16 a[244:245], v254 offset:12288
    ds_read_b64_tr_b16 a[246:247], v254 offset:12800
    s_cmp_lg_u32 s28, 3
    s_cbranch_scc1 attn_ready
    s_waitcnt vmcnt(14)
    s_mov_b64 exec, 0xffffffff
attn_poll:
    v_cmp_ne_u64 vcc, s[100:101], v[14:15]
    s_cbranch_vccz attn_seen
    buffer_load_dwordx2 v[14:15], v1, s[92:95], s87 offen sc1
    s_waitcnt vmcnt(0)
    s_branch attn_poll
attn_seen:
    s_mov_b64 exec, -1
attn_ready:
    s_waitcnt vmcnt(6) lgkmcnt(10)
    s_barrier
    v_mfma_f32_16x16x32_bf16 v[64:67], a[160:163], a[112:115], v[64:67]
    ds_read_b128 a[96:99], v9 offset:0
    v_accvgpr_write_b32 a88, 0
    v_mfma_f32_16x16x32_bf16 v[96:99], a[160:163], a[116:119], v[96:99]
    s_add_u32 m0, s61, 32768
    s_add_u32 s62, s60, 896
    v_mfma_f32_16x16x32_bf16 v[128:131], a[160:163], a[120:123], v[128:131]
    ds_read_b128 a[100:103], v9 offset:2048
    v_accvgpr_write_b32 a89, 0
    v_mfma_f32_16x16x32_bf16 v[160:163], a[160:163], a[124:127], v[160:163]
    buffer_load_dwordx4 v12, s[20:23], s62 offen offset:0 lds
    v_mfma_f32_16x16x32_bf16 v[68:71], a[164:167], a[112:115], v[68:71]
    ds_read_b128 a[104:107], v10 offset:0
    v_accvgpr_write_b32 a90, 0
    v_mfma_f32_16x16x32_bf16 v[100:103], a[164:167], a[116:119], v[100:103]
    v_mfma_f32_16x16x32_bf16 v[132:135], a[164:167], a[120:123], v[132:135]
    ds_read_b128 a[108:111], v10 offset:2048
    v_accvgpr_write_b32 a91, 0
    v_mfma_f32_16x16x32_bf16 v[164:167], a[164:167], a[124:127], v[164:167]
    buffer_load_dwordx4 v13, s[20:23], s62 offen offset:1024 lds
    v_mfma_f32_16x16x32_bf16 v[72:75], a[168:171], a[112:115], v[72:75]
    ds_read_b64_tr_b16 a[128:129], v240 offset:0
    v_accvgpr_write_b32 a92, 0
    v_mfma_f32_16x16x32_bf16 v[104:107], a[168:171], a[116:119], v[104:107]
    s_add_u32 m0, s61, 34816
    s_add_u32 s62, s60, 17280
    v_mfma_f32_16x16x32_bf16 v[136:139], a[168:171], a[120:123], v[136:139]
    ds_read_b64_tr_b16 a[130:131], v240 offset:1024
    v_accvgpr_write_b32 a93, 0
    v_mfma_f32_16x16x32_bf16 v[168:171], a[168:171], a[124:127], v[168:171]
    buffer_load_dwordx4 v12, s[20:23], s62 offen offset:0 lds
    v_mfma_f32_16x16x32_bf16 v[76:79], a[172:175], a[112:115], v[76:79]
    ds_read_b64_tr_b16 a[132:133], v240 offset:8
    v_accvgpr_write_b32 a94, 0
    v_mfma_f32_16x16x32_bf16 v[108:111], a[172:175], a[116:119], v[108:111]
    v_mfma_f32_16x16x32_bf16 v[140:143], a[172:175], a[120:123], v[140:143]
    ds_read_b64_tr_b16 a[134:135], v240 offset:1032
    v_accvgpr_write_b32 a95, 0
    v_mfma_f32_16x16x32_bf16 v[172:175], a[172:175], a[124:127], v[172:175]
    buffer_load_dwordx4 v13, s[20:23], s62 offen offset:1024 lds
    v_mfma_f32_16x16x32_bf16 v[80:83], a[176:179], a[112:115], v[80:83]
    ds_read_b64_tr_b16 a[136:137], v241 offset:0
    v_mfma_f32_16x16x32_bf16 v[112:115], a[176:179], a[116:119], v[112:115]
    s_add_u32 m0, s61, 36864
    s_add_u32 s62, s60, 33664
    v_mfma_f32_16x16x32_bf16 v[144:147], a[176:179], a[120:123], v[144:147]
    ds_read_b64_tr_b16 a[138:139], v241 offset:1024
    v_mfma_f32_16x16x32_bf16 v[176:179], a[176:179], a[124:127], v[176:179]
    buffer_load_dwordx4 v12, s[20:23], s62 offen offset:0 lds
    v_mfma_f32_16x16x32_bf16 v[84:87], a[180:183], a[112:115], v[84:87]
    ds_read_b64_tr_b16 a[140:141], v241 offset:8
    v_mfma_f32_16x16x32_bf16 v[116:119], a[180:183], a[116:119], v[116:119]
    v_mfma_f32_16x16x32_bf16 v[148:151], a[180:183], a[120:123], v[148:151]
    ds_read_b64_tr_b16 a[142:143], v241 offset:1032
    v_mfma_f32_16x16x32_bf16 v[180:183], a[180:183], a[124:127], v[180:183]
    buffer_load_dwordx4 v13, s[20:23], s62 offen offset:1024 lds
    v_mfma_f32_16x16x32_bf16 v[88:91], a[184:187], a[112:115], v[88:91]
    ds_read_b64_tr_b16 a[144:145], v242 offset:0
    v_mfma_f32_16x16x32_bf16 v[120:123], a[184:187], a[116:119], v[120:123]
    s_add_u32 m0, s61, 38912
    s_add_u32 s62, s60, 50048
    v_mfma_f32_16x16x32_bf16 v[152:155], a[184:187], a[120:123], v[152:155]
    ds_read_b64_tr_b16 a[146:147], v242 offset:1024
    v_mfma_f32_16x16x32_bf16 v[184:187], a[184:187], a[124:127], v[184:187]
    buffer_load_dwordx4 v12, s[20:23], s62 offen offset:0 lds
    v_mfma_f32_16x16x32_bf16 v[92:95], a[188:191], a[112:115], v[92:95]
    ds_read_b64_tr_b16 a[148:149], v242 offset:8
    ds_read_b64_tr_b16 a[150:151], v242 offset:1032
    v_mfma_f32_16x16x32_bf16 v[124:127], a[188:191], a[116:119], v[124:127]
    v_mfma_f32_16x16x32_bf16 v[156:159], a[188:191], a[120:123], v[156:159]
    ds_read_b64_tr_b16 a[152:153], v243 offset:0
    ds_read_b64_tr_b16 a[154:155], v243 offset:1024
    s_waitcnt lgkmcnt(15)
    v_mfma_f32_16x16x32_bf16 v[188:191], a[188:191], a[124:127], v[188:191]
    buffer_load_dwordx4 v13, s[20:23], s62 offen offset:1024 lds
    v_mfma_f32_16x16x32_bf16 v[192:195], a[208:211], a[112:115], v[192:195]
    ds_read_b64_tr_b16 a[156:157], v243 offset:8
    ds_read_b64_tr_b16 a[158:159], v243 offset:1032
    v_mfma_f32_16x16x32_bf16 v[200:203], a[208:211], a[116:119], v[200:203]
    v_mfma_f32_16x16x32_bf16 v[208:211], a[208:211], a[120:123], v[208:211]
    ds_read_b64_tr_b16 a[224:225], v8 offset:0
    ds_read_b64_tr_b16 a[226:227], v8 offset:1024
    v_mfma_f32_16x16x32_bf16 v[216:219], a[208:211], a[124:127], v[216:219]
    v_mfma_f32_16x16x32_bf16 v[196:199], a[212:215], a[112:115], v[196:199]
    ds_read_b64_tr_b16 a[228:229], v8 offset:8
    ds_read_b64_tr_b16 a[230:231], v8 offset:1032
    v_mfma_f32_16x16x32_bf16 v[204:207], a[212:215], a[116:119], v[204:207]
    v_mfma_f32_16x16x32_bf16 v[212:215], a[212:215], a[120:123], v[212:215]
    ds_read_b64_tr_b16 a[192:193], v244 offset:16384
    ds_read_b64_tr_b16 a[194:195], v244 offset:16896
    v_mfma_f32_16x16x32_bf16 v[220:223], a[212:215], a[124:127], v[220:223]
    v_mfma_f32_16x16x32_bf16 v[224:227], a[216:219], a[112:115], v[224:227]
    ds_read_b64_tr_b16 a[196:197], v245 offset:16384
    ds_read_b64_tr_b16 a[198:199], v245 offset:16896
    v_mfma_f32_16x16x32_bf16 v[232:235], a[216:219], a[116:119], v[232:235]
    v_mfma_f32_16x16x32_bf16 v[228:231], a[220:223], a[112:115], v[228:231]
    ds_read_b64_tr_b16 a[200:201], v246 offset:16384
    ds_read_b64_tr_b16 a[202:203], v246 offset:16896
    v_mfma_f32_16x16x32_bf16 v[236:239], a[220:223], a[116:119], v[236:239]
    v_mfma_f32_16x16x32_bf16 v[34:37], a[236:239], v[46:49], v[34:37]
    ds_read_b64_tr_b16 a[204:205], v247 offset:16384
    ds_read_b64_tr_b16 a[206:207], v247 offset:16896
    v_mfma_f32_16x16x32_bf16 v[38:41], a[240:243], v[46:49], v[38:41]
    v_mfma_f32_16x16x32_bf16 v[42:45], a[244:247], v[46:49], v[42:45]
    ds_read_b64_tr_b16 a[232:233], v254 offset:16384
    ds_read_b64_tr_b16 a[234:235], v254 offset:16896
    s_waitcnt lgkmcnt(10)
    v_mfma_f32_16x16x32_bf16 v[64:67], a[128:131], a[96:99], v[64:67]
    ds_read_b128 a[112:115], v11 offset:0
    v_mfma_f32_16x16x32_bf16 v[96:99], a[128:131], a[100:103], v[96:99]
    s_add_u32 m0, s33, 0
    s_mov_b32 s31, 0
    v_mfma_f32_16x16x32_bf16 v[128:131], a[128:131], a[104:107], v[128:131]
    ds_read_b128 a[116:119], v11 offset:2048
    v_mfma_f32_16x16x32_bf16 v[160:163], a[128:131], a[108:111], v[160:163]
    buffer_load_dwordx4 v28, s[8:11], s31 offen offset:0 lds
    v_mfma_f32_16x16x32_bf16 v[68:71], a[132:135], a[96:99], v[68:71]
    ds_read_b128 a[120:123], v7 offset:0
    v_mfma_f32_16x16x32_bf16 v[100:103], a[132:135], a[100:103], v[100:103]
    v_mfma_f32_16x16x32_bf16 v[132:135], a[132:135], a[104:107], v[132:135]
    ds_read_b128 a[124:127], v7 offset:2048
    v_mfma_f32_16x16x32_bf16 v[164:167], a[132:135], a[108:111], v[164:167]
    buffer_load_dwordx4 v29, s[8:11], s31 offen offset:1024 lds
    v_mfma_f32_16x16x32_bf16 v[72:75], a[136:139], a[96:99], v[72:75]
    ds_read_b64_tr_b16 a[160:161], v240 offset:8192
    v_mfma_f32_16x16x32_bf16 v[104:107], a[136:139], a[100:103], v[104:107]
    v_mfma_f32_16x16x32_bf16 v[136:139], a[136:139], a[104:107], v[136:139]
    ds_read_b64_tr_b16 a[162:163], v240 offset:9216
    v_mfma_f32_16x16x32_bf16 v[168:171], a[136:139], a[108:111], v[168:171]
    buffer_load_dwordx4 v30, s[8:11], s31 offen offset:2048 lds
    v_mfma_f32_16x16x32_bf16 v[76:79], a[140:143], a[96:99], v[76:79]
    ds_read_b64_tr_b16 a[164:165], v240 offset:8200
    v_mfma_f32_16x16x32_bf16 v[108:111], a[140:143], a[100:103], v[108:111]
    v_mfma_f32_16x16x32_bf16 v[140:143], a[140:143], a[104:107], v[140:143]
    ds_read_b64_tr_b16 a[166:167], v240 offset:9224
    v_mfma_f32_16x16x32_bf16 v[172:175], a[140:143], a[108:111], v[172:175]
    buffer_load_dwordx4 v31, s[8:11], s31 offen offset:3072 lds
    v_mfma_f32_16x16x32_bf16 v[80:83], a[144:147], a[96:99], v[80:83]
    ds_read_b64_tr_b16 a[168:169], v241 offset:8192
    v_mfma_f32_16x16x32_bf16 v[112:115], a[144:147], a[100:103], v[112:115]
    v_mfma_f32_16x16x32_bf16 v[144:147], a[144:147], a[104:107], v[144:147]
    ds_read_b64_tr_b16 a[170:171], v241 offset:9216
    v_mfma_f32_16x16x32_bf16 v[176:179], a[144:147], a[108:111], v[176:179]
    buffer_load_dwordx4 v[56:59], v50, s[44:47], s48 offen offset:0 sc1
    v_mfma_f32_16x16x32_bf16 v[84:87], a[148:151], a[96:99], v[84:87]
    ds_read_b64_tr_b16 a[172:173], v241 offset:8200
    v_mfma_f32_16x16x32_bf16 v[116:119], a[148:151], a[100:103], v[116:119]
    v_mfma_f32_16x16x32_bf16 v[148:151], a[148:151], a[104:107], v[148:151]
    ds_read_b64_tr_b16 a[174:175], v241 offset:9224
    v_mfma_f32_16x16x32_bf16 v[180:183], a[148:151], a[108:111], v[180:183]
    buffer_load_dwordx4 v[60:63], v50, s[44:47], s48 offen offset:256 sc1
    v_mfma_f32_16x16x32_bf16 v[88:91], a[152:155], a[96:99], v[88:91]
    ds_read_b64_tr_b16 a[176:177], v242 offset:8192
    v_mfma_f32_16x16x32_bf16 v[120:123], a[152:155], a[100:103], v[120:123]
    v_mfma_f32_16x16x32_bf16 v[152:155], a[152:155], a[104:107], v[152:155]
    ds_read_b64_tr_b16 a[178:179], v242 offset:9216
    v_mfma_f32_16x16x32_bf16 v[184:187], a[152:155], a[108:111], v[184:187]
    buffer_load_dwordx4 v[2:5], v50, s[44:47], s49 offen offset:0 sc1
    v_mfma_f32_16x16x32_bf16 v[92:95], a[156:159], a[96:99], v[92:95]
    ds_read_b64_tr_b16 a[180:181], v242 offset:8200
    ds_read_b64_tr_b16 a[182:183], v242 offset:9224
    v_mfma_f32_16x16x32_bf16 v[124:127], a[156:159], a[100:103], v[124:127]
    v_mfma_f32_16x16x32_bf16 v[156:159], a[156:159], a[104:107], v[156:159]
    ds_read_b64_tr_b16 a[184:185], v243 offset:8192
    ds_read_b64_tr_b16 a[186:187], v243 offset:9216
    s_waitcnt lgkmcnt(15)
    v_mfma_f32_16x16x32_bf16 v[188:191], a[156:159], a[108:111], v[188:191]
    buffer_load_dwordx4 v[12:15], v50, s[44:47], s49 offen offset:256 sc1
    v_mfma_f32_16x16x32_bf16 v[192:195], a[192:195], a[96:99], v[192:195]
    ds_read_b64_tr_b16 a[188:189], v243 offset:8200
    ds_read_b64_tr_b16 a[190:191], v243 offset:9224
    v_mfma_f32_16x16x32_bf16 v[200:203], a[192:195], a[100:103], v[200:203]
    v_mfma_f32_16x16x32_bf16 v[208:211], a[192:195], a[104:107], v[208:211]
    ds_read_b64_tr_b16 a[236:237], v8 offset:8192
    ds_read_b64_tr_b16 a[238:239], v8 offset:9216
    v_mfma_f32_16x16x32_bf16 v[216:219], a[192:195], a[108:111], v[216:219]
    v_mfma_f32_16x16x32_bf16 v[196:199], a[196:199], a[96:99], v[196:199]
    ds_read_b64_tr_b16 a[240:241], v8 offset:8200
    ds_read_b64_tr_b16 a[242:243], v8 offset:9224
    v_mfma_f32_16x16x32_bf16 v[204:207], a[196:199], a[100:103], v[204:207]
    v_mfma_f32_16x16x32_bf16 v[212:215], a[196:199], a[104:107], v[212:215]
    ds_read_b64_tr_b16 a[208:209], v244 offset:20480
    ds_read_b64_tr_b16 a[210:211], v244 offset:20992
    v_mfma_f32_16x16x32_bf16 v[220:223], a[196:199], a[108:111], v[220:223]
    v_mfma_f32_16x16x32_bf16 v[224:227], a[200:203], a[96:99], v[224:227]
    ds_read_b64_tr_b16 a[212:213], v245 offset:20480
    ds_read_b64_tr_b16 a[214:215], v245 offset:20992
    v_mfma_f32_16x16x32_bf16 v[232:235], a[200:203], a[100:103], v[232:235]
    v_mfma_f32_16x16x32_bf16 v[228:231], a[204:207], a[96:99], v[228:231]
    ds_read_b64_tr_b16 a[216:217], v246 offset:20480
    ds_read_b64_tr_b16 a[218:219], v246 offset:20992
    v_mfma_f32_16x16x32_bf16 v[236:239], a[204:207], a[100:103], v[236:239]
    v_mfma_f32_16x16x32_bf16 v[34:37], a[224:227], v[46:49], v[34:37]
    ds_read_b64_tr_b16 a[220:221], v247 offset:20480
    ds_read_b64_tr_b16 a[222:223], v247 offset:20992
    v_mfma_f32_16x16x32_bf16 v[38:41], a[228:231], v[46:49], v[38:41]
    v_mfma_f32_16x16x32_bf16 v[42:45], a[232:235], v[46:49], v[42:45]
    ds_read_b64_tr_b16 a[244:245], v254 offset:20480
    ds_read_b64_tr_b16 a[246:247], v254 offset:20992
    s_waitcnt vmcnt(8) lgkmcnt(10)
    s_barrier
    v_mfma_f32_16x16x32_bf16 v[64:67], a[160:163], a[112:115], v[64:67]
    ds_read_b128 a[96:99], v9 offset:32768
    v_mfma_f32_16x16x32_bf16 v[96:99], a[160:163], a[116:119], v[96:99]
    s_add_u32 m0, s33, 16384
    s_mov_b32 s31, 16384
    v_mfma_f32_16x16x32_bf16 v[128:131], a[160:163], a[120:123], v[128:131]
    ds_read_b128 a[100:103], v9 offset:34816
    v_mfma_f32_16x16x32_bf16 v[160:163], a[160:163], a[124:127], v[160:163]
    buffer_load_dwordx4 v28, s[8:11], s31 offen offset:0 lds
    v_mfma_f32_16x16x32_bf16 v[68:71], a[164:167], a[112:115], v[68:71]
    ds_read_b128 a[104:107], v10 offset:32768
    v_mfma_f32_16x16x32_bf16 v[100:103], a[164:167], a[116:119], v[100:103]
    v_mfma_f32_16x16x32_bf16 v[132:135], a[164:167], a[120:123], v[132:135]
    ds_read_b128 a[108:111], v10 offset:34816
    v_mfma_f32_16x16x32_bf16 v[164:167], a[164:167], a[124:127], v[164:167]
    buffer_load_dwordx4 v29, s[8:11], s31 offen offset:1024 lds
    v_mfma_f32_16x16x32_bf16 v[72:75], a[168:171], a[112:115], v[72:75]
    ds_read_b64_tr_b16 a[128:129], v240 offset:16384
    v_mfma_f32_16x16x32_bf16 v[104:107], a[168:171], a[116:119], v[104:107]
    v_mfma_f32_16x16x32_bf16 v[136:139], a[168:171], a[120:123], v[136:139]
    ds_read_b64_tr_b16 a[130:131], v240 offset:17408
    v_mfma_f32_16x16x32_bf16 v[168:171], a[168:171], a[124:127], v[168:171]
    buffer_load_dwordx4 v30, s[8:11], s31 offen offset:2048 lds
    v_mfma_f32_16x16x32_bf16 v[76:79], a[172:175], a[112:115], v[76:79]
    ds_read_b64_tr_b16 a[132:133], v240 offset:16392
    v_mfma_f32_16x16x32_bf16 v[108:111], a[172:175], a[116:119], v[108:111]
    v_mfma_f32_16x16x32_bf16 v[140:143], a[172:175], a[120:123], v[140:143]
    ds_read_b64_tr_b16 a[134:135], v240 offset:17416
    v_mfma_f32_16x16x32_bf16 v[172:175], a[172:175], a[124:127], v[172:175]
    buffer_load_dwordx4 v31, s[8:11], s31 offen offset:3072 lds
    v_mfma_f32_16x16x32_bf16 v[80:83], a[176:179], a[112:115], v[80:83]
    ds_read_b64_tr_b16 a[136:137], v241 offset:16384
    v_mfma_f32_16x16x32_bf16 v[112:115], a[176:179], a[116:119], v[112:115]
    s_add_u32 m0, s33, 32768
    s_mov_b32 s31, 32768
    v_mfma_f32_16x16x32_bf16 v[144:147], a[176:179], a[120:123], v[144:147]
    ds_read_b64_tr_b16 a[138:139], v241 offset:17408
    v_mfma_f32_16x16x32_bf16 v[176:179], a[176:179], a[124:127], v[176:179]
    buffer_load_dwordx4 v28, s[8:11], s31 offen offset:0 lds
    v_mfma_f32_16x16x32_bf16 v[84:87], a[180:183], a[112:115], v[84:87]
    ds_read_b64_tr_b16 a[140:141], v241 offset:16392
    v_mfma_f32_16x16x32_bf16 v[116:119], a[180:183], a[116:119], v[116:119]
    v_mfma_f32_16x16x32_bf16 v[148:151], a[180:183], a[120:123], v[148:151]
    ds_read_b64_tr_b16 a[142:143], v241 offset:17416
    v_mfma_f32_16x16x32_bf16 v[180:183], a[180:183], a[124:127], v[180:183]
    buffer_load_dwordx4 v29, s[8:11], s31 offen offset:1024 lds
    v_mfma_f32_16x16x32_bf16 v[88:91], a[184:187], a[112:115], v[88:91]
    ds_read_b64_tr_b16 a[144:145], v242 offset:16384
    v_mfma_f32_16x16x32_bf16 v[120:123], a[184:187], a[116:119], v[120:123]
    v_mfma_f32_16x16x32_bf16 v[152:155], a[184:187], a[120:123], v[152:155]
    ds_read_b64_tr_b16 a[146:147], v242 offset:17408
    v_mfma_f32_16x16x32_bf16 v[184:187], a[184:187], a[124:127], v[184:187]
    buffer_load_dwordx4 v30, s[8:11], s31 offen offset:2048 lds
    v_mfma_f32_16x16x32_bf16 v[92:95], a[188:191], a[112:115], v[92:95]
    ds_read_b64_tr_b16 a[148:149], v242 offset:16392
    ds_read_b64_tr_b16 a[150:151], v242 offset:17416
    v_mfma_f32_16x16x32_bf16 v[124:127], a[188:191], a[116:119], v[124:127]
    v_mfma_f32_16x16x32_bf16 v[156:159], a[188:191], a[120:123], v[156:159]
    ds_read_b64_tr_b16 a[152:153], v243 offset:16384
    ds_read_b64_tr_b16 a[154:155], v243 offset:17408
    s_waitcnt lgkmcnt(15)
    v_mfma_f32_16x16x32_bf16 v[188:191], a[188:191], a[124:127], v[188:191]
    buffer_load_dwordx4 v31, s[8:11], s31 offen offset:3072 lds
    v_mfma_f32_16x16x32_bf16 v[192:195], a[208:211], a[112:115], v[192:195]
    ds_read_b64_tr_b16 a[156:157], v243 offset:16392
    ds_read_b64_tr_b16 a[158:159], v243 offset:17416
    v_mfma_f32_16x16x32_bf16 v[200:203], a[208:211], a[116:119], v[200:203]
    v_mfma_f32_16x16x32_bf16 v[208:211], a[208:211], a[120:123], v[208:211]
    ds_read_b64_tr_b16 a[224:225], v8 offset:16384
    ds_read_b64_tr_b16 a[226:227], v8 offset:17408
    v_mfma_f32_16x16x32_bf16 v[216:219], a[208:211], a[124:127], v[216:219]
    v_mfma_f32_16x16x32_bf16 v[196:199], a[212:215], a[112:115], v[196:199]
    ds_read_b64_tr_b16 a[228:229], v8 offset:16392
    ds_read_b64_tr_b16 a[230:231], v8 offset:17416
    v_mfma_f32_16x16x32_bf16 v[204:207], a[212:215], a[116:119], v[204:207]
    v_mfma_f32_16x16x32_bf16 v[212:215], a[212:215], a[120:123], v[212:215]
    ds_read_b64_tr_b16 a[192:193], v244 offset:24576
    ds_read_b64_tr_b16 a[194:195], v244 offset:25088
    v_mfma_f32_16x16x32_bf16 v[220:223], a[212:215], a[124:127], v[220:223]
    v_mfma_f32_16x16x32_bf16 v[224:227], a[216:219], a[112:115], v[224:227]
    ds_read_b64_tr_b16 a[196:197], v245 offset:24576
    ds_read_b64_tr_b16 a[198:199], v245 offset:25088
    v_mfma_f32_16x16x32_bf16 v[232:235], a[216:219], a[116:119], v[232:235]
    v_mfma_f32_16x16x32_bf16 v[228:231], a[220:223], a[112:115], v[228:231]
    ds_read_b64_tr_b16 a[200:201], v246 offset:24576
    ds_read_b64_tr_b16 a[202:203], v246 offset:25088
    v_mfma_f32_16x16x32_bf16 v[236:239], a[220:223], a[116:119], v[236:239]
    v_mfma_f32_16x16x32_bf16 v[34:37], a[236:239], v[46:49], v[34:37]
    ds_read_b64_tr_b16 a[204:205], v247 offset:24576
    ds_read_b64_tr_b16 a[206:207], v247 offset:25088
    v_mfma_f32_16x16x32_bf16 v[38:41], a[240:243], v[46:49], v[38:41]
    v_mfma_f32_16x16x32_bf16 v[42:45], a[244:247], v[46:49], v[42:45]
    ds_read_b64_tr_b16 a[232:233], v254 offset:24576
    ds_read_b64_tr_b16 a[234:235], v254 offset:25088
    s_waitcnt lgkmcnt(10)
    v_mfma_f32_16x16x32_bf16 v[64:67], a[128:131], a[96:99], v[64:67]
    ds_read_b128 a[112:115], v11 offset:32768
    v_mfma_f32_16x16x32_bf16 v[96:99], a[128:131], a[100:103], v[96:99]
    s_add_u32 m0, s34, 16384
    s_mov_b32 s32, 16384
    v_mfma_f32_16x16x32_bf16 v[128:131], a[128:131], a[104:107], v[128:131]
    ds_read_b128 a[116:119], v11 offset:34816
    v_mfma_f32_16x16x32_bf16 v[160:163], a[128:131], a[108:111], v[160:163]
    buffer_load_dwordx4 v32, s[12:15], s32 offen offset:0 lds
    v_mfma_f32_16x16x32_bf16 v[68:71], a[132:135], a[96:99], v[68:71]
    ds_read_b128 a[120:123], v7 offset:32768
    v_mfma_f32_16x16x32_bf16 v[100:103], a[132:135], a[100:103], v[100:103]
    v_mfma_f32_16x16x32_bf16 v[132:135], a[132:135], a[104:107], v[132:135]
    ds_read_b128 a[124:127], v7 offset:34816
    v_mfma_f32_16x16x32_bf16 v[164:167], a[132:135], a[108:111], v[164:167]
    buffer_load_dwordx4 v33, s[12:15], s32 offen offset:1024 lds
    v_mfma_f32_16x16x32_bf16 v[72:75], a[136:139], a[96:99], v[72:75]
    ds_read_b64_tr_b16 a[160:161], v240 offset:24576
    v_mfma_f32_16x16x32_bf16 v[104:107], a[136:139], a[100:103], v[104:107]
    v_mfma_f32_16x16x32_bf16 v[136:139], a[136:139], a[104:107], v[136:139]
    ds_read_b64_tr_b16 a[162:163], v240 offset:25600
    v_mfma_f32_16x16x32_bf16 v[168:171], a[136:139], a[108:111], v[168:171]
    buffer_load_dwordx4 v32, s[12:15], s32 offen offset:2048 lds
    v_mfma_f32_16x16x32_bf16 v[76:79], a[140:143], a[96:99], v[76:79]
    ds_read_b64_tr_b16 a[164:165], v240 offset:24584
    v_mfma_f32_16x16x32_bf16 v[108:111], a[140:143], a[100:103], v[108:111]
    v_mfma_f32_16x16x32_bf16 v[140:143], a[140:143], a[104:107], v[140:143]
    ds_read_b64_tr_b16 a[166:167], v240 offset:25608
    v_mfma_f32_16x16x32_bf16 v[172:175], a[140:143], a[108:111], v[172:175]
    buffer_load_dwordx4 v33, s[12:15], s32 offen offset:3072 lds
    v_mfma_f32_16x16x32_bf16 v[80:83], a[144:147], a[96:99], v[80:83]
    ds_read_b64_tr_b16 a[168:169], v241 offset:24576
    v_mfma_f32_16x16x32_bf16 v[112:115], a[144:147], a[100:103], v[112:115]
    v_mfma_f32_16x16x32_bf16 v[144:147], a[144:147], a[104:107], v[144:147]
    ds_read_b64_tr_b16 a[170:171], v241 offset:25600
    v_mfma_f32_16x16x32_bf16 v[176:179], a[144:147], a[108:111], v[176:179]
    v_mfma_f32_16x16x32_bf16 v[84:87], a[148:151], a[96:99], v[84:87]
    ds_read_b64_tr_b16 a[172:173], v241 offset:24584
    v_mfma_f32_16x16x32_bf16 v[116:119], a[148:151], a[100:103], v[116:119]
    v_mfma_f32_16x16x32_bf16 v[148:151], a[148:151], a[104:107], v[148:151]
    ds_read_b64_tr_b16 a[174:175], v241 offset:25608
    v_mfma_f32_16x16x32_bf16 v[180:183], a[148:151], a[108:111], v[180:183]
    v_mfma_f32_16x16x32_bf16 v[88:91], a[152:155], a[96:99], v[88:91]
    ds_read_b64_tr_b16 a[176:177], v242 offset:24576
    v_mfma_f32_16x16x32_bf16 v[120:123], a[152:155], a[100:103], v[120:123]
    v_mfma_f32_16x16x32_bf16 v[152:155], a[152:155], a[104:107], v[152:155]
    ds_read_b64_tr_b16 a[178:179], v242 offset:25600
    v_mfma_f32_16x16x32_bf16 v[184:187], a[152:155], a[108:111], v[184:187]
    v_mfma_f32_16x16x32_bf16 v[92:95], a[156:159], a[96:99], v[92:95]
    ds_read_b64_tr_b16 a[180:181], v242 offset:24584
    ds_read_b64_tr_b16 a[182:183], v242 offset:25608
    v_mfma_f32_16x16x32_bf16 v[124:127], a[156:159], a[100:103], v[124:127]
    v_mfma_f32_16x16x32_bf16 v[156:159], a[156:159], a[104:107], v[156:159]
    ds_read_b64_tr_b16 a[184:185], v243 offset:24576
    ds_read_b64_tr_b16 a[186:187], v243 offset:25600
    s_waitcnt lgkmcnt(15)
    v_mfma_f32_16x16x32_bf16 v[188:191], a[156:159], a[108:111], v[188:191]
    v_mfma_f32_16x16x32_bf16 v[192:195], a[192:195], a[96:99], v[192:195]
    ds_read_b64_tr_b16 a[188:189], v243 offset:24584
    ds_read_b64_tr_b16 a[190:191], v243 offset:25608
    v_mfma_f32_16x16x32_bf16 v[200:203], a[192:195], a[100:103], v[200:203]
    v_mfma_f32_16x16x32_bf16 v[208:211], a[192:195], a[104:107], v[208:211]
    ds_read_b64_tr_b16 a[236:237], v8 offset:24576
    ds_read_b64_tr_b16 a[238:239], v8 offset:25600
    v_mfma_f32_16x16x32_bf16 v[216:219], a[192:195], a[108:111], v[216:219]
    v_mfma_f32_16x16x32_bf16 v[196:199], a[196:199], a[96:99], v[196:199]
    ds_read_b64_tr_b16 a[240:241], v8 offset:24584
    ds_read_b64_tr_b16 a[242:243], v8 offset:25608
    v_mfma_f32_16x16x32_bf16 v[204:207], a[196:199], a[100:103], v[204:207]
    v_mfma_f32_16x16x32_bf16 v[212:215], a[196:199], a[104:107], v[212:215]
    ds_read_b64_tr_b16 a[208:209], v244 offset:28672
    ds_read_b64_tr_b16 a[210:211], v244 offset:29184
    v_mfma_f32_16x16x32_bf16 v[220:223], a[196:199], a[108:111], v[220:223]
    v_mfma_f32_16x16x32_bf16 v[224:227], a[200:203], a[96:99], v[224:227]
    ds_read_b64_tr_b16 a[212:213], v245 offset:28672
    ds_read_b64_tr_b16 a[214:215], v245 offset:29184
    v_mfma_f32_16x16x32_bf16 v[232:235], a[200:203], a[100:103], v[232:235]
    v_mfma_f32_16x16x32_bf16 v[228:231], a[204:207], a[96:99], v[228:231]
    ds_read_b64_tr_b16 a[216:217], v246 offset:28672
    ds_read_b64_tr_b16 a[218:219], v246 offset:29184
    v_mfma_f32_16x16x32_bf16 v[236:239], a[204:207], a[100:103], v[236:239]
    v_mfma_f32_16x16x32_bf16 v[34:37], a[224:227], v[46:49], v[34:37]
    ds_read_b64_tr_b16 a[220:221], v247 offset:28672
    ds_read_b64_tr_b16 a[222:223], v247 offset:29184
    v_mfma_f32_16x16x32_bf16 v[38:41], a[228:231], v[46:49], v[38:41]
    v_mfma_f32_16x16x32_bf16 v[42:45], a[232:235], v[46:49], v[42:45]
    ds_read_b64_tr_b16 a[244:245], v254 offset:28672
    ds_read_b64_tr_b16 a[246:247], v254 offset:29184
    s_waitcnt vmcnt(12) lgkmcnt(0)
    s_barrier
    v_mfma_f32_16x16x32_bf16 v[34:37], a[236:239], v[46:49], v[34:37]
    v_mfma_f32_16x16x32_bf16 v[38:41], a[240:243], v[46:49], v[38:41]
    s_add_u32 m0, s34, 0
    s_mov_b32 s32, 0
    v_mfma_f32_16x16x32_bf16 v[42:45], a[244:247], v[46:49], v[42:45]
    v_mfma_f32_16x16x32_bf16 v[64:67], a[160:163], a[112:115], v[64:67]
    buffer_load_dwordx4 v32, s[12:15], s32 offen offset:0 lds
    v_mfma_f32_16x16x32_bf16 v[96:99], a[160:163], a[116:119], v[96:99]
    v_mfma_f32_16x16x32_bf16 v[128:131], a[160:163], a[120:123], v[128:131]
    v_accvgpr_write_b32 a96, 0
    v_mfma_f32_16x16x32_bf16 v[160:163], a[160:163], a[124:127], v[160:163]
    v_mfma_f32_16x16x32_bf16 v[68:71], a[164:167], a[112:115], v[68:71]
    buffer_load_dwordx4 v33, s[12:15], s32 offen offset:1024 lds
    v_accvgpr_write_b32 a97, 0
    v_mfma_f32_16x16x32_bf16 v[100:103], a[164:167], a[116:119], v[100:103]
    ds_write_b128 v52, v[34:37]
    v_mfma_f32_16x16x32_bf16 v[132:135], a[164:167], a[120:123], v[132:135]
    v_accvgpr_write_b32 a98, 0
    v_mfma_f32_16x16x32_bf16 v[164:167], a[164:167], a[124:127], v[164:167]
    ds_write_b128 v52, v[38:41] offset:64
    v_mfma_f32_16x16x32_bf16 v[72:75], a[168:171], a[112:115], v[72:75]
    s_lshl_b32 s37, s28, 6
    v_add_u32 v52, s37, v53
    buffer_load_dwordx4 v32, s[12:15], s32 offen offset:2048 lds
    v_accvgpr_write_b32 a99, 0
    v_mfma_f32_16x16x32_bf16 v[104:107], a[168:171], a[116:119], v[104:107]
    ds_write_b128 v52, v[42:45] offset:512
    v_mfma_f32_16x16x32_bf16 v[136:139], a[168:171], a[120:123], v[136:139]
    v_accvgpr_write_b32 a100, 0
    v_mfma_f32_16x16x32_bf16 v[168:171], a[168:171], a[124:127], v[168:171]
    ds_read_b128 a[128:131], v16 offset:0
    v_mfma_f32_16x16x32_bf16 v[76:79], a[172:175], a[112:115], v[76:79]
    buffer_load_dwordx4 v33, s[12:15], s32 offen offset:3072 lds
    v_accvgpr_write_b32 a101, 0
    v_mfma_f32_16x16x32_bf16 v[108:111], a[172:175], a[116:119], v[108:111]
    ds_read_b128 a[132:135], v17 offset:0
    v_mfma_f32_16x16x32_bf16 v[140:143], a[172:175], a[120:123], v[140:143]
    v_accvgpr_write_b32 a102, 0
    v_mfma_f32_16x16x32_bf16 v[172:175], a[172:175], a[124:127], v[172:175]
    ds_read_b128 a[136:139], v18 offset:0
    v_mfma_f32_16x16x32_bf16 v[80:83], a[176:179], a[112:115], v[80:83]
    v_accvgpr_write_b32 a103, 0
    v_mfma_f32_16x16x32_bf16 v[112:115], a[176:179], a[116:119], v[112:115]
    ds_read_b128 a[140:143], v19 offset:0
    v_mfma_f32_16x16x32_bf16 v[144:147], a[176:179], a[120:123], v[144:147]
    v_accvgpr_write_b32 a104, 0
    v_mfma_f32_16x16x32_bf16 v[176:179], a[176:179], a[124:127], v[176:179]
    ds_read_b128 a[144:147], v16 offset:4096
    v_mfma_f32_16x16x32_bf16 v[84:87], a[180:183], a[112:115], v[84:87]
    v_accvgpr_write_b32 a105, 0
    v_mfma_f32_16x16x32_bf16 v[116:119], a[180:183], a[116:119], v[116:119]
    ds_read_b128 a[148:151], v17 offset:4096
    v_mfma_f32_16x16x32_bf16 v[148:151], a[180:183], a[120:123], v[148:151]
    v_accvgpr_write_b32 a106, 0
    v_mfma_f32_16x16x32_bf16 v[180:183], a[180:183], a[124:127], v[180:183]
    ds_read_b128 a[152:155], v18 offset:4096
    v_mfma_f32_16x16x32_bf16 v[88:91], a[184:187], a[112:115], v[88:91]
    v_accvgpr_write_b32 a107, 0
    v_mfma_f32_16x16x32_bf16 v[120:123], a[184:187], a[116:119], v[120:123]
    ds_read_b128 a[156:159], v19 offset:4096
    v_mfma_f32_16x16x32_bf16 v[152:155], a[184:187], a[120:123], v[152:155]
    s_waitcnt lgkmcnt(8)
    s_barrier
    v_accvgpr_write_b32 a108, 0
    v_mfma_f32_16x16x32_bf16 v[184:187], a[184:187], a[124:127], v[184:187]
    ds_read_b128 v[34:37], v53 offset:0
    v_mfma_f32_16x16x32_bf16 v[92:95], a[188:191], a[112:115], v[92:95]
    v_accvgpr_write_b32 a109, 0
    v_mfma_f32_16x16x32_bf16 v[124:127], a[188:191], a[116:119], v[124:127]
    ds_read_b128 v[38:41], v53 offset:64
    v_mfma_f32_16x16x32_bf16 v[156:159], a[188:191], a[120:123], v[156:159]
    v_accvgpr_write_b32 a110, 0
    v_mfma_f32_16x16x32_bf16 v[188:191], a[188:191], a[124:127], v[188:191]
    ds_read_b128 v[42:45], v53 offset:128
    v_mfma_f32_16x16x32_bf16 v[192:195], a[208:211], a[112:115], v[192:195]
    v_accvgpr_write_b32 a111, 0
    v_mfma_f32_16x16x32_bf16 v[200:203], a[208:211], a[116:119], v[200:203]
    ds_read_b128 v[46:49], v53 offset:192
    v_mfma_f32_16x16x32_bf16 v[208:211], a[208:211], a[120:123], v[208:211]
    v_mfma_f32_16x16x32_bf16 v[216:219], a[208:211], a[124:127], v[216:219]
    ds_read_b128 v[240:243], v53 offset:256
    v_mfma_f32_16x16x32_bf16 v[196:199], a[212:215], a[112:115], v[196:199]
    v_mfma_f32_16x16x32_bf16 v[204:207], a[212:215], a[116:119], v[204:207]
    ds_read_b128 v[244:247], v53 offset:320
    v_mfma_f32_16x16x32_bf16 v[212:215], a[212:215], a[120:123], v[212:215]
    v_mfma_f32_16x16x32_bf16 v[220:223], a[212:215], a[124:127], v[220:223]
    ds_read_b128 v[248:251], v53 offset:384
    v_mfma_f32_16x16x32_bf16 v[224:227], a[216:219], a[112:115], v[224:227]
    s_mov_b32 s31, 32768
    v_mfma_f32_16x16x32_bf16 v[232:235], a[216:219], a[116:119], v[232:235]
    ds_read_b128 v[252:255], v53 offset:448
    v_mfma_f32_16x16x32_bf16 v[228:231], a[220:223], a[112:115], v[228:231]
    s_mov_b32 s32, 16384
    v_mfma_f32_16x16x32_bf16 v[236:239], a[220:223], a[116:119], v[236:239]
    v_accvgpr_write_b32 a112, 0
    v_accvgpr_write_b32 a113, 0
    v_accvgpr_write_b32 a114, 0
    v_accvgpr_write_b32 a115, 0
    v_accvgpr_write_b32 a116, 0
    v_accvgpr_write_b32 a117, 0
    v_accvgpr_write_b32 a118, 0
    v_accvgpr_write_b32 a119, 0
    v_accvgpr_write_b32 a120, 0
    v_accvgpr_write_b32 a121, 0
    v_accvgpr_write_b32 a122, 0
    v_accvgpr_write_b32 a123, 0
    v_accvgpr_write_b32 a124, 0
    v_accvgpr_write_b32 a125, 0
    v_accvgpr_write_b32 a126, 0
    v_accvgpr_write_b32 a127, 0
    s_waitcnt lgkmcnt(0)
    v_pk_fma_f32 v[64:65], v[56:57], v[34:35], v[64:65] op_sel_hi:[0,1,1]
    v_pk_fma_f32 v[66:67], v[56:57], v[36:37], v[66:67] op_sel_hi:[0,1,1]
    v_pk_mul_f32 v[64:65], v[64:65], v[56:57] op_sel:[0,1]
    v_pk_mul_f32 v[66:67], v[66:67], v[56:57] op_sel:[0,1]
    v_cvt_pk_bf16_f32 v64, v64, v65
    v_cvt_pk_bf16_f32 v65, v66, v67
    v_pk_fma_f32 v[68:69], v[56:57], v[38:39], v[68:69] op_sel_hi:[0,1,1]
    v_pk_fma_f32 v[70:71], v[56:57], v[40:41], v[70:71] op_sel_hi:[0,1,1]
    v_pk_mul_f32 v[68:69], v[68:69], v[56:57] op_sel:[0,1]
    v_pk_mul_f32 v[70:71], v[70:71], v[56:57] op_sel:[0,1]
    v_cvt_pk_bf16_f32 v66, v68, v69
    v_cvt_pk_bf16_f32 v67, v70, v71
    v_pk_fma_f32 v[72:73], v[56:57], v[42:43], v[72:73] op_sel_hi:[0,1,1]
    v_pk_fma_f32 v[74:75], v[56:57], v[44:45], v[74:75] op_sel_hi:[0,1,1]
    v_pk_mul_f32 v[72:73], v[72:73], v[56:57] op_sel:[0,1]
    v_pk_mul_f32 v[74:75], v[74:75], v[56:57] op_sel:[0,1]
    v_cvt_pk_bf16_f32 v68, v72, v73
    v_cvt_pk_bf16_f32 v69, v74, v75
    v_pk_fma_f32 v[76:77], v[56:57], v[46:47], v[76:77] op_sel_hi:[0,1,1]
    v_pk_fma_f32 v[78:79], v[56:57], v[48:49], v[78:79] op_sel_hi:[0,1,1]
    v_pk_mul_f32 v[76:77], v[76:77], v[56:57] op_sel:[0,1]
    v_pk_mul_f32 v[78:79], v[78:79], v[56:57] op_sel:[0,1]
    v_cvt_pk_bf16_f32 v70, v76, v77
    v_cvt_pk_bf16_f32 v71, v78, v79
    v_pk_fma_f32 v[80:81], v[56:57], v[240:241], v[80:81] op_sel_hi:[0,1,1]
    v_pk_fma_f32 v[82:83], v[56:57], v[242:243], v[82:83] op_sel_hi:[0,1,1]
    v_pk_mul_f32 v[80:81], v[80:81], v[56:57] op_sel:[0,1]
    v_pk_mul_f32 v[82:83], v[82:83], v[56:57] op_sel:[0,1]
    v_cvt_pk_bf16_f32 v72, v80, v81
    v_cvt_pk_bf16_f32 v73, v82, v83
    v_pk_fma_f32 v[84:85], v[56:57], v[244:245], v[84:85] op_sel_hi:[0,1,1]
    v_pk_fma_f32 v[86:87], v[56:57], v[246:247], v[86:87] op_sel_hi:[0,1,1]
    v_pk_mul_f32 v[84:85], v[84:85], v[56:57] op_sel:[0,1]
    v_pk_mul_f32 v[86:87], v[86:87], v[56:57] op_sel:[0,1]
    v_cvt_pk_bf16_f32 v74, v84, v85
    v_cvt_pk_bf16_f32 v75, v86, v87
    v_pk_fma_f32 v[88:89], v[56:57], v[248:249], v[88:89] op_sel_hi:[0,1,1]
    v_pk_fma_f32 v[90:91], v[56:57], v[250:251], v[90:91] op_sel_hi:[0,1,1]
    v_pk_mul_f32 v[88:89], v[88:89], v[56:57] op_sel:[0,1]
    v_pk_mul_f32 v[90:91], v[90:91], v[56:57] op_sel:[0,1]
    v_cvt_pk_bf16_f32 v76, v88, v89
    v_cvt_pk_bf16_f32 v77, v90, v91
    v_pk_fma_f32 v[92:93], v[56:57], v[252:253], v[92:93] op_sel_hi:[0,1,1]
    v_pk_fma_f32 v[94:95], v[56:57], v[254:255], v[94:95] op_sel_hi:[0,1,1]
    v_pk_mul_f32 v[92:93], v[92:93], v[56:57] op_sel:[0,1]
    v_pk_mul_f32 v[94:95], v[94:95], v[56:57] op_sel:[0,1]
    v_cvt_pk_bf16_f32 v78, v92, v93
    v_cvt_pk_bf16_f32 v79, v94, v95
    v_pk_fma_f32 v[96:97], v[60:61], v[34:35], v[96:97] op_sel_hi:[0,1,1]
    v_pk_fma_f32 v[98:99], v[60:61], v[36:37], v[98:99] op_sel_hi:[0,1,1]
    v_pk_mul_f32 v[96:97], v[96:97], v[60:61] op_sel:[0,1]
    v_pk_mul_f32 v[98:99], v[98:99], v[60:61] op_sel:[0,1]
    v_cvt_pk_bf16_f32 v80, v96, v97
    v_cvt_pk_bf16_f32 v81, v98, v99
    v_pk_fma_f32 v[100:101], v[60:61], v[38:39], v[100:101] op_sel_hi:[0,1,1]
    v_pk_fma_f32 v[102:103], v[60:61], v[40:41], v[102:103] op_sel_hi:[0,1,1]
    v_pk_mul_f32 v[100:101], v[100:101], v[60:61] op_sel:[0,1]
    v_pk_mul_f32 v[102:103], v[102:103], v[60:61] op_sel:[0,1]
    v_cvt_pk_bf16_f32 v82, v100, v101
    v_cvt_pk_bf16_f32 v83, v102, v103
    v_pk_fma_f32 v[104:105], v[60:61], v[42:43], v[104:105] op_sel_hi:[0,1,1]
    v_pk_fma_f32 v[106:107], v[60:61], v[44:45], v[106:107] op_sel_hi:[0,1,1]
    v_pk_mul_f32 v[104:105], v[104:105], v[60:61] op_sel:[0,1]
    v_pk_mul_f32 v[106:107], v[106:107], v[60:61] op_sel:[0,1]
    v_cvt_pk_bf16_f32 v84, v104, v105
    v_cvt_pk_bf16_f32 v85, v106, v107
    v_pk_fma_f32 v[108:109], v[60:61], v[46:47], v[108:109] op_sel_hi:[0,1,1]
    v_pk_fma_f32 v[110:111], v[60:61], v[48:49], v[110:111] op_sel_hi:[0,1,1]
    v_pk_mul_f32 v[108:109], v[108:109], v[60:61] op_sel:[0,1]
    v_pk_mul_f32 v[110:111], v[110:111], v[60:61] op_sel:[0,1]
    v_cvt_pk_bf16_f32 v86, v108, v109
    v_cvt_pk_bf16_f32 v87, v110, v111
    v_pk_fma_f32 v[112:113], v[60:61], v[240:241], v[112:113] op_sel_hi:[0,1,1]
    v_pk_fma_f32 v[114:115], v[60:61], v[242:243], v[114:115] op_sel_hi:[0,1,1]
    v_pk_mul_f32 v[112:113], v[112:113], v[60:61] op_sel:[0,1]
    v_pk_mul_f32 v[114:115], v[114:115], v[60:61] op_sel:[0,1]
    v_cvt_pk_bf16_f32 v88, v112, v113
    v_cvt_pk_bf16_f32 v89, v114, v115
    v_pk_fma_f32 v[116:117], v[60:61], v[244:245], v[116:117] op_sel_hi:[0,1,1]
    v_pk_fma_f32 v[118:119], v[60:61], v[246:247], v[118:119] op_sel_hi:[0,1,1]
    v_pk_mul_f32 v[116:117], v[116:117], v[60:61] op_sel:[0,1]
    v_pk_mul_f32 v[118:119], v[118:119], v[60:61] op_sel:[0,1]
    v_cvt_pk_bf16_f32 v90, v116, v117
    v_cvt_pk_bf16_f32 v91, v118, v119
    v_pk_fma_f32 v[120:121], v[60:61], v[248:249], v[120:121] op_sel_hi:[0,1,1]
    v_pk_fma_f32 v[122:123], v[60:61], v[250:251], v[122:123] op_sel_hi:[0,1,1]
    v_pk_mul_f32 v[120:121], v[120:121], v[60:61] op_sel:[0,1]
    v_pk_mul_f32 v[122:123], v[122:123], v[60:61] op_sel:[0,1]
    v_cvt_pk_bf16_f32 v92, v120, v121
    v_cvt_pk_bf16_f32 v93, v122, v123
    v_pk_fma_f32 v[124:125], v[60:61], v[252:253], v[124:125] op_sel_hi:[0,1,1]
    v_pk_fma_f32 v[126:127], v[60:61], v[254:255], v[126:127] op_sel_hi:[0,1,1]
    v_pk_mul_f32 v[124:125], v[124:125], v[60:61] op_sel:[0,1]
    v_pk_mul_f32 v[126:127], v[126:127], v[60:61] op_sel:[0,1]
    v_cvt_pk_bf16_f32 v94, v124, v125
    v_cvt_pk_bf16_f32 v95, v126, v127
    v_pk_fma_f32 v[128:129], v[2:3], v[34:35], v[128:129] op_sel_hi:[0,1,1]
    v_pk_fma_f32 v[130:131], v[2:3], v[36:37], v[130:131] op_sel_hi:[0,1,1]
    v_pk_mul_f32 v[128:129], v[128:129], v[2:3] op_sel:[0,1]
    v_pk_mul_f32 v[130:131], v[130:131], v[2:3] op_sel:[0,1]
    v_cvt_pk_bf16_f32 v96, v128, v129
    v_cvt_pk_bf16_f32 v97, v130, v131
    v_pk_fma_f32 v[132:133], v[2:3], v[38:39], v[132:133] op_sel_hi:[0,1,1]
    v_pk_fma_f32 v[134:135], v[2:3], v[40:41], v[134:135] op_sel_hi:[0,1,1]
    v_pk_mul_f32 v[132:133], v[132:133], v[2:3] op_sel:[0,1]
    v_pk_mul_f32 v[134:135], v[134:135], v[2:3] op_sel:[0,1]
    v_cvt_pk_bf16_f32 v98, v132, v133
    v_cvt_pk_bf16_f32 v99, v134, v135
    v_pk_fma_f32 v[136:137], v[2:3], v[42:43], v[136:137] op_sel_hi:[0,1,1]
    v_pk_fma_f32 v[138:139], v[2:3], v[44:45], v[138:139] op_sel_hi:[0,1,1]
    v_pk_mul_f32 v[136:137], v[136:137], v[2:3] op_sel:[0,1]
    v_pk_mul_f32 v[138:139], v[138:139], v[2:3] op_sel:[0,1]
    v_cvt_pk_bf16_f32 v100, v136, v137
    v_cvt_pk_bf16_f32 v101, v138, v139
    v_pk_fma_f32 v[140:141], v[2:3], v[46:47], v[140:141] op_sel_hi:[0,1,1]
    v_pk_fma_f32 v[142:143], v[2:3], v[48:49], v[142:143] op_sel_hi:[0,1,1]
    v_pk_mul_f32 v[140:141], v[140:141], v[2:3] op_sel:[0,1]
    v_pk_mul_f32 v[142:143], v[142:143], v[2:3] op_sel:[0,1]
    v_cvt_pk_bf16_f32 v102, v140, v141
    v_cvt_pk_bf16_f32 v103, v142, v143
    v_pk_fma_f32 v[144:145], v[2:3], v[240:241], v[144:145] op_sel_hi:[0,1,1]
    v_pk_fma_f32 v[146:147], v[2:3], v[242:243], v[146:147] op_sel_hi:[0,1,1]
    v_pk_mul_f32 v[144:145], v[144:145], v[2:3] op_sel:[0,1]
    v_pk_mul_f32 v[146:147], v[146:147], v[2:3] op_sel:[0,1]
    v_cvt_pk_bf16_f32 v104, v144, v145
    v_cvt_pk_bf16_f32 v105, v146, v147
    v_pk_fma_f32 v[148:149], v[2:3], v[244:245], v[148:149] op_sel_hi:[0,1,1]
    v_pk_fma_f32 v[150:151], v[2:3], v[246:247], v[150:151] op_sel_hi:[0,1,1]
    v_pk_mul_f32 v[148:149], v[148:149], v[2:3] op_sel:[0,1]
    v_pk_mul_f32 v[150:151], v[150:151], v[2:3] op_sel:[0,1]
    v_cvt_pk_bf16_f32 v106, v148, v149
    v_cvt_pk_bf16_f32 v107, v150, v151
    v_pk_fma_f32 v[152:153], v[2:3], v[248:249], v[152:153] op_sel_hi:[0,1,1]
    v_pk_fma_f32 v[154:155], v[2:3], v[250:251], v[154:155] op_sel_hi:[0,1,1]
    v_pk_mul_f32 v[152:153], v[152:153], v[2:3] op_sel:[0,1]
    v_pk_mul_f32 v[154:155], v[154:155], v[2:3] op_sel:[0,1]
    v_cvt_pk_bf16_f32 v108, v152, v153
    v_cvt_pk_bf16_f32 v109, v154, v155
    v_pk_fma_f32 v[156:157], v[2:3], v[252:253], v[156:157] op_sel_hi:[0,1,1]
    v_pk_fma_f32 v[158:159], v[2:3], v[254:255], v[158:159] op_sel_hi:[0,1,1]
    v_pk_mul_f32 v[156:157], v[156:157], v[2:3] op_sel:[0,1]
    v_pk_mul_f32 v[158:159], v[158:159], v[2:3] op_sel:[0,1]
    v_cvt_pk_bf16_f32 v110, v156, v157
    v_cvt_pk_bf16_f32 v111, v158, v159
    v_pk_fma_f32 v[160:161], v[12:13], v[34:35], v[160:161] op_sel_hi:[0,1,1]
    v_pk_fma_f32 v[162:163], v[12:13], v[36:37], v[162:163] op_sel_hi:[0,1,1]
    v_pk_mul_f32 v[160:161], v[160:161], v[12:13] op_sel:[0,1]
    v_pk_mul_f32 v[162:163], v[162:163], v[12:13] op_sel:[0,1]
    v_cvt_pk_bf16_f32 v112, v160, v161
    v_cvt_pk_bf16_f32 v113, v162, v163
    v_pk_fma_f32 v[164:165], v[12:13], v[38:39], v[164:165] op_sel_hi:[0,1,1]
    v_pk_fma_f32 v[166:167], v[12:13], v[40:41], v[166:167] op_sel_hi:[0,1,1]
    v_pk_mul_f32 v[164:165], v[164:165], v[12:13] op_sel:[0,1]
    v_pk_mul_f32 v[166:167], v[166:167], v[12:13] op_sel:[0,1]
    v_cvt_pk_bf16_f32 v114, v164, v165
    v_cvt_pk_bf16_f32 v115, v166, v167
    v_pk_fma_f32 v[168:169], v[12:13], v[42:43], v[168:169] op_sel_hi:[0,1,1]
    v_pk_fma_f32 v[170:171], v[12:13], v[44:45], v[170:171] op_sel_hi:[0,1,1]
    v_pk_mul_f32 v[168:169], v[168:169], v[12:13] op_sel:[0,1]
    v_pk_mul_f32 v[170:171], v[170:171], v[12:13] op_sel:[0,1]
    v_cvt_pk_bf16_f32 v116, v168, v169
    v_cvt_pk_bf16_f32 v117, v170, v171
    v_pk_fma_f32 v[172:173], v[12:13], v[46:47], v[172:173] op_sel_hi:[0,1,1]
    v_pk_fma_f32 v[174:175], v[12:13], v[48:49], v[174:175] op_sel_hi:[0,1,1]
    v_pk_mul_f32 v[172:173], v[172:173], v[12:13] op_sel:[0,1]
    v_pk_mul_f32 v[174:175], v[174:175], v[12:13] op_sel:[0,1]
    v_cvt_pk_bf16_f32 v118, v172, v173
    v_cvt_pk_bf16_f32 v119, v174, v175
    v_pk_fma_f32 v[176:177], v[12:13], v[240:241], v[176:177] op_sel_hi:[0,1,1]
    v_pk_fma_f32 v[178:179], v[12:13], v[242:243], v[178:179] op_sel_hi:[0,1,1]
    v_pk_mul_f32 v[176:177], v[176:177], v[12:13] op_sel:[0,1]
    v_pk_mul_f32 v[178:179], v[178:179], v[12:13] op_sel:[0,1]
    v_cvt_pk_bf16_f32 v120, v176, v177
    v_cvt_pk_bf16_f32 v121, v178, v179
    v_pk_fma_f32 v[180:181], v[12:13], v[244:245], v[180:181] op_sel_hi:[0,1,1]
    v_pk_fma_f32 v[182:183], v[12:13], v[246:247], v[182:183] op_sel_hi:[0,1,1]
    v_pk_mul_f32 v[180:181], v[180:181], v[12:13] op_sel:[0,1]
    v_pk_mul_f32 v[182:183], v[182:183], v[12:13] op_sel:[0,1]
    v_cvt_pk_bf16_f32 v122, v180, v181
    v_cvt_pk_bf16_f32 v123, v182, v183
    v_pk_fma_f32 v[184:185], v[12:13], v[248:249], v[184:185] op_sel_hi:[0,1,1]
    v_pk_fma_f32 v[186:187], v[12:13], v[250:251], v[186:187] op_sel_hi:[0,1,1]
    v_pk_mul_f32 v[184:185], v[184:185], v[12:13] op_sel:[0,1]
    v_pk_mul_f32 v[186:187], v[186:187], v[12:13] op_sel:[0,1]
    v_cvt_pk_bf16_f32 v124, v184, v185
    v_cvt_pk_bf16_f32 v125, v186, v187
    v_pk_fma_f32 v[188:189], v[12:13], v[252:253], v[188:189] op_sel_hi:[0,1,1]
    v_pk_fma_f32 v[190:191], v[12:13], v[254:255], v[190:191] op_sel_hi:[0,1,1]
    v_pk_mul_f32 v[188:189], v[188:189], v[12:13] op_sel:[0,1]
    v_pk_mul_f32 v[190:191], v[190:191], v[12:13] op_sel:[0,1]
    v_cvt_pk_bf16_f32 v126, v188, v189
    v_cvt_pk_bf16_f32 v127, v190, v191
    ds_read_b128 v[160:163], v53 offset:512
    ds_read_b128 v[168:171], v53 offset:576
    ds_read_b128 v[176:179], v53 offset:640
    ds_read_b128 v[184:187], v53 offset:704
    v_accvgpr_read_b32 v240, a248
    v_accvgpr_read_b32 v241, a249
    v_lshlrev_b32 v164, 16, v240
    v_and_b32 v165, 0xffff0000, v240
    v_lshlrev_b32 v166, 16, v241
    v_and_b32 v167, 0xffff0000, v241
    v_accvgpr_read_b32 v240, a250
    v_accvgpr_read_b32 v241, a251
    v_lshlrev_b32 v172, 16, v240
    v_and_b32 v173, 0xffff0000, v240
    v_lshlrev_b32 v174, 16, v241
    v_and_b32 v175, 0xffff0000, v241
    v_accvgpr_read_b32 v240, a252
    v_accvgpr_read_b32 v241, a253
    v_lshlrev_b32 v180, 16, v240
    v_and_b32 v181, 0xffff0000, v240
    v_lshlrev_b32 v182, 16, v241
    v_and_b32 v183, 0xffff0000, v241
    v_accvgpr_read_b32 v240, a254
    v_accvgpr_read_b32 v241, a255
    v_lshlrev_b32 v188, 16, v240
    v_and_b32 v189, 0xffff0000, v240
    v_lshlrev_b32 v190, 16, v241
    v_and_b32 v191, 0xffff0000, v241
    s_mov_b32 s66, 0xbdd2d3e8
    s_mov_b32 s67, s66
    v_mov_b32 v8, 0xc0135761
    v_mov_b32 v9, 1.0
    s_waitcnt lgkmcnt(0)
    v_mfma_f32_16x16x32_bf16 v[128:131], a[128:131], v[64:67], 0
    v_fma_f32 v240, v59, v160, v164
    v_fma_f32 v241, v59, v161, v165
    v_mfma_f32_16x16x32_bf16 v[128:131], a[132:135], v[68:71], v[128:131]
    v_fma_f32 v242, v59, v162, v166
    v_fma_f32 v243, v59, v163, v167
    v_mfma_f32_16x16x32_bf16 v[128:131], a[136:139], v[72:75], v[128:131]
    v_fma_f32 v244, v59, v168, v172
    v_fma_f32 v245, v59, v169, v173
    v_mfma_f32_16x16x32_bf16 v[128:131], a[140:143], v[76:79], v[128:131]
    v_fma_f32 v246, v59, v170, v174
    v_fma_f32 v247, v59, v171, v175
    v_mfma_f32_16x16x32_bf16 v[132:135], a[144:147], v[64:67], 0
    v_fma_f32 v192, v58, v192, v240
    v_fma_f32 v193, v58, v193, v241
    v_mfma_f32_16x16x32_bf16 v[132:135], a[148:151], v[68:71], v[132:135]
    v_fma_f32 v194, v58, v194, v242
    v_fma_f32 v195, v58, v195, v243
    v_mfma_f32_16x16x32_bf16 v[132:135], a[152:155], v[72:75], v[132:135]
    v_fma_f32 v196, v58, v196, v244
    v_fma_f32 v197, v58, v197, v245
    v_mfma_f32_16x16x32_bf16 v[132:135], a[156:159], v[76:79], v[132:135]
    v_fma_f32 v198, v58, v198, v246
    v_fma_f32 v199, v58, v199, v247
    v_mfma_f32_16x16x32_bf16 v[136:139], a[128:131], v[80:83], 0
    v_mul_f32 v240, v192, v192
    v_mul_f32 v241, v193, v193
    v_mfma_f32_16x16x32_bf16 v[136:139], a[132:135], v[84:87], v[136:139]
    v_mul_f32 v242, v194, v194
    v_mul_f32 v243, v195, v195
    v_mfma_f32_16x16x32_bf16 v[136:139], a[136:139], v[88:91], v[136:139]
    v_mul_f32 v244, v196, v196
    v_mul_f32 v245, v197, v197
    v_mfma_f32_16x16x32_bf16 v[136:139], a[140:143], v[92:95], v[136:139]
    v_mul_f32 v246, v198, v198
    v_mul_f32 v247, v199, v199
    v_mfma_f32_16x16x32_bf16 v[140:143], a[144:147], v[80:83], 0
    v_fma_f32 v240, v240, s66, v8
    v_fma_f32 v241, v241, s66, v8
    v_mfma_f32_16x16x32_bf16 v[140:143], a[148:151], v[84:87], v[140:143]
    v_fma_f32 v242, v242, s66, v8
    v_fma_f32 v243, v243, s66, v8
    v_mfma_f32_16x16x32_bf16 v[140:143], a[152:155], v[88:91], v[140:143]
    v_fma_f32 v244, v244, s66, v8
    v_fma_f32 v245, v245, s66, v8
    v_mfma_f32_16x16x32_bf16 v[140:143], a[156:159], v[92:95], v[140:143]
    v_fma_f32 v246, v246, s66, v8
    v_fma_f32 v247, v247, s66, v8
    v_mfma_f32_16x16x32_bf16 v[144:147], a[128:131], v[96:99], 0
    v_mul_f32 v240, v240, v192
    v_mul_f32 v241, v241, v193
    v_mfma_f32_16x16x32_bf16 v[144:147], a[132:135], v[100:103], v[144:147]
    v_mul_f32 v242, v242, v194
    v_mul_f32 v243, v243, v195
    v_mfma_f32_16x16x32_bf16 v[144:147], a[136:139], v[104:107], v[144:147]
    v_mul_f32 v244, v244, v196
    v_mul_f32 v245, v245, v197
    v_mfma_f32_16x16x32_bf16 v[144:147], a[140:143], v[108:111], v[144:147]
    v_mul_f32 v246, v246, v198
    v_mul_f32 v247, v247, v199
    v_mfma_f32_16x16x32_bf16 v[148:151], a[144:147], v[96:99], 0
    v_exp_f32 v240, v240
    v_mfma_f32_16x16x32_bf16 v[148:151], a[148:151], v[100:103], v[148:151]
    v_exp_f32 v241, v241
    v_mfma_f32_16x16x32_bf16 v[148:151], a[152:155], v[104:107], v[148:151]
    v_exp_f32 v242, v242
    v_mfma_f32_16x16x32_bf16 v[148:151], a[156:159], v[108:111], v[148:151]
    v_exp_f32 v243, v243
    v_mfma_f32_16x16x32_bf16 v[152:155], a[128:131], v[112:115], 0
    v_exp_f32 v244, v244
    v_mfma_f32_16x16x32_bf16 v[152:155], a[132:135], v[116:119], v[152:155]
    v_exp_f32 v245, v245
    v_mfma_f32_16x16x32_bf16 v[152:155], a[136:139], v[120:123], v[152:155]
    v_exp_f32 v246, v246
    v_mfma_f32_16x16x32_bf16 v[152:155], a[140:143], v[124:127], v[152:155]
    v_exp_f32 v247, v247
    v_mfma_f32_16x16x32_bf16 v[156:159], a[144:147], v[112:115], 0
    v_add_f32 v240, 1.0, v240
    v_add_f32 v241, 1.0, v241
    v_mfma_f32_16x16x32_bf16 v[156:159], a[148:151], v[116:119], v[156:159]
    v_add_f32 v242, 1.0, v242
    v_add_f32 v243, 1.0, v243
    v_mfma_f32_16x16x32_bf16 v[156:159], a[152:155], v[120:123], v[156:159]
    v_add_f32 v244, 1.0, v244
    v_add_f32 v245, 1.0, v245
    v_mfma_f32_16x16x32_bf16 v[156:159], a[156:159], v[124:127], v[156:159]
    v_add_f32 v246, 1.0, v246
    v_add_f32 v247, 1.0, v247
    v_rcp_f32 v240, v240
    v_rcp_f32 v241, v241
    v_rcp_f32 v242, v242
    v_rcp_f32 v243, v243
    v_rcp_f32 v244, v244
    v_rcp_f32 v245, v245
    v_rcp_f32 v246, v246
    v_rcp_f32 v247, v247
    v_mul_f32 v192, v192, v240
    v_mul_f32 v193, v193, v241
    v_mul_f32 v194, v194, v242
    v_mul_f32 v195, v195, v243
    v_mul_f32 v196, v196, v244
    v_mul_f32 v197, v197, v245
    v_mul_f32 v198, v198, v246
    v_mul_f32 v199, v199, v247
    s_add_u32 s37, s80, 0
    s_mul_i32 s37, s37, 43
    s_add_u32 s37, s37, s29
    s_lshl_b32 s37, s37, 10
    v_cvt_pk_bf16_f32 v192, v192, v193
    v_cvt_pk_bf16_f32 v193, v194, v195
    v_cvt_pk_bf16_f32 v194, v196, v197
    v_cvt_pk_bf16_f32 v195, v198, v199
    buffer_store_dwordx4 v[192:195], v54, s[76:79], s37 offen sc1
    v_pk_fma_f32 v[240:241], v[62:63], v[160:161], v[164:165] op_sel:[1,0,0] op_sel_hi:[1,1,1]
    v_pk_fma_f32 v[242:243], v[62:63], v[162:163], v[166:167] op_sel:[1,0,0] op_sel_hi:[1,1,1]
    v_pk_fma_f32 v[244:245], v[62:63], v[168:169], v[172:173] op_sel:[1,0,0] op_sel_hi:[1,1,1]
    v_pk_fma_f32 v[246:247], v[62:63], v[170:171], v[174:175] op_sel:[1,0,0] op_sel_hi:[1,1,1]
    v_pk_fma_f32 v[200:201], v[62:63], v[200:201], v[240:241] op_sel_hi:[0,1,1]
    v_pk_fma_f32 v[202:203], v[62:63], v[202:203], v[242:243] op_sel_hi:[0,1,1]
    v_pk_fma_f32 v[204:205], v[62:63], v[204:205], v[244:245] op_sel_hi:[0,1,1]
    v_pk_fma_f32 v[206:207], v[62:63], v[206:207], v[246:247] op_sel_hi:[0,1,1]
    v_pk_mul_f32 v[240:241], v[200:201], v[200:201]
    v_pk_mul_f32 v[242:243], v[202:203], v[202:203]
    v_pk_mul_f32 v[244:245], v[204:205], v[204:205]
    v_pk_mul_f32 v[246:247], v[206:207], v[206:207]
    v_pk_fma_f32 v[240:241], v[240:241], s[66:67], v[8:9] op_sel_hi:[1,1,0]
    v_pk_fma_f32 v[242:243], v[242:243], s[66:67], v[8:9] op_sel_hi:[1,1,0]
    v_pk_fma_f32 v[244:245], v[244:245], s[66:67], v[8:9] op_sel_hi:[1,1,0]
    v_pk_fma_f32 v[246:247], v[246:247], s[66:67], v[8:9] op_sel_hi:[1,1,0]
    v_pk_mul_f32 v[240:241], v[240:241], v[200:201]
    v_pk_mul_f32 v[242:243], v[242:243], v[202:203]
    v_pk_mul_f32 v[244:245], v[244:245], v[204:205]
    v_pk_mul_f32 v[246:247], v[246:247], v[206:207]
    v_exp_f32 v240, v240
    v_exp_f32 v242, v242
    v_exp_f32 v244, v244
    v_exp_f32 v246, v246
    v_exp_f32 v241, v241
    v_exp_f32 v243, v243
    v_exp_f32 v245, v245
    v_exp_f32 v247, v247
    v_pk_add_f32 v[240:241], v[240:241], v[8:9] op_sel:[0,1]
    v_pk_add_f32 v[242:243], v[242:243], v[8:9] op_sel:[0,1]
    v_pk_add_f32 v[244:245], v[244:245], v[8:9] op_sel:[0,1]
    v_pk_add_f32 v[246:247], v[246:247], v[8:9] op_sel:[0,1]
    v_rcp_f32 v240, v240
    v_rcp_f32 v242, v242
    v_rcp_f32 v244, v244
    v_rcp_f32 v246, v246
    v_rcp_f32 v241, v241
    v_rcp_f32 v243, v243
    v_rcp_f32 v245, v245
    v_rcp_f32 v247, v247
    v_pk_mul_f32 v[200:201], v[200:201], v[240:241]
    v_pk_mul_f32 v[202:203], v[202:203], v[242:243]
    v_pk_mul_f32 v[204:205], v[204:205], v[244:245]
    v_pk_mul_f32 v[206:207], v[206:207], v[246:247]
    s_add_u32 s37, s80, 1
    s_mul_i32 s37, s37, 43
    s_add_u32 s37, s37, s29
    s_lshl_b32 s37, s37, 10
    v_cvt_pk_bf16_f32 v200, v200, v201
    v_cvt_pk_bf16_f32 v201, v202, v203
    v_cvt_pk_bf16_f32 v202, v204, v205
    v_cvt_pk_bf16_f32 v203, v206, v207
    buffer_store_dwordx4 v[200:203], v54, s[76:79], s37 offen sc1
    v_pk_fma_f32 v[240:241], v[4:5], v[160:161], v[164:165] op_sel:[1,0,0] op_sel_hi:[1,1,1]
    v_pk_fma_f32 v[242:243], v[4:5], v[162:163], v[166:167] op_sel:[1,0,0] op_sel_hi:[1,1,1]
    v_pk_fma_f32 v[244:245], v[4:5], v[168:169], v[172:173] op_sel:[1,0,0] op_sel_hi:[1,1,1]
    v_pk_fma_f32 v[246:247], v[4:5], v[170:171], v[174:175] op_sel:[1,0,0] op_sel_hi:[1,1,1]
    v_pk_fma_f32 v[208:209], v[4:5], v[208:209], v[240:241] op_sel_hi:[0,1,1]
    v_pk_fma_f32 v[210:211], v[4:5], v[210:211], v[242:243] op_sel_hi:[0,1,1]
    v_pk_fma_f32 v[212:213], v[4:5], v[212:213], v[244:245] op_sel_hi:[0,1,1]
    v_pk_fma_f32 v[214:215], v[4:5], v[214:215], v[246:247] op_sel_hi:[0,1,1]
    v_pk_mul_f32 v[240:241], v[208:209], v[208:209]
    v_pk_mul_f32 v[242:243], v[210:211], v[210:211]
    v_pk_mul_f32 v[244:245], v[212:213], v[212:213]
    v_pk_mul_f32 v[246:247], v[214:215], v[214:215]
    v_pk_fma_f32 v[240:241], v[240:241], s[66:67], v[8:9] op_sel_hi:[1,1,0]
    v_pk_fma_f32 v[242:243], v[242:243], s[66:67], v[8:9] op_sel_hi:[1,1,0]
    v_pk_fma_f32 v[244:245], v[244:245], s[66:67], v[8:9] op_sel_hi:[1,1,0]
    v_pk_fma_f32 v[246:247], v[246:247], s[66:67], v[8:9] op_sel_hi:[1,1,0]
    v_pk_mul_f32 v[240:241], v[240:241], v[208:209]
    v_pk_mul_f32 v[242:243], v[242:243], v[210:211]
    v_pk_mul_f32 v[244:245], v[244:245], v[212:213]
    v_pk_mul_f32 v[246:247], v[246:247], v[214:215]
    v_exp_f32 v240, v240
    v_exp_f32 v242, v242
    v_exp_f32 v244, v244
    v_exp_f32 v246, v246
    v_exp_f32 v241, v241
    v_exp_f32 v243, v243
    v_exp_f32 v245, v245
    v_exp_f32 v247, v247
    v_pk_add_f32 v[240:241], v[240:241], v[8:9] op_sel:[0,1]
    v_pk_add_f32 v[242:243], v[242:243], v[8:9] op_sel:[0,1]
    v_pk_add_f32 v[244:245], v[244:245], v[8:9] op_sel:[0,1]
    v_pk_add_f32 v[246:247], v[246:247], v[8:9] op_sel:[0,1]
    v_rcp_f32 v240, v240
    v_rcp_f32 v242, v242
    v_rcp_f32 v244, v244
    v_rcp_f32 v246, v246
    v_rcp_f32 v241, v241
    v_rcp_f32 v243, v243
    v_rcp_f32 v245, v245
    v_rcp_f32 v247, v247
    v_pk_mul_f32 v[208:209], v[208:209], v[240:241]
    v_pk_mul_f32 v[210:211], v[210:211], v[242:243]
    v_pk_mul_f32 v[212:213], v[212:213], v[244:245]
    v_pk_mul_f32 v[214:215], v[214:215], v[246:247]
    s_add_u32 s37, s81, 0
    s_mul_i32 s37, s37, 43
    s_add_u32 s37, s37, s29
    s_lshl_b32 s37, s37, 10
    v_cvt_pk_bf16_f32 v208, v208, v209
    v_cvt_pk_bf16_f32 v209, v210, v211
    v_cvt_pk_bf16_f32 v210, v212, v213
    v_cvt_pk_bf16_f32 v211, v214, v215
    buffer_store_dwordx4 v[208:211], v54, s[76:79], s37 offen sc1
    v_pk_fma_f32 v[240:241], v[14:15], v[160:161], v[164:165] op_sel:[1,0,0] op_sel_hi:[1,1,1]
    v_pk_fma_f32 v[242:243], v[14:15], v[162:163], v[166:167] op_sel:[1,0,0] op_sel_hi:[1,1,1]
    v_pk_fma_f32 v[244:245], v[14:15], v[168:169], v[172:173] op_sel:[1,0,0] op_sel_hi:[1,1,1]
    v_pk_fma_f32 v[246:247], v[14:15], v[170:171], v[174:175] op_sel:[1,0,0] op_sel_hi:[1,1,1]
    v_pk_fma_f32 v[216:217], v[14:15], v[216:217], v[240:241] op_sel_hi:[0,1,1]
    v_pk_fma_f32 v[218:219], v[14:15], v[218:219], v[242:243] op_sel_hi:[0,1,1]
    v_pk_fma_f32 v[220:221], v[14:15], v[220:221], v[244:245] op_sel_hi:[0,1,1]
    v_pk_fma_f32 v[222:223], v[14:15], v[222:223], v[246:247] op_sel_hi:[0,1,1]
    v_pk_mul_f32 v[240:241], v[216:217], v[216:217]
    v_pk_mul_f32 v[242:243], v[218:219], v[218:219]
    v_pk_mul_f32 v[244:245], v[220:221], v[220:221]
    v_pk_mul_f32 v[246:247], v[222:223], v[222:223]
    v_pk_fma_f32 v[240:241], v[240:241], s[66:67], v[8:9] op_sel_hi:[1,1,0]
    v_pk_fma_f32 v[242:243], v[242:243], s[66:67], v[8:9] op_sel_hi:[1,1,0]
    v_pk_fma_f32 v[244:245], v[244:245], s[66:67], v[8:9] op_sel_hi:[1,1,0]
    v_pk_fma_f32 v[246:247], v[246:247], s[66:67], v[8:9] op_sel_hi:[1,1,0]
    v_pk_mul_f32 v[240:241], v[240:241], v[216:217]
    v_pk_mul_f32 v[242:243], v[242:243], v[218:219]
    v_pk_mul_f32 v[244:245], v[244:245], v[220:221]
    v_pk_mul_f32 v[246:247], v[246:247], v[222:223]
    v_exp_f32 v240, v240
    v_exp_f32 v242, v242
    v_exp_f32 v244, v244
    v_exp_f32 v246, v246
    v_exp_f32 v241, v241
    v_exp_f32 v243, v243
    v_exp_f32 v245, v245
    v_exp_f32 v247, v247
    v_pk_add_f32 v[240:241], v[240:241], v[8:9] op_sel:[0,1]
    v_pk_add_f32 v[242:243], v[242:243], v[8:9] op_sel:[0,1]
    v_pk_add_f32 v[244:245], v[244:245], v[8:9] op_sel:[0,1]
    v_pk_add_f32 v[246:247], v[246:247], v[8:9] op_sel:[0,1]
    v_rcp_f32 v240, v240
    v_rcp_f32 v242, v242
    v_rcp_f32 v244, v244
    v_rcp_f32 v246, v246
    v_rcp_f32 v241, v241
    v_rcp_f32 v243, v243
    v_rcp_f32 v245, v245
    v_rcp_f32 v247, v247
    v_pk_mul_f32 v[216:217], v[216:217], v[240:241]
    v_pk_mul_f32 v[218:219], v[218:219], v[242:243]
    v_pk_mul_f32 v[220:221], v[220:221], v[244:245]
    v_pk_mul_f32 v[222:223], v[222:223], v[246:247]
    s_add_u32 s37, s81, 1
    s_mul_i32 s37, s37, 43
    s_add_u32 s37, s37, s29
    s_lshl_b32 s37, s37, 10
    v_cvt_pk_bf16_f32 v216, v216, v217
    v_cvt_pk_bf16_f32 v217, v218, v219
    v_cvt_pk_bf16_f32 v218, v220, v221
    v_cvt_pk_bf16_f32 v219, v222, v223
    buffer_store_dwordx4 v[216:219], v54, s[76:79], s37 offen sc1
    s_cmp_ge_u32 s29, 22
    s_cbranch_scc1 attn_noub
    v_pk_fma_f32 v[240:241], v[58:59], v[176:177], v[180:181] op_sel:[1,0,0] op_sel_hi:[1,1,1]
    v_pk_fma_f32 v[242:243], v[58:59], v[178:179], v[182:183] op_sel:[1,0,0] op_sel_hi:[1,1,1]
    v_pk_fma_f32 v[244:245], v[58:59], v[184:185], v[188:189] op_sel:[1,0,0] op_sel_hi:[1,1,1]
    v_pk_fma_f32 v[246:247], v[58:59], v[186:187], v[190:191] op_sel:[1,0,0] op_sel_hi:[1,1,1]
    v_pk_fma_f32 v[224:225], v[58:59], v[224:225], v[240:241] op_sel_hi:[0,1,1]
    v_pk_fma_f32 v[226:227], v[58:59], v[226:227], v[242:243] op_sel_hi:[0,1,1]
    v_pk_fma_f32 v[228:229], v[58:59], v[228:229], v[244:245] op_sel_hi:[0,1,1]
    v_pk_fma_f32 v[230:231], v[58:59], v[230:231], v[246:247] op_sel_hi:[0,1,1]
    v_pk_mul_f32 v[240:241], v[224:225], v[224:225]
    v_pk_mul_f32 v[242:243], v[226:227], v[226:227]
    v_pk_mul_f32 v[244:245], v[228:229], v[228:229]
    v_pk_mul_f32 v[246:247], v[230:231], v[230:231]
    v_pk_fma_f32 v[240:241], v[240:241], s[66:67], v[8:9] op_sel_hi:[1,1,0]
    v_pk_fma_f32 v[242:243], v[242:243], s[66:67], v[8:9] op_sel_hi:[1,1,0]
    v_pk_fma_f32 v[244:245], v[244:245], s[66:67], v[8:9] op_sel_hi:[1,1,0]
    v_pk_fma_f32 v[246:247], v[246:247], s[66:67], v[8:9] op_sel_hi:[1,1,0]
    v_pk_mul_f32 v[240:241], v[240:241], v[224:225]
    v_pk_mul_f32 v[242:243], v[242:243], v[226:227]
    v_pk_mul_f32 v[244:245], v[244:245], v[228:229]
    v_pk_mul_f32 v[246:247], v[246:247], v[230:231]
    v_exp_f32 v240, v240
    v_exp_f32 v242, v242
    v_exp_f32 v244, v244
    v_exp_f32 v246, v246
    v_exp_f32 v241, v241
    v_exp_f32 v243, v243
    v_exp_f32 v245, v245
    v_exp_f32 v247, v247
    v_pk_add_f32 v[240:241], v[240:241], v[8:9] op_sel:[0,1]
    v_pk_add_f32 v[242:243], v[242:243], v[8:9] op_sel:[0,1]
    v_pk_add_f32 v[244:245], v[244:245], v[8:9] op_sel:[0,1]
    v_pk_add_f32 v[246:247], v[246:247], v[8:9] op_sel:[0,1]
    v_rcp_f32 v240, v240
    v_rcp_f32 v242, v242
    v_rcp_f32 v244, v244
    v_rcp_f32 v246, v246
    v_rcp_f32 v241, v241
    v_rcp_f32 v243, v243
    v_rcp_f32 v245, v245
    v_rcp_f32 v247, v247
    v_pk_mul_f32 v[224:225], v[224:225], v[240:241]
    v_pk_mul_f32 v[226:227], v[226:227], v[242:243]
    v_pk_mul_f32 v[228:229], v[228:229], v[244:245]
    v_pk_mul_f32 v[230:231], v[230:231], v[246:247]
    s_add_u32 s37, s80, 0
    s_mul_i32 s37, s37, 43
    s_add_u32 s37, s37, s82
    s_lshl_b32 s37, s37, 10
    v_cvt_pk_bf16_f32 v224, v224, v225
    v_cvt_pk_bf16_f32 v225, v226, v227
    v_cvt_pk_bf16_f32 v226, v228, v229
    v_cvt_pk_bf16_f32 v227, v230, v231
    buffer_store_dwordx4 v[224:227], v54, s[76:79], s37 offen sc1
    v_pk_fma_f32 v[240:241], v[62:63], v[176:177], v[180:181] op_sel:[1,0,0] op_sel_hi:[1,1,1]
    v_pk_fma_f32 v[242:243], v[62:63], v[178:179], v[182:183] op_sel:[1,0,0] op_sel_hi:[1,1,1]
    v_pk_fma_f32 v[244:245], v[62:63], v[184:185], v[188:189] op_sel:[1,0,0] op_sel_hi:[1,1,1]
    v_pk_fma_f32 v[246:247], v[62:63], v[186:187], v[190:191] op_sel:[1,0,0] op_sel_hi:[1,1,1]
    v_pk_fma_f32 v[232:233], v[62:63], v[232:233], v[240:241] op_sel_hi:[0,1,1]
    v_pk_fma_f32 v[234:235], v[62:63], v[234:235], v[242:243] op_sel_hi:[0,1,1]
    v_pk_fma_f32 v[236:237], v[62:63], v[236:237], v[244:245] op_sel_hi:[0,1,1]
    v_pk_fma_f32 v[238:239], v[62:63], v[238:239], v[246:247] op_sel_hi:[0,1,1]
    v_pk_mul_f32 v[240:241], v[232:233], v[232:233]
    v_pk_mul_f32 v[242:243], v[234:235], v[234:235]
    v_pk_mul_f32 v[244:245], v[236:237], v[236:237]
    v_pk_mul_f32 v[246:247], v[238:239], v[238:239]
    v_pk_fma_f32 v[240:241], v[240:241], s[66:67], v[8:9] op_sel_hi:[1,1,0]
    v_pk_fma_f32 v[242:243], v[242:243], s[66:67], v[8:9] op_sel_hi:[1,1,0]
    v_pk_fma_f32 v[244:245], v[244:245], s[66:67], v[8:9] op_sel_hi:[1,1,0]
    v_pk_fma_f32 v[246:247], v[246:247], s[66:67], v[8:9] op_sel_hi:[1,1,0]
    v_pk_mul_f32 v[240:241], v[240:241], v[232:233]
    v_pk_mul_f32 v[242:243], v[242:243], v[234:235]
    v_pk_mul_f32 v[244:245], v[244:245], v[236:237]
    v_pk_mul_f32 v[246:247], v[246:247], v[238:239]
    v_exp_f32 v240, v240
    v_exp_f32 v242, v242
    v_exp_f32 v244, v244
    v_exp_f32 v246, v246
    v_exp_f32 v241, v241
    v_exp_f32 v243, v243
    v_exp_f32 v245, v245
    v_exp_f32 v247, v247
    v_pk_add_f32 v[240:241], v[240:241], v[8:9] op_sel:[0,1]
    v_pk_add_f32 v[242:243], v[242:243], v[8:9] op_sel:[0,1]
    v_pk_add_f32 v[244:245], v[244:245], v[8:9] op_sel:[0,1]
    v_pk_add_f32 v[246:247], v[246:247], v[8:9] op_sel:[0,1]
    v_rcp_f32 v240, v240
    v_rcp_f32 v242, v242
    v_rcp_f32 v244, v244
    v_rcp_f32 v246, v246
    v_rcp_f32 v241, v241
    v_rcp_f32 v243, v243
    v_rcp_f32 v245, v245
    v_rcp_f32 v247, v247
    v_pk_mul_f32 v[232:233], v[232:233], v[240:241]
    v_pk_mul_f32 v[234:235], v[234:235], v[242:243]
    v_pk_mul_f32 v[236:237], v[236:237], v[244:245]
    v_pk_mul_f32 v[238:239], v[238:239], v[246:247]
    s_add_u32 s37, s80, 1
    s_mul_i32 s37, s37, 43
    s_add_u32 s37, s37, s82
    s_lshl_b32 s37, s37, 10
    v_cvt_pk_bf16_f32 v232, v232, v233
    v_cvt_pk_bf16_f32 v233, v234, v235
    v_cvt_pk_bf16_f32 v234, v236, v237
    v_cvt_pk_bf16_f32 v235, v238, v239
    buffer_store_dwordx4 v[232:235], v54, s[76:79], s37 offen sc1
attn_noub:
    s_waitcnt vmcnt(4)
    s_barrier
    v_max3_f32 v50, v128, v129, v130
    v_max3_f32 v50, v50, v131, v132
    v_max3_f32 v50, v50, v133, v134
    v_max_f32 v50, v50, v135
    v_mov_b32 v51, v50
    s_nop 1
    v_permlane16_swap_b32 v50, v51
    v_max_f32 v50, v50, v51
    v_mov_b32 v51, v50
    s_nop 1
    v_permlane32_swap_b32 v50, v51
    v_max_f32 v50, v50, v51
    v_sub_f32 v224, 0, v50
    v_sub_f32 v225, 0, v50
    v_sub_f32 v226, 0, v50
    v_sub_f32 v227, 0, v50
    v_pk_add_f32 v[128:129], v[128:129], v[224:225]
    v_pk_add_f32 v[130:131], v[130:131], v[224:225]
    v_pk_add_f32 v[132:133], v[132:133], v[224:225]
    v_pk_add_f32 v[134:135], v[134:135], v[224:225]
    v_max3_f32 v50, v136, v137, v138
    v_max3_f32 v50, v50, v139, v140
    v_max3_f32 v50, v50, v141, v142
    v_max_f32 v50, v50, v143
    v_mov_b32 v51, v50
    s_nop 1
    v_permlane16_swap_b32 v50, v51
    v_max_f32 v50, v50, v51
    v_mov_b32 v51, v50
    s_nop 1
    v_permlane32_swap_b32 v50, v51
    v_max_f32 v50, v50, v51
    v_sub_f32 v228, 0, v50
    v_sub_f32 v229, 0, v50
    v_sub_f32 v230, 0, v50
    v_sub_f32 v231, 0, v50
    v_pk_add_f32 v[136:137], v[136:137], v[228:229]
    v_pk_add_f32 v[138:139], v[138:139], v[228:229]
    v_pk_add_f32 v[140:141], v[140:141], v[228:229]
    v_pk_add_f32 v[142:143], v[142:143], v[228:229]
    v_max3_f32 v50, v144, v145, v146
    v_max3_f32 v50, v50, v147, v148
    v_max3_f32 v50, v50, v149, v150
    v_max_f32 v50, v50, v151
    v_mov_b32 v51, v50
    s_nop 1
    v_permlane16_swap_b32 v50, v51
    v_max_f32 v50, v50, v51
    v_mov_b32 v51, v50
    s_nop 1
    v_permlane32_swap_b32 v50, v51
    v_max_f32 v50, v50, v51
    v_sub_f32 v232, 0, v50
    v_sub_f32 v233, 0, v50
    v_sub_f32 v234, 0, v50
    v_sub_f32 v235, 0, v50
    v_pk_add_f32 v[144:145], v[144:145], v[232:233]
    v_pk_add_f32 v[146:147], v[146:147], v[232:233]
    v_pk_add_f32 v[148:149], v[148:149], v[232:233]
    v_pk_add_f32 v[150:151], v[150:151], v[232:233]
    v_max3_f32 v50, v152, v153, v154
    v_max3_f32 v50, v50, v155, v156
    v_max3_f32 v50, v50, v157, v158
    v_max_f32 v50, v50, v159
    v_mov_b32 v51, v50
    s_nop 1
    v_permlane16_swap_b32 v50, v51
    v_max_f32 v50, v50, v51
    v_mov_b32 v51, v50
    s_nop 1
    v_permlane32_swap_b32 v50, v51
    v_max_f32 v50, v50, v51
    v_sub_f32 v236, 0, v50
    v_sub_f32 v237, 0, v50
    v_sub_f32 v238, 0, v50
    v_sub_f32 v239, 0, v50
    v_pk_add_f32 v[152:153], v[152:153], v[236:237]
    v_pk_add_f32 v[154:155], v[154:155], v[236:237]
    v_pk_add_f32 v[156:157], v[156:157], v[236:237]
    v_pk_add_f32 v[158:159], v[158:159], v[236:237]
    v_and_b32 v1, 3, v0
    v_cmp_eq_u32 vcc, 0, v1
    v_mov_b32 v1, 0x3f803f80
    v_mov_b32 v248, -1
    v_cndmask_b32 v244, 0, v1, vcc
    v_mov_b32 v249, -1
    v_cndmask_b32 v245, 0, v1, vcc
    v_mov_b32 v250, -1
    v_cndmask_b32 v246, 0, v1, vcc
    v_mov_b32 v251, -1
    v_cndmask_b32 v247, 0, v1, vcc
    v_mov_b32 v240, 0
    v_mov_b32 v241, 0
    v_mov_b32 v242, 0
    v_mov_b32 v243, 0
    v_mov_b32 v252, 0
    v_mov_b32 v253, 0
    v_mov_b32 v254, 0
    v_mov_b32 v255, 0
    v_mov_b32 v4, 0
    v_mov_b32 v5, 0
    v_mov_b32 v6, 0
    v_mov_b32 v7, 0
    v_mov_b32 v8, 0
    v_mov_b32 v9, 0
    v_mov_b32 v10, 0
    v_mov_b32 v11, 0
    s_add_u32 m0, s33, 49152
    s_add_u32 s31, s31, 16384
    s_nop 0
    buffer_load_dwordx4 v28, s[8:11], s31 offen offset:0  lds
    v_exp_f32 v34, v128
    s_nop 0
    buffer_load_dwordx4 v29, s[8:11], s31 offen offset:1024  lds
    v_exp_f32 v35, v129
    s_nop 0
    v_cvt_pk_bf16_f32 v192, v34, v35
    v_exp_f32 v36, v130
    v_exp_f32 v37, v131
    s_nop 0
    v_cvt_pk_bf16_f32 v193, v36, v37
    v_exp_f32 v34, v132
    s_nop 0
    ds_read_b128 a[128:131], v16 offset:8192
    v_exp_f32 v35, v133
    s_nop 0
    ds_read_b128 a[132:135], v17 offset:8192
    v_cvt_pk_bf16_f32 v194, v34, v35
    v_exp_f32 v36, v134
    s_nop 0
    ds_read_b128 a[136:139], v18 offset:8192
    v_exp_f32 v37, v135
    s_nop 0
    ds_read_b128 a[140:143], v19 offset:8192
    v_cvt_pk_bf16_f32 v195, v36, v37
    v_exp_f32 v34, v136
    s_nop 0
    ds_read_b128 a[144:147], v16 offset:12288
    s_nop 1
    v_mfma_f32_16x16x32_bf16 v[40:43], v[244:247], v[192:195], v[240:243]
    v_exp_f32 v35, v137
    s_nop 0
    ds_read_b128 a[148:151], v17 offset:12288
    v_cvt_pk_bf16_f32 v196, v34, v35
    v_exp_f32 v36, v138
    s_nop 0
    buffer_load_dwordx4 v30, s[8:11], s31 offen offset:2048  lds
    v_exp_f32 v37, v139
    s_nop 0
    ds_read_b128 a[152:155], v18 offset:12288
    v_cvt_pk_bf16_f32 v197, v36, v37
    v_exp_f32 v34, v140
    s_nop 0
    ds_read_b128 a[156:159], v19 offset:12288
    v_exp_f32 v35, v141
    s_nop 0
    ds_read_b64_tr_b16 a[160:161], v20 offset:0
    v_cvt_pk_bf16_f32 v198, v34, v35
    v_exp_f32 v36, v142
    s_nop 0
    ds_read_b64_tr_b16 a[162:163], v20 offset:4096
    v_exp_f32 v37, v143
    s_nop 0
    ds_read_b64_tr_b16 a[164:165], v21 offset:0
    v_cvt_pk_bf16_f32 v199, v36, v37
    v_exp_f32 v34, v144
    s_nop 0
    ds_read_b64_tr_b16 a[166:167], v21 offset:4096
    s_nop 1
    v_mfma_f32_16x16x32_bf16 v[44:47], v[244:247], v[196:199], v[252:255]
    v_exp_f32 v35, v145
    s_nop 0
    ds_read_b64_tr_b16 a[168:169], v22 offset:0
    v_cvt_pk_bf16_f32 v200, v34, v35
    v_exp_f32 v36, v146
    s_nop 0
    buffer_load_dwordx4 v31, s[8:11], s31 offen offset:3072  lds
    v_exp_f32 v37, v147
    s_nop 0
    v_cvt_pk_bf16_f32 v201, v36, v37
    s_waitcnt lgkmcnt(5)
    s_mov_b32 s35, 0
    s_branch attn_h1
.p2align 6
attn_loop:
    v_mfma_f32_16x16x32_bf16 v[128:131], a[128:131], v[64:67], v[224:227]
    v_exp_f32 v34, v180
    v_mfma_f32_16x16x32_bf16 v[128:131], a[132:135], v[68:71], v[128:131]
    s_add_u32 m0, s33, 49152
    ds_read_b64_tr_b16 a[170:171], v22 offset:61440
    v_mfma_f32_16x16x32_bf16 v[128:131], a[136:139], v[72:75], v[128:131]
    v_exp_f32 v35, v181
    v_mfma_f32_16x16x32_bf16 v[128:131], a[140:143], v[76:79], v[128:131]
    ds_read_b64_tr_b16 a[172:173], v23 offset:57344
    v_cvt_pk_bf16_f32 v218, v34, v35
    v_mfma_f32_16x16x32_bf16 v[132:135], a[144:147], v[64:67], v[224:227]
    v_exp_f32 v36, v182
    v_mfma_f32_16x16x32_bf16 v[132:135], a[148:151], v[68:71], v[132:135]
    s_add_u32 s31, s31, 16384
    ds_read_b64_tr_b16 a[174:175], v23 offset:61440
    v_mfma_f32_16x16x32_bf16 v[132:135], a[152:155], v[72:75], v[132:135]
    v_exp_f32 v37, v183
    v_mfma_f32_16x16x32_bf16 v[132:135], a[156:159], v[76:79], v[132:135]
    ds_read_b64_tr_b16 a[176:177], v24 offset:57344
    v_cvt_pk_bf16_f32 v219, v36, v37
    v_mfma_f32_16x16x32_bf16 v[136:139], a[128:131], v[80:83], v[228:231]
    v_exp_f32 v34, v184
    v_mfma_f32_16x16x32_bf16 v[136:139], a[132:135], v[84:87], v[136:139]
    ds_read_b64_tr_b16 a[178:179], v24 offset:61440
    v_mfma_f32_16x16x32_bf16 v[4:7], v[244:247], v[216:219], v[56:59]
    v_mfma_f32_16x16x32_bf16 v[136:139], a[136:139], v[88:91], v[136:139]
    v_exp_f32 v35, v185
    v_mfma_f32_16x16x32_bf16 v[136:139], a[140:143], v[92:95], v[136:139]
    ds_read_b64_tr_b16 a[180:181], v25 offset:57344
    v_cvt_pk_bf16_f32 v220, v34, v35
    v_mfma_f32_16x16x32_bf16 v[140:143], a[144:147], v[80:83], v[228:231]
    v_exp_f32 v36, v186
    v_mfma_f32_16x16x32_bf16 v[140:143], a[148:151], v[84:87], v[140:143]
    buffer_load_dwordx4 v28, s[8:11], s31 offen offset:0  lds
    v_mfma_f32_16x16x32_bf16 v[140:143], a[152:155], v[88:91], v[140:143]
    v_exp_f32 v37, v187
    v_mfma_f32_16x16x32_bf16 v[140:143], a[156:159], v[92:95], v[140:143]
    ds_read_b64_tr_b16 a[182:183], v25 offset:61440
    v_cvt_pk_bf16_f32 v221, v36, v37
    v_mfma_f32_16x16x32_bf16 v[144:147], a[128:131], v[96:99], v[232:235]
    v_exp_f32 v34, v188
    v_mfma_f32_16x16x32_bf16 v[144:147], a[132:135], v[100:103], v[144:147]
    ds_read_b64_tr_b16 a[184:185], v26 offset:57344
    v_max3_f32 v50, v240, v252, v4
    v_mfma_f32_16x16x32_bf16 v[144:147], a[136:139], v[104:107], v[144:147]
    v_exp_f32 v35, v189
    v_mfma_f32_16x16x32_bf16 v[144:147], a[140:143], v[108:111], v[144:147]
    ds_read_b64_tr_b16 a[186:187], v26 offset:61440
    v_cvt_pk_bf16_f32 v222, v34, v35
    v_mfma_f32_16x16x32_bf16 v[148:151], a[144:147], v[96:99], v[232:235]
    v_exp_f32 v36, v190
    v_mfma_f32_16x16x32_bf16 v[148:151], a[148:151], v[100:103], v[148:151]
    ds_read_b64_tr_b16 a[188:189], v27 offset:57344
    v_mfma_f32_16x16x32_bf16 v[148:151], a[152:155], v[104:107], v[148:151]
    v_exp_f32 v37, v191
    v_mfma_f32_16x16x32_bf16 v[148:151], a[156:159], v[108:111], v[148:151]
    ds_read_b64_tr_b16 a[190:191], v27 offset:61440
    v_cvt_pk_bf16_f32 v223, v36, v37
    v_mfma_f32_16x16x32_bf16 v[152:155], a[128:131], v[112:115], v[236:239]
    v_exp_f32 v34, v128
    v_mfma_f32_16x16x32_bf16 v[152:155], a[132:135], v[116:119], v[152:155]
    buffer_load_dwordx4 v29, s[8:11], s31 offen offset:1024  lds
    v_mfma_f32_16x16x32_bf16 v[8:11], v[244:247], v[220:223], v[60:63]
    v_mfma_f32_16x16x32_bf16 v[152:155], a[136:139], v[120:123], v[152:155]
    v_exp_f32 v35, v129
    v_mfma_f32_16x16x32_bf16 v[152:155], a[140:143], v[124:127], v[152:155]
    v_cvt_pk_bf16_f32 v192, v34, v35
    s_waitcnt lgkmcnt(0)
    v_mfma_f32_16x16x32_bf16 v[156:159], a[144:147], v[112:115], v[236:239]
    v_exp_f32 v36, v130
    v_mfma_f32_16x16x32_bf16 v[156:159], a[148:151], v[116:119], v[156:159]
    v_max_f32 v50, v50, v8
    v_cmp_nge_f32 vcc, s36, v50
    v_mfma_f32_16x16x32_bf16 v[156:159], a[152:155], v[120:123], v[156:159]
    v_exp_f32 v37, v131
    v_mfma_f32_16x16x32_bf16 v[156:159], a[156:159], v[124:127], v[156:159]
    v_cvt_pk_bf16_f32 v193, v36, v37
    s_cbranch_vccnz slow_0
resume_0:
    v_mfma_f32_16x16x32_bf16 a[0:3], a[160:163], v[208:211], a[0:3]
    v_exp_f32 v34, v132
    v_mfma_f32_16x16x32_bf16 a[32:35], a[160:163], v[212:215], a[32:35]
    ds_read_b128 a[128:131], v16 offset:8192
    v_mfma_f32_16x16x32_bf16 a[64:67], a[160:163], v[216:219], a[64:67]
    v_exp_f32 v35, v133
    v_mfma_f32_16x16x32_bf16 a[96:99], a[160:163], v[220:223], a[96:99]
    ds_read_b128 a[132:135], v17 offset:8192
    v_cvt_pk_bf16_f32 v194, v34, v35
    v_mfma_f32_16x16x32_bf16 a[4:7], a[164:167], v[208:211], a[4:7]
    v_exp_f32 v36, v134
    v_mfma_f32_16x16x32_bf16 a[36:39], a[164:167], v[212:215], a[36:39]
    ds_read_b128 a[136:139], v18 offset:8192
    v_mfma_f32_16x16x32_bf16 a[68:71], a[164:167], v[216:219], a[68:71]
    v_exp_f32 v37, v135
    v_mfma_f32_16x16x32_bf16 a[100:103], a[164:167], v[220:223], a[100:103]
    ds_read_b128 a[140:143], v19 offset:8192
    v_cvt_pk_bf16_f32 v195, v36, v37
    v_mfma_f32_16x16x32_bf16 a[8:11], a[168:171], v[208:211], a[8:11]
    v_exp_f32 v34, v136
    v_mfma_f32_16x16x32_bf16 a[40:43], a[168:171], v[212:215], a[40:43]
    ds_read_b128 a[144:147], v16 offset:12288
    v_mfma_f32_16x16x32_bf16 v[40:43], v[244:247], v[192:195], v[240:243]
    v_mfma_f32_16x16x32_bf16 a[72:75], a[168:171], v[216:219], a[72:75]
    v_exp_f32 v35, v137
    v_mfma_f32_16x16x32_bf16 a[104:107], a[168:171], v[220:223], a[104:107]
    ds_read_b128 a[148:151], v17 offset:12288
    v_cvt_pk_bf16_f32 v196, v34, v35
    v_mfma_f32_16x16x32_bf16 a[12:15], a[172:175], v[208:211], a[12:15]
    v_exp_f32 v36, v138
    v_mfma_f32_16x16x32_bf16 a[44:47], a[172:175], v[212:215], a[44:47]
    buffer_load_dwordx4 v30, s[8:11], s31 offen offset:2048  lds
    v_mfma_f32_16x16x32_bf16 a[76:79], a[172:175], v[216:219], a[76:79]
    v_exp_f32 v37, v139
    v_mfma_f32_16x16x32_bf16 a[108:111], a[172:175], v[220:223], a[108:111]
    ds_read_b128 a[152:155], v18 offset:12288
    v_cvt_pk_bf16_f32 v197, v36, v37
    v_mfma_f32_16x16x32_bf16 a[16:19], a[176:179], v[208:211], a[16:19]
    v_exp_f32 v34, v140
    v_mfma_f32_16x16x32_bf16 a[48:51], a[176:179], v[212:215], a[48:51]
    ds_read_b128 a[156:159], v19 offset:12288
    v_mfma_f32_16x16x32_bf16 a[80:83], a[176:179], v[216:219], a[80:83]
    v_exp_f32 v35, v141
    v_mfma_f32_16x16x32_bf16 a[112:115], a[176:179], v[220:223], a[112:115]
    ds_read_b64_tr_b16 a[160:161], v20 offset:0
    v_cvt_pk_bf16_f32 v198, v34, v35
    v_mfma_f32_16x16x32_bf16 a[20:23], a[180:183], v[208:211], a[20:23]
    v_exp_f32 v36, v142
    v_mfma_f32_16x16x32_bf16 a[52:55], a[180:183], v[212:215], a[52:55]
    ds_read_b64_tr_b16 a[162:163], v20 offset:4096
    v_mfma_f32_16x16x32_bf16 a[84:87], a[180:183], v[216:219], a[84:87]
    v_exp_f32 v37, v143
    v_mfma_f32_16x16x32_bf16 a[116:119], a[180:183], v[220:223], a[116:119]
    ds_read_b64_tr_b16 a[164:165], v21 offset:0
    v_cvt_pk_bf16_f32 v199, v36, v37
    v_mfma_f32_16x16x32_bf16 a[24:27], a[184:187], v[208:211], a[24:27]
    v_exp_f32 v34, v144
    v_mfma_f32_16x16x32_bf16 a[56:59], a[184:187], v[212:215], a[56:59]
    ds_read_b64_tr_b16 a[166:167], v21 offset:4096
    v_mfma_f32_16x16x32_bf16 v[44:47], v[244:247], v[196:199], v[252:255]
    v_mfma_f32_16x16x32_bf16 a[88:91], a[184:187], v[216:219], a[88:91]
    v_exp_f32 v35, v145
    v_mfma_f32_16x16x32_bf16 a[120:123], a[184:187], v[220:223], a[120:123]
    ds_read_b64_tr_b16 a[168:169], v22 offset:0
    v_cvt_pk_bf16_f32 v200, v34, v35
    v_mfma_f32_16x16x32_bf16 a[28:31], a[188:191], v[208:211], a[28:31]
    v_exp_f32 v36, v146
    v_mfma_f32_16x16x32_bf16 a[60:63], a[188:191], v[212:215], a[60:63]
    buffer_load_dwordx4 v31, s[8:11], s31 offen offset:3072  lds
    v_mfma_f32_16x16x32_bf16 a[92:95], a[188:191], v[216:219], a[92:95]
    v_exp_f32 v37, v147
    v_mfma_f32_16x16x32_bf16 a[124:127], a[188:191], v[220:223], a[124:127]
    v_cvt_pk_bf16_f32 v201, v36, v37
    s_waitcnt lgkmcnt(5)
attn_h1:
    v_mfma_f32_16x16x32_bf16 v[160:163], a[128:131], v[64:67], v[224:227]
    v_exp_f32 v34, v148
    v_mfma_f32_16x16x32_bf16 v[160:163], a[132:135], v[68:71], v[160:163]
    s_add_u32 m0, s34, 32768
    ds_read_b64_tr_b16 a[170:171], v22 offset:4096
    v_mfma_f32_16x16x32_bf16 v[160:163], a[136:139], v[72:75], v[160:163]
    v_exp_f32 v35, v149
    v_mfma_f32_16x16x32_bf16 v[160:163], a[140:143], v[76:79], v[160:163]
    ds_read_b64_tr_b16 a[172:173], v23 offset:0
    v_cvt_pk_bf16_f32 v202, v34, v35
    v_mfma_f32_16x16x32_bf16 v[164:167], a[144:147], v[64:67], v[224:227]
    v_exp_f32 v36, v150
    v_mfma_f32_16x16x32_bf16 v[164:167], a[148:151], v[68:71], v[164:167]
    s_add_u32 s32, s32, 16384
    ds_read_b64_tr_b16 a[174:175], v23 offset:4096
    v_mfma_f32_16x16x32_bf16 v[164:167], a[152:155], v[72:75], v[164:167]
    v_exp_f32 v37, v151
    v_mfma_f32_16x16x32_bf16 v[164:167], a[156:159], v[76:79], v[164:167]
    ds_read_b64_tr_b16 a[176:177], v24 offset:0
    v_cvt_pk_bf16_f32 v203, v36, v37
    v_mfma_f32_16x16x32_bf16 v[168:171], a[128:131], v[80:83], v[228:231]
    v_exp_f32 v34, v152
    v_mfma_f32_16x16x32_bf16 v[168:171], a[132:135], v[84:87], v[168:171]
    ds_read_b64_tr_b16 a[178:179], v24 offset:4096
    v_mfma_f32_16x16x32_bf16 v[56:59], v[244:247], v[200:203], v[4:7]
    v_mfma_f32_16x16x32_bf16 v[168:171], a[136:139], v[88:91], v[168:171]
    v_exp_f32 v35, v153
    v_mfma_f32_16x16x32_bf16 v[168:171], a[140:143], v[92:95], v[168:171]
    ds_read_b64_tr_b16 a[180:181], v25 offset:0
    v_cvt_pk_bf16_f32 v204, v34, v35
    v_mfma_f32_16x16x32_bf16 v[172:175], a[144:147], v[80:83], v[228:231]
    v_exp_f32 v36, v154
    v_mfma_f32_16x16x32_bf16 v[172:175], a[148:151], v[84:87], v[172:175]
    buffer_load_dwordx4 v32, s[12:15], s32 offen offset:0  lds
    v_mfma_f32_16x16x32_bf16 v[172:175], a[152:155], v[88:91], v[172:175]
    v_exp_f32 v37, v155
    v_mfma_f32_16x16x32_bf16 v[172:175], a[156:159], v[92:95], v[172:175]
    ds_read_b64_tr_b16 a[182:183], v25 offset:4096
    v_cvt_pk_bf16_f32 v205, v36, v37
    v_mfma_f32_16x16x32_bf16 v[176:179], a[128:131], v[96:99], v[232:235]
    v_exp_f32 v34, v156
    v_mfma_f32_16x16x32_bf16 v[176:179], a[132:135], v[100:103], v[176:179]
    ds_read_b64_tr_b16 a[184:185], v26 offset:0
    v_max3_f32 v50, v40, v44, v56
    v_mfma_f32_16x16x32_bf16 v[176:179], a[136:139], v[104:107], v[176:179]
    v_exp_f32 v35, v157
    v_mfma_f32_16x16x32_bf16 v[176:179], a[140:143], v[108:111], v[176:179]
    ds_read_b64_tr_b16 a[186:187], v26 offset:4096
    v_cvt_pk_bf16_f32 v206, v34, v35
    v_mfma_f32_16x16x32_bf16 v[180:183], a[144:147], v[96:99], v[232:235]
    v_exp_f32 v36, v158
    v_mfma_f32_16x16x32_bf16 v[180:183], a[148:151], v[100:103], v[180:183]
    ds_read_b64_tr_b16 a[188:189], v27 offset:0
    v_mfma_f32_16x16x32_bf16 v[180:183], a[152:155], v[104:107], v[180:183]
    v_exp_f32 v37, v159
    v_mfma_f32_16x16x32_bf16 v[180:183], a[156:159], v[108:111], v[180:183]
    ds_read_b64_tr_b16 a[190:191], v27 offset:4096
    v_cvt_pk_bf16_f32 v207, v36, v37
    v_mfma_f32_16x16x32_bf16 v[184:187], a[128:131], v[112:115], v[236:239]
    v_exp_f32 v34, v160
    v_mfma_f32_16x16x32_bf16 v[184:187], a[132:135], v[116:119], v[184:187]
    buffer_load_dwordx4 v33, s[12:15], s32 offen offset:1024  lds
    v_mfma_f32_16x16x32_bf16 v[60:63], v[244:247], v[204:207], v[8:11]
    v_mfma_f32_16x16x32_bf16 v[184:187], a[136:139], v[120:123], v[184:187]
    v_exp_f32 v35, v161
    v_mfma_f32_16x16x32_bf16 v[184:187], a[140:143], v[124:127], v[184:187]
    v_cvt_pk_bf16_f32 v208, v34, v35
    s_waitcnt lgkmcnt(0)
    v_mfma_f32_16x16x32_bf16 v[188:191], a[144:147], v[112:115], v[236:239]
    v_exp_f32 v36, v162
    v_mfma_f32_16x16x32_bf16 v[188:191], a[148:151], v[116:119], v[188:191]
    v_max_f32 v50, v50, v60
    v_cmp_nge_f32 vcc, s36, v50
    v_mfma_f32_16x16x32_bf16 v[188:191], a[152:155], v[120:123], v[188:191]
    v_exp_f32 v37, v163
    v_mfma_f32_16x16x32_bf16 v[188:191], a[156:159], v[124:127], v[188:191]
    v_cvt_pk_bf16_f32 v209, v36, v37
    s_cbranch_vccnz slow_1
resume_1:
    v_mfma_f32_16x16x32_bf16 a[0:3], a[160:163], v[192:195], a[0:3]
    v_exp_f32 v34, v164
    v_mfma_f32_16x16x32_bf16 a[32:35], a[160:163], v[196:199], a[32:35]
    ds_read_b128 a[128:131], v16 offset:16384
    v_mfma_f32_16x16x32_bf16 a[64:67], a[160:163], v[200:203], a[64:67]
    v_exp_f32 v35, v165
    v_mfma_f32_16x16x32_bf16 a[96:99], a[160:163], v[204:207], a[96:99]
    ds_read_b128 a[132:135], v17 offset:16384
    v_cvt_pk_bf16_f32 v210, v34, v35
    v_mfma_f32_16x16x32_bf16 a[4:7], a[164:167], v[192:195], a[4:7]
    v_exp_f32 v36, v166
    v_mfma_f32_16x16x32_bf16 a[36:39], a[164:167], v[196:199], a[36:39]
    ds_read_b128 a[136:139], v18 offset:16384
    v_mfma_f32_16x16x32_bf16 a[68:71], a[164:167], v[200:203], a[68:71]
    v_exp_f32 v37, v167
    v_mfma_f32_16x16x32_bf16 a[100:103], a[164:167], v[204:207], a[100:103]
    ds_read_b128 a[140:143], v19 offset:16384
    v_cvt_pk_bf16_f32 v211, v36, v37
    v_mfma_f32_16x16x32_bf16 a[8:11], a[168:171], v[192:195], a[8:11]
    v_exp_f32 v34, v168
    v_mfma_f32_16x16x32_bf16 a[40:43], a[168:171], v[196:199], a[40:43]
    ds_read_b128 a[144:147], v16 offset:20480
    v_mfma_f32_16x16x32_bf16 v[240:243], v[244:247], v[208:211], v[40:43]
    v_mfma_f32_16x16x32_bf16 a[72:75], a[168:171], v[200:203], a[72:75]
    v_exp_f32 v35, v169
    v_mfma_f32_16x16x32_bf16 a[104:107], a[168:171], v[204:207], a[104:107]
    ds_read_b128 a[148:151], v17 offset:20480
    v_cvt_pk_bf16_f32 v212, v34, v35
    v_mfma_f32_16x16x32_bf16 a[12:15], a[172:175], v[192:195], a[12:15]
    v_exp_f32 v36, v170
    v_mfma_f32_16x16x32_bf16 a[44:47], a[172:175], v[196:199], a[44:47]
    buffer_load_dwordx4 v32, s[12:15], s32 offen offset:2048  lds
    v_mfma_f32_16x16x32_bf16 a[76:79], a[172:175], v[200:203], a[76:79]
    v_exp_f32 v37, v171
    v_mfma_f32_16x16x32_bf16 a[108:111], a[172:175], v[204:207], a[108:111]
    ds_read_b128 a[152:155], v18 offset:20480
    v_cvt_pk_bf16_f32 v213, v36, v37
    v_mfma_f32_16x16x32_bf16 a[16:19], a[176:179], v[192:195], a[16:19]
    v_exp_f32 v34, v172
    v_mfma_f32_16x16x32_bf16 a[48:51], a[176:179], v[196:199], a[48:51]
    ds_read_b128 a[156:159], v19 offset:20480
    v_mfma_f32_16x16x32_bf16 a[80:83], a[176:179], v[200:203], a[80:83]
    v_exp_f32 v35, v173
    v_mfma_f32_16x16x32_bf16 a[112:115], a[176:179], v[204:207], a[112:115]
    ds_read_b64_tr_b16 a[160:161], v20 offset:8192
    v_cvt_pk_bf16_f32 v214, v34, v35
    v_mfma_f32_16x16x32_bf16 a[20:23], a[180:183], v[192:195], a[20:23]
    v_exp_f32 v36, v174
    v_mfma_f32_16x16x32_bf16 a[52:55], a[180:183], v[196:199], a[52:55]
    ds_read_b64_tr_b16 a[162:163], v20 offset:12288
    v_mfma_f32_16x16x32_bf16 a[84:87], a[180:183], v[200:203], a[84:87]
    v_exp_f32 v37, v175
    v_mfma_f32_16x16x32_bf16 a[116:119], a[180:183], v[204:207], a[116:119]
    ds_read_b64_tr_b16 a[164:165], v21 offset:8192
    v_cvt_pk_bf16_f32 v215, v36, v37
    v_mfma_f32_16x16x32_bf16 a[24:27], a[184:187], v[192:195], a[24:27]
    v_exp_f32 v34, v176
    v_mfma_f32_16x16x32_bf16 a[56:59], a[184:187], v[196:199], a[56:59]
    ds_read_b64_tr_b16 a[166:167], v21 offset:12288
    v_mfma_f32_16x16x32_bf16 v[252:255], v[244:247], v[212:215], v[44:47]
    v_mfma_f32_16x16x32_bf16 a[88:91], a[184:187], v[200:203], a[88:91]
    v_exp_f32 v35, v177
    v_mfma_f32_16x16x32_bf16 a[120:123], a[184:187], v[204:207], a[120:123]
    ds_read_b64_tr_b16 a[168:169], v22 offset:8192
    v_cvt_pk_bf16_f32 v216, v34, v35
    v_mfma_f32_16x16x32_bf16 a[28:31], a[188:191], v[192:195], a[28:31]
    v_exp_f32 v36, v178
    v_mfma_f32_16x16x32_bf16 a[60:63], a[188:191], v[196:199], a[60:63]
    buffer_load_dwordx4 v33, s[12:15], s32 offen offset:3072  lds
    v_mfma_f32_16x16x32_bf16 a[92:95], a[188:191], v[200:203], a[92:95]
    v_exp_f32 v37, v179
    v_mfma_f32_16x16x32_bf16 a[124:127], a[188:191], v[204:207], a[124:127]
    v_cvt_pk_bf16_f32 v217, v36, v37
    s_waitcnt vmcnt(8) lgkmcnt(5)
    s_barrier
    v_mfma_f32_16x16x32_bf16 v[128:131], a[128:131], v[64:67], v[224:227]
    v_exp_f32 v34, v180
    v_mfma_f32_16x16x32_bf16 v[128:131], a[132:135], v[68:71], v[128:131]
    s_add_u32 m0, s33, 0
    ds_read_b64_tr_b16 a[170:171], v22 offset:12288
    v_mfma_f32_16x16x32_bf16 v[128:131], a[136:139], v[72:75], v[128:131]
    v_exp_f32 v35, v181
    v_mfma_f32_16x16x32_bf16 v[128:131], a[140:143], v[76:79], v[128:131]
    ds_read_b64_tr_b16 a[172:173], v23 offset:8192
    v_cvt_pk_bf16_f32 v218, v34, v35
    v_mfma_f32_16x16x32_bf16 v[132:135], a[144:147], v[64:67], v[224:227]
    v_exp_f32 v36, v182
    v_mfma_f32_16x16x32_bf16 v[132:135], a[148:151], v[68:71], v[132:135]
    s_add_u32 s31, s31, 16384
    ds_read_b64_tr_b16 a[174:175], v23 offset:12288
    v_mfma_f32_16x16x32_bf16 v[132:135], a[152:155], v[72:75], v[132:135]
    v_exp_f32 v37, v183
    v_mfma_f32_16x16x32_bf16 v[132:135], a[156:159], v[76:79], v[132:135]
    ds_read_b64_tr_b16 a[176:177], v24 offset:8192
    v_cvt_pk_bf16_f32 v219, v36, v37
    v_mfma_f32_16x16x32_bf16 v[136:139], a[128:131], v[80:83], v[228:231]
    v_exp_f32 v34, v184
    v_mfma_f32_16x16x32_bf16 v[136:139], a[132:135], v[84:87], v[136:139]
    ds_read_b64_tr_b16 a[178:179], v24 offset:12288
    v_mfma_f32_16x16x32_bf16 v[4:7], v[244:247], v[216:219], v[56:59]
    v_mfma_f32_16x16x32_bf16 v[136:139], a[136:139], v[88:91], v[136:139]
    v_exp_f32 v35, v185
    v_mfma_f32_16x16x32_bf16 v[136:139], a[140:143], v[92:95], v[136:139]
    ds_read_b64_tr_b16 a[180:181], v25 offset:8192
    v_cvt_pk_bf16_f32 v220, v34, v35
    v_mfma_f32_16x16x32_bf16 v[140:143], a[144:147], v[80:83], v[228:231]
    v_exp_f32 v36, v186
    v_mfma_f32_16x16x32_bf16 v[140:143], a[148:151], v[84:87], v[140:143]
    buffer_load_dwordx4 v28, s[8:11], s31 offen offset:0  lds
    v_mfma_f32_16x16x32_bf16 v[140:143], a[152:155], v[88:91], v[140:143]
    v_exp_f32 v37, v187
    v_mfma_f32_16x16x32_bf16 v[140:143], a[156:159], v[92:95], v[140:143]
    ds_read_b64_tr_b16 a[182:183], v25 offset:12288
    v_cvt_pk_bf16_f32 v221, v36, v37
    v_mfma_f32_16x16x32_bf16 v[144:147], a[128:131], v[96:99], v[232:235]
    v_exp_f32 v34, v188
    v_mfma_f32_16x16x32_bf16 v[144:147], a[132:135], v[100:103], v[144:147]
    ds_read_b64_tr_b16 a[184:185], v26 offset:8192
    v_max3_f32 v50, v240, v252, v4
    v_mfma_f32_16x16x32_bf16 v[144:147], a[136:139], v[104:107], v[144:147]
    v_exp_f32 v35, v189
    v_mfma_f32_16x16x32_bf16 v[144:147], a[140:143], v[108:111], v[144:147]
    ds_read_b64_tr_b16 a[186:187], v26 offset:12288
    v_cvt_pk_bf16_f32 v222, v34, v35
    v_mfma_f32_16x16x32_bf16 v[148:151], a[144:147], v[96:99], v[232:235]
    v_exp_f32 v36, v190
    v_mfma_f32_16x16x32_bf16 v[148:151], a[148:151], v[100:103], v[148:151]
    ds_read_b64_tr_b16 a[188:189], v27 offset:8192
    v_mfma_f32_16x16x32_bf16 v[148:151], a[152:155], v[104:107], v[148:151]
    v_exp_f32 v37, v191
    v_mfma_f32_16x16x32_bf16 v[148:151], a[156:159], v[108:111], v[148:151]
    ds_read_b64_tr_b16 a[190:191], v27 offset:12288
    v_cvt_pk_bf16_f32 v223, v36, v37
    v_mfma_f32_16x16x32_bf16 v[152:155], a[128:131], v[112:115], v[236:239]
    v_exp_f32 v34, v128
    v_mfma_f32_16x16x32_bf16 v[152:155], a[132:135], v[116:119], v[152:155]
    buffer_load_dwordx4 v29, s[8:11], s31 offen offset:1024  lds
    v_mfma_f32_16x16x32_bf16 v[8:11], v[244:247], v[220:223], v[60:63]
    v_mfma_f32_16x16x32_bf16 v[152:155], a[136:139], v[120:123], v[152:155]
    v_exp_f32 v35, v129
    v_mfma_f32_16x16x32_bf16 v[152:155], a[140:143], v[124:127], v[152:155]
    v_cvt_pk_bf16_f32 v192, v34, v35
    s_waitcnt lgkmcnt(0)
    v_mfma_f32_16x16x32_bf16 v[156:159], a[144:147], v[112:115], v[236:239]
    v_exp_f32 v36, v130
    v_mfma_f32_16x16x32_bf16 v[156:159], a[148:151], v[116:119], v[156:159]
    v_max_f32 v50, v50, v8
    v_cmp_nge_f32 vcc, s36, v50
    v_mfma_f32_16x16x32_bf16 v[156:159], a[152:155], v[120:123], v[156:159]
    v_exp_f32 v37, v131
    v_mfma_f32_16x16x32_bf16 v[156:159], a[156:159], v[124:127], v[156:159]
    v_cvt_pk_bf16_f32 v193, v36, v37
    s_cbranch_vccnz slow_2
resume_2:
    v_mfma_f32_16x16x32_bf16 a[0:3], a[160:163], v[208:211], a[0:3]
    v_exp_f32 v34, v132
    v_mfma_f32_16x16x32_bf16 a[32:35], a[160:163], v[212:215], a[32:35]
    s_lshl_b32 s38, s35, 11
    ds_read_b128 a[128:131], v16 offset:24576
    v_mfma_f32_16x16x32_bf16 a[64:67], a[160:163], v[216:219], a[64:67]
    v_exp_f32 v35, v133
    v_mfma_f32_16x16x32_bf16 a[96:99], a[160:163], v[220:223], a[96:99]
    ds_read_b128 a[132:135], v17 offset:24576
    v_cvt_pk_bf16_f32 v194, v34, v35
    v_mfma_f32_16x16x32_bf16 a[4:7], a[164:167], v[208:211], a[4:7]
    v_exp_f32 v36, v134
    v_mfma_f32_16x16x32_bf16 a[36:39], a[164:167], v[212:215], a[36:39]
    ds_read_b128 a[136:139], v18 offset:24576
    v_mfma_f32_16x16x32_bf16 a[68:71], a[164:167], v[216:219], a[68:71]
    v_exp_f32 v37, v135
    v_mfma_f32_16x16x32_bf16 a[100:103], a[164:167], v[220:223], a[100:103]
    ds_read_b128 a[140:143], v19 offset:24576
    v_cvt_pk_bf16_f32 v195, v36, v37
    v_mfma_f32_16x16x32_bf16 a[8:11], a[168:171], v[208:211], a[8:11]
    v_exp_f32 v34, v136
    v_mfma_f32_16x16x32_bf16 a[40:43], a[168:171], v[212:215], a[40:43]
    ds_read_b128 a[144:147], v16 offset:28672
    v_mfma_f32_16x16x32_bf16 v[40:43], v[244:247], v[192:195], v[240:243]
    buffer_store_dwordx4 v[248:251], v54, s[4:7], s38 offen offset:0 sc1
    v_mfma_f32_16x16x32_bf16 a[72:75], a[168:171], v[216:219], a[72:75]
    v_exp_f32 v35, v137
    v_mfma_f32_16x16x32_bf16 a[104:107], a[168:171], v[220:223], a[104:107]
    ds_read_b128 a[148:151], v17 offset:28672
    v_cvt_pk_bf16_f32 v196, v34, v35
    v_mfma_f32_16x16x32_bf16 a[12:15], a[172:175], v[208:211], a[12:15]
    v_exp_f32 v36, v138
    v_mfma_f32_16x16x32_bf16 a[44:47], a[172:175], v[212:215], a[44:47]
    buffer_load_dwordx4 v30, s[8:11], s31 offen offset:2048  lds
    v_mfma_f32_16x16x32_bf16 a[76:79], a[172:175], v[216:219], a[76:79]
    v_exp_f32 v37, v139
    v_mfma_f32_16x16x32_bf16 a[108:111], a[172:175], v[220:223], a[108:111]
    ds_read_b128 a[152:155], v18 offset:28672
    v_cvt_pk_bf16_f32 v197, v36, v37
    v_mfma_f32_16x16x32_bf16 a[16:19], a[176:179], v[208:211], a[16:19]
    v_exp_f32 v34, v140
    v_mfma_f32_16x16x32_bf16 a[48:51], a[176:179], v[212:215], a[48:51]
    ds_read_b128 a[156:159], v19 offset:28672
    v_mfma_f32_16x16x32_bf16 a[80:83], a[176:179], v[216:219], a[80:83]
    v_exp_f32 v35, v141
    v_mfma_f32_16x16x32_bf16 a[112:115], a[176:179], v[220:223], a[112:115]
    ds_read_b64_tr_b16 a[160:161], v20 offset:16384
    v_cvt_pk_bf16_f32 v198, v34, v35
    v_mfma_f32_16x16x32_bf16 a[20:23], a[180:183], v[208:211], a[20:23]
    v_exp_f32 v36, v142
    v_mfma_f32_16x16x32_bf16 a[52:55], a[180:183], v[212:215], a[52:55]
    ds_read_b64_tr_b16 a[162:163], v20 offset:20480
    v_mfma_f32_16x16x32_bf16 a[84:87], a[180:183], v[216:219], a[84:87]
    v_exp_f32 v37, v143
    v_mfma_f32_16x16x32_bf16 a[116:119], a[180:183], v[220:223], a[116:119]
    ds_read_b64_tr_b16 a[164:165], v21 offset:16384
    v_cvt_pk_bf16_f32 v199, v36, v37
    v_mfma_f32_16x16x32_bf16 a[24:27], a[184:187], v[208:211], a[24:27]
    v_exp_f32 v34, v144
    v_mfma_f32_16x16x32_bf16 a[56:59], a[184:187], v[212:215], a[56:59]
    ds_read_b64_tr_b16 a[166:167], v21 offset:20480
    v_mfma_f32_16x16x32_bf16 v[44:47], v[244:247], v[196:199], v[252:255]
    v_mfma_f32_16x16x32_bf16 a[88:91], a[184:187], v[216:219], a[88:91]
    v_exp_f32 v35, v145
    v_mfma_f32_16x16x32_bf16 a[120:123], a[184:187], v[220:223], a[120:123]
    ds_read_b64_tr_b16 a[168:169], v22 offset:16384
    v_cvt_pk_bf16_f32 v200, v34, v35
    v_mfma_f32_16x16x32_bf16 a[28:31], a[188:191], v[208:211], a[28:31]
    v_exp_f32 v36, v146
    v_mfma_f32_16x16x32_bf16 a[60:63], a[188:191], v[212:215], a[60:63]
    buffer_load_dwordx4 v31, s[8:11], s31 offen offset:3072  lds
    v_mfma_f32_16x16x32_bf16 a[92:95], a[188:191], v[216:219], a[92:95]
    v_exp_f32 v37, v147
    v_mfma_f32_16x16x32_bf16 a[124:127], a[188:191], v[220:223], a[124:127]
    v_cvt_pk_bf16_f32 v201, v36, v37
    s_waitcnt lgkmcnt(5)
    v_mfma_f32_16x16x32_bf16 v[160:163], a[128:131], v[64:67], v[224:227]
    v_exp_f32 v34, v148
    v_mfma_f32_16x16x32_bf16 v[160:163], a[132:135], v[68:71], v[160:163]
    s_add_u32 m0, s34, 49152
    ds_read_b64_tr_b16 a[170:171], v22 offset:20480
    v_mfma_f32_16x16x32_bf16 v[160:163], a[136:139], v[72:75], v[160:163]
    v_exp_f32 v35, v149
    v_mfma_f32_16x16x32_bf16 v[160:163], a[140:143], v[76:79], v[160:163]
    ds_read_b64_tr_b16 a[172:173], v23 offset:16384
    v_cvt_pk_bf16_f32 v202, v34, v35
    v_mfma_f32_16x16x32_bf16 v[164:167], a[144:147], v[64:67], v[224:227]
    v_exp_f32 v36, v150
    v_mfma_f32_16x16x32_bf16 v[164:167], a[148:151], v[68:71], v[164:167]
    s_add_u32 s32, s32, 16384
    ds_read_b64_tr_b16 a[174:175], v23 offset:20480
    v_mfma_f32_16x16x32_bf16 v[164:167], a[152:155], v[72:75], v[164:167]
    v_exp_f32 v37, v151
    v_mfma_f32_16x16x32_bf16 v[164:167], a[156:159], v[76:79], v[164:167]
    ds_read_b64_tr_b16 a[176:177], v24 offset:16384
    v_cvt_pk_bf16_f32 v203, v36, v37
    v_mfma_f32_16x16x32_bf16 v[168:171], a[128:131], v[80:83], v[228:231]
    v_exp_f32 v34, v152
    v_mfma_f32_16x16x32_bf16 v[168:171], a[132:135], v[84:87], v[168:171]
    ds_read_b64_tr_b16 a[178:179], v24 offset:20480
    v_mfma_f32_16x16x32_bf16 v[56:59], v[244:247], v[200:203], v[4:7]
    v_mfma_f32_16x16x32_bf16 v[168:171], a[136:139], v[88:91], v[168:171]
    v_exp_f32 v35, v153
    v_mfma_f32_16x16x32_bf16 v[168:171], a[140:143], v[92:95], v[168:171]
    ds_read_b64_tr_b16 a[180:181], v25 offset:16384
    v_cvt_pk_bf16_f32 v204, v34, v35
    v_mfma_f32_16x16x32_bf16 v[172:175], a[144:147], v[80:83], v[228:231]
    v_exp_f32 v36, v154
    v_mfma_f32_16x16x32_bf16 v[172:175], a[148:151], v[84:87], v[172:175]
    buffer_load_dwordx4 v32, s[12:15], s32 offen offset:0  lds
    v_mfma_f32_16x16x32_bf16 v[172:175], a[152:155], v[88:91], v[172:175]
    v_exp_f32 v37, v155
    v_mfma_f32_16x16x32_bf16 v[172:175], a[156:159], v[92:95], v[172:175]
    ds_read_b64_tr_b16 a[182:183], v25 offset:20480
    v_cvt_pk_bf16_f32 v205, v36, v37
    v_mfma_f32_16x16x32_bf16 v[176:179], a[128:131], v[96:99], v[232:235]
    v_exp_f32 v34, v156
    v_mfma_f32_16x16x32_bf16 v[176:179], a[132:135], v[100:103], v[176:179]
    ds_read_b64_tr_b16 a[184:185], v26 offset:16384
    v_max3_f32 v50, v40, v44, v56
    v_mfma_f32_16x16x32_bf16 v[176:179], a[136:139], v[104:107], v[176:179]
    v_exp_f32 v35, v157
    v_mfma_f32_16x16x32_bf16 v[176:179], a[140:143], v[108:111], v[176:179]
    ds_read_b64_tr_b16 a[186:187], v26 offset:20480
    v_cvt_pk_bf16_f32 v206, v34, v35
    v_mfma_f32_16x16x32_bf16 v[180:183], a[144:147], v[96:99], v[232:235]
    v_exp_f32 v36, v158
    v_mfma_f32_16x16x32_bf16 v[180:183], a[148:151], v[100:103], v[180:183]
    ds_read_b64_tr_b16 a[188:189], v27 offset:16384
    v_mfma_f32_16x16x32_bf16 v[180:183], a[152:155], v[104:107], v[180:183]
    v_exp_f32 v37, v159
    v_mfma_f32_16x16x32_bf16 v[180:183], a[156:159], v[108:111], v[180:183]
    ds_read_b64_tr_b16 a[190:191], v27 offset:20480
    v_cvt_pk_bf16_f32 v207, v36, v37
    v_mfma_f32_16x16x32_bf16 v[184:187], a[128:131], v[112:115], v[236:239]
    v_exp_f32 v34, v160
    v_mfma_f32_16x16x32_bf16 v[184:187], a[132:135], v[116:119], v[184:187]
    buffer_load_dwordx4 v33, s[12:15], s32 offen offset:1024  lds
    v_mfma_f32_16x16x32_bf16 v[60:63], v[244:247], v[204:207], v[8:11]
    v_mfma_f32_16x16x32_bf16 v[184:187], a[136:139], v[120:123], v[184:187]
    v_exp_f32 v35, v161
    v_mfma_f32_16x16x32_bf16 v[184:187], a[140:143], v[124:127], v[184:187]
    v_cvt_pk_bf16_f32 v208, v34, v35
    s_waitcnt lgkmcnt(0)
    v_mfma_f32_16x16x32_bf16 v[188:191], a[144:147], v[112:115], v[236:239]
    v_exp_f32 v36, v162
    v_mfma_f32_16x16x32_bf16 v[188:191], a[148:151], v[116:119], v[188:191]
    v_max_f32 v50, v50, v60
    v_cmp_nge_f32 vcc, s36, v50
    v_mfma_f32_16x16x32_bf16 v[188:191], a[152:155], v[120:123], v[188:191]
    v_exp_f32 v37, v163
    v_mfma_f32_16x16x32_bf16 v[188:191], a[156:159], v[124:127], v[188:191]
    v_cvt_pk_bf16_f32 v209, v36, v37
    s_cbranch_vccnz slow_3
resume_3:
    v_mfma_f32_16x16x32_bf16 a[0:3], a[160:163], v[192:195], a[0:3]
    v_exp_f32 v34, v164
    v_mfma_f32_16x16x32_bf16 a[32:35], a[160:163], v[196:199], a[32:35]
    ds_read_b128 a[128:131], v16 offset:32768
    v_mfma_f32_16x16x32_bf16 a[64:67], a[160:163], v[200:203], a[64:67]
    v_exp_f32 v35, v165
    v_mfma_f32_16x16x32_bf16 a[96:99], a[160:163], v[204:207], a[96:99]
    ds_read_b128 a[132:135], v17 offset:32768
    v_cvt_pk_bf16_f32 v210, v34, v35
    v_mfma_f32_16x16x32_bf16 a[4:7], a[164:167], v[192:195], a[4:7]
    v_exp_f32 v36, v166
    v_mfma_f32_16x16x32_bf16 a[36:39], a[164:167], v[196:199], a[36:39]
    ds_read_b128 a[136:139], v18 offset:32768
    v_mfma_f32_16x16x32_bf16 a[68:71], a[164:167], v[200:203], a[68:71]
    v_exp_f32 v37, v167
    v_mfma_f32_16x16x32_bf16 a[100:103], a[164:167], v[204:207], a[100:103]
    ds_read_b128 a[140:143], v19 offset:32768
    v_cvt_pk_bf16_f32 v211, v36, v37
    v_mfma_f32_16x16x32_bf16 a[8:11], a[168:171], v[192:195], a[8:11]
    v_exp_f32 v34, v168
    v_mfma_f32_16x16x32_bf16 a[40:43], a[168:171], v[196:199], a[40:43]
    ds_read_b128 a[144:147], v16 offset:36864
    v_mfma_f32_16x16x32_bf16 v[240:243], v[244:247], v[208:211], v[40:43]
    v_mfma_f32_16x16x32_bf16 a[72:75], a[168:171], v[200:203], a[72:75]
    v_exp_f32 v35, v169
    v_mfma_f32_16x16x32_bf16 a[104:107], a[168:171], v[204:207], a[104:107]
    ds_read_b128 a[148:151], v17 offset:36864
    v_cvt_pk_bf16_f32 v212, v34, v35
    v_mfma_f32_16x16x32_bf16 a[12:15], a[172:175], v[192:195], a[12:15]
    v_exp_f32 v36, v170
    v_mfma_f32_16x16x32_bf16 a[44:47], a[172:175], v[196:199], a[44:47]
    buffer_load_dwordx4 v32, s[12:15], s32 offen offset:2048  lds
    v_mfma_f32_16x16x32_bf16 a[76:79], a[172:175], v[200:203], a[76:79]
    v_exp_f32 v37, v171
    v_mfma_f32_16x16x32_bf16 a[108:111], a[172:175], v[204:207], a[108:111]
    ds_read_b128 a[152:155], v18 offset:36864
    v_cvt_pk_bf16_f32 v213, v36, v37
    v_mfma_f32_16x16x32_bf16 a[16:19], a[176:179], v[192:195], a[16:19]
    v_exp_f32 v34, v172
    v_mfma_f32_16x16x32_bf16 a[48:51], a[176:179], v[196:199], a[48:51]
    ds_read_b128 a[156:159], v19 offset:36864
    v_mfma_f32_16x16x32_bf16 a[80:83], a[176:179], v[200:203], a[80:83]
    v_exp_f32 v35, v173
    v_mfma_f32_16x16x32_bf16 a[112:115], a[176:179], v[204:207], a[112:115]
    ds_read_b64_tr_b16 a[160:161], v20 offset:24576
    v_cvt_pk_bf16_f32 v214, v34, v35
    v_mfma_f32_16x16x32_bf16 a[20:23], a[180:183], v[192:195], a[20:23]
    v_exp_f32 v36, v174
    v_mfma_f32_16x16x32_bf16 a[52:55], a[180:183], v[196:199], a[52:55]
    ds_read_b64_tr_b16 a[162:163], v20 offset:28672
    v_mfma_f32_16x16x32_bf16 a[84:87], a[180:183], v[200:203], a[84:87]
    v_exp_f32 v37, v175
    v_mfma_f32_16x16x32_bf16 a[116:119], a[180:183], v[204:207], a[116:119]
    ds_read_b64_tr_b16 a[164:165], v21 offset:24576
    v_cvt_pk_bf16_f32 v215, v36, v37
    v_mfma_f32_16x16x32_bf16 a[24:27], a[184:187], v[192:195], a[24:27]
    v_exp_f32 v34, v176
    v_mfma_f32_16x16x32_bf16 a[56:59], a[184:187], v[196:199], a[56:59]
    ds_read_b64_tr_b16 a[166:167], v21 offset:28672
    v_mfma_f32_16x16x32_bf16 v[252:255], v[244:247], v[212:215], v[44:47]
    v_mfma_f32_16x16x32_bf16 a[88:91], a[184:187], v[200:203], a[88:91]
    v_exp_f32 v35, v177
    v_mfma_f32_16x16x32_bf16 a[120:123], a[184:187], v[204:207], a[120:123]
    ds_read_b64_tr_b16 a[168:169], v22 offset:24576
    v_cvt_pk_bf16_f32 v216, v34, v35
    v_mfma_f32_16x16x32_bf16 a[28:31], a[188:191], v[192:195], a[28:31]
    v_exp_f32 v36, v178
    v_mfma_f32_16x16x32_bf16 a[60:63], a[188:191], v[196:199], a[60:63]
    buffer_load_dwordx4 v33, s[12:15], s32 offen offset:3072  lds
    v_mfma_f32_16x16x32_bf16 a[92:95], a[188:191], v[200:203], a[92:95]
    v_exp_f32 v37, v179
    v_mfma_f32_16x16x32_bf16 a[124:127], a[188:191], v[204:207], a[124:127]
    v_cvt_pk_bf16_f32 v217, v36, v37
    s_waitcnt vmcnt(9) lgkmcnt(5)
    s_barrier
    v_mfma_f32_16x16x32_bf16 v[128:131], a[128:131], v[64:67], v[224:227]
    v_exp_f32 v34, v180
    v_mfma_f32_16x16x32_bf16 v[128:131], a[132:135], v[68:71], v[128:131]
    s_add_u32 m0, s33, 16384
    ds_read_b64_tr_b16 a[170:171], v22 offset:28672
    v_mfma_f32_16x16x32_bf16 v[128:131], a[136:139], v[72:75], v[128:131]
    v_exp_f32 v35, v181
    v_mfma_f32_16x16x32_bf16 v[128:131], a[140:143], v[76:79], v[128:131]
    ds_read_b64_tr_b16 a[172:173], v23 offset:24576
    v_cvt_pk_bf16_f32 v218, v34, v35
    v_mfma_f32_16x16x32_bf16 v[132:135], a[144:147], v[64:67], v[224:227]
    v_exp_f32 v36, v182
    v_mfma_f32_16x16x32_bf16 v[132:135], a[148:151], v[68:71], v[132:135]
    s_add_u32 s31, s31, 16384
    ds_read_b64_tr_b16 a[174:175], v23 offset:28672
    v_mfma_f32_16x16x32_bf16 v[132:135], a[152:155], v[72:75], v[132:135]
    v_exp_f32 v37, v183
    v_mfma_f32_16x16x32_bf16 v[132:135], a[156:159], v[76:79], v[132:135]
    ds_read_b64_tr_b16 a[176:177], v24 offset:24576
    v_cvt_pk_bf16_f32 v219, v36, v37
    v_mfma_f32_16x16x32_bf16 v[136:139], a[128:131], v[80:83], v[228:231]
    v_exp_f32 v34, v184
    v_mfma_f32_16x16x32_bf16 v[136:139], a[132:135], v[84:87], v[136:139]
    ds_read_b64_tr_b16 a[178:179], v24 offset:28672
    v_mfma_f32_16x16x32_bf16 v[4:7], v[244:247], v[216:219], v[56:59]
    v_mfma_f32_16x16x32_bf16 v[136:139], a[136:139], v[88:91], v[136:139]
    v_exp_f32 v35, v185
    v_mfma_f32_16x16x32_bf16 v[136:139], a[140:143], v[92:95], v[136:139]
    ds_read_b64_tr_b16 a[180:181], v25 offset:24576
    v_cvt_pk_bf16_f32 v220, v34, v35
    v_mfma_f32_16x16x32_bf16 v[140:143], a[144:147], v[80:83], v[228:231]
    v_exp_f32 v36, v186
    v_mfma_f32_16x16x32_bf16 v[140:143], a[148:151], v[84:87], v[140:143]
    buffer_load_dwordx4 v28, s[8:11], s31 offen offset:0  lds
    v_mfma_f32_16x16x32_bf16 v[140:143], a[152:155], v[88:91], v[140:143]
    v_exp_f32 v37, v187
    v_mfma_f32_16x16x32_bf16 v[140:143], a[156:159], v[92:95], v[140:143]
    ds_read_b64_tr_b16 a[182:183], v25 offset:28672
    v_cvt_pk_bf16_f32 v221, v36, v37
    v_mfma_f32_16x16x32_bf16 v[144:147], a[128:131], v[96:99], v[232:235]
    v_exp_f32 v34, v188
    v_mfma_f32_16x16x32_bf16 v[144:147], a[132:135], v[100:103], v[144:147]
    ds_read_b64_tr_b16 a[184:185], v26 offset:24576
    v_max3_f32 v50, v240, v252, v4
    v_mfma_f32_16x16x32_bf16 v[144:147], a[136:139], v[104:107], v[144:147]
    v_exp_f32 v35, v189
    v_mfma_f32_16x16x32_bf16 v[144:147], a[140:143], v[108:111], v[144:147]
    ds_read_b64_tr_b16 a[186:187], v26 offset:28672
    v_cvt_pk_bf16_f32 v222, v34, v35
    v_mfma_f32_16x16x32_bf16 v[148:151], a[144:147], v[96:99], v[232:235]
    v_exp_f32 v36, v190
    v_mfma_f32_16x16x32_bf16 v[148:151], a[148:151], v[100:103], v[148:151]
    ds_read_b64_tr_b16 a[188:189], v27 offset:24576
    v_mfma_f32_16x16x32_bf16 v[148:151], a[152:155], v[104:107], v[148:151]
    v_exp_f32 v37, v191
    v_mfma_f32_16x16x32_bf16 v[148:151], a[156:159], v[108:111], v[148:151]
    ds_read_b64_tr_b16 a[190:191], v27 offset:28672
    v_cvt_pk_bf16_f32 v223, v36, v37
    v_mfma_f32_16x16x32_bf16 v[152:155], a[128:131], v[112:115], v[236:239]
    v_exp_f32 v34, v128
    v_mfma_f32_16x16x32_bf16 v[152:155], a[132:135], v[116:119], v[152:155]
    buffer_load_dwordx4 v29, s[8:11], s31 offen offset:1024  lds
    v_mfma_f32_16x16x32_bf16 v[8:11], v[244:247], v[220:223], v[60:63]
    v_mfma_f32_16x16x32_bf16 v[152:155], a[136:139], v[120:123], v[152:155]
    v_exp_f32 v35, v129
    v_mfma_f32_16x16x32_bf16 v[152:155], a[140:143], v[124:127], v[152:155]
    v_cvt_pk_bf16_f32 v192, v34, v35
    s_waitcnt lgkmcnt(0)
    v_mfma_f32_16x16x32_bf16 v[156:159], a[144:147], v[112:115], v[236:239]
    v_exp_f32 v36, v130
    v_mfma_f32_16x16x32_bf16 v[156:159], a[148:151], v[116:119], v[156:159]
    v_max_f32 v50, v50, v8
    v_cmp_nge_f32 vcc, s36, v50
    v_mfma_f32_16x16x32_bf16 v[156:159], a[152:155], v[120:123], v[156:159]
    v_exp_f32 v37, v131
    v_mfma_f32_16x16x32_bf16 v[156:159], a[156:159], v[124:127], v[156:159]
    v_cvt_pk_bf16_f32 v193, v36, v37
    s_cbranch_vccnz slow_4
resume_4:
    v_mfma_f32_16x16x32_bf16 a[0:3], a[160:163], v[208:211], a[0:3]
    v_exp_f32 v34, v132
    v_mfma_f32_16x16x32_bf16 a[32:35], a[160:163], v[212:215], a[32:35]
    ds_read_b128 a[128:131], v16 offset:40960
    v_mfma_f32_16x16x32_bf16 a[64:67], a[160:163], v[216:219], a[64:67]
    v_exp_f32 v35, v133
    v_mfma_f32_16x16x32_bf16 a[96:99], a[160:163], v[220:223], a[96:99]
    ds_read_b128 a[132:135], v17 offset:40960
    v_cvt_pk_bf16_f32 v194, v34, v35
    v_mfma_f32_16x16x32_bf16 a[4:7], a[164:167], v[208:211], a[4:7]
    v_exp_f32 v36, v134
    v_mfma_f32_16x16x32_bf16 a[36:39], a[164:167], v[212:215], a[36:39]
    ds_read_b128 a[136:139], v18 offset:40960
    v_mfma_f32_16x16x32_bf16 a[68:71], a[164:167], v[216:219], a[68:71]
    v_exp_f32 v37, v135
    v_mfma_f32_16x16x32_bf16 a[100:103], a[164:167], v[220:223], a[100:103]
    ds_read_b128 a[140:143], v19 offset:40960
    v_cvt_pk_bf16_f32 v195, v36, v37
    v_mfma_f32_16x16x32_bf16 a[8:11], a[168:171], v[208:211], a[8:11]
    v_exp_f32 v34, v136
    v_mfma_f32_16x16x32_bf16 a[40:43], a[168:171], v[212:215], a[40:43]
    ds_read_b128 a[144:147], v16 offset:45056
    v_mfma_f32_16x16x32_bf16 v[40:43], v[244:247], v[192:195], v[240:243]
    buffer_store_dwordx4 v[248:251], v54, s[4:7], s38 offen offset:1024 sc1
    v_mfma_f32_16x16x32_bf16 a[72:75], a[168:171], v[216:219], a[72:75]
    v_exp_f32 v35, v137
    v_mfma_f32_16x16x32_bf16 a[104:107], a[168:171], v[220:223], a[104:107]
    ds_read_b128 a[148:151], v17 offset:45056
    v_cvt_pk_bf16_f32 v196, v34, v35
    v_mfma_f32_16x16x32_bf16 a[12:15], a[172:175], v[208:211], a[12:15]
    v_exp_f32 v36, v138
    v_mfma_f32_16x16x32_bf16 a[44:47], a[172:175], v[212:215], a[44:47]
    buffer_load_dwordx4 v30, s[8:11], s31 offen offset:2048  lds
    v_mfma_f32_16x16x32_bf16 a[76:79], a[172:175], v[216:219], a[76:79]
    v_exp_f32 v37, v139
    v_mfma_f32_16x16x32_bf16 a[108:111], a[172:175], v[220:223], a[108:111]
    ds_read_b128 a[152:155], v18 offset:45056
    v_cvt_pk_bf16_f32 v197, v36, v37
    v_mfma_f32_16x16x32_bf16 a[16:19], a[176:179], v[208:211], a[16:19]
    v_exp_f32 v34, v140
    v_mfma_f32_16x16x32_bf16 a[48:51], a[176:179], v[212:215], a[48:51]
    ds_read_b128 a[156:159], v19 offset:45056
    v_mfma_f32_16x16x32_bf16 a[80:83], a[176:179], v[216:219], a[80:83]
    v_exp_f32 v35, v141
    v_mfma_f32_16x16x32_bf16 a[112:115], a[176:179], v[220:223], a[112:115]
    ds_read_b64_tr_b16 a[160:161], v20 offset:32768
    v_cvt_pk_bf16_f32 v198, v34, v35
    v_mfma_f32_16x16x32_bf16 a[20:23], a[180:183], v[208:211], a[20:23]
    v_exp_f32 v36, v142
    v_mfma_f32_16x16x32_bf16 a[52:55], a[180:183], v[212:215], a[52:55]
    ds_read_b64_tr_b16 a[162:163], v20 offset:36864
    v_mfma_f32_16x16x32_bf16 a[84:87], a[180:183], v[216:219], a[84:87]
    v_exp_f32 v37, v143
    v_mfma_f32_16x16x32_bf16 a[116:119], a[180:183], v[220:223], a[116:119]
    ds_read_b64_tr_b16 a[164:165], v21 offset:32768
    v_cvt_pk_bf16_f32 v199, v36, v37
    v_mfma_f32_16x16x32_bf16 a[24:27], a[184:187], v[208:211], a[24:27]
    v_exp_f32 v34, v144
    v_mfma_f32_16x16x32_bf16 a[56:59], a[184:187], v[212:215], a[56:59]
    ds_read_b64_tr_b16 a[166:167], v21 offset:36864
    v_mfma_f32_16x16x32_bf16 v[44:47], v[244:247], v[196:199], v[252:255]
    v_mfma_f32_16x16x32_bf16 a[88:91], a[184:187], v[216:219], a[88:91]
    v_exp_f32 v35, v145
    v_mfma_f32_16x16x32_bf16 a[120:123], a[184:187], v[220:223], a[120:123]
    ds_read_b64_tr_b16 a[168:169], v22 offset:32768
    v_cvt_pk_bf16_f32 v200, v34, v35
    v_mfma_f32_16x16x32_bf16 a[28:31], a[188:191], v[208:211], a[28:31]
    v_exp_f32 v36, v146
    v_mfma_f32_16x16x32_bf16 a[60:63], a[188:191], v[212:215], a[60:63]
    buffer_load_dwordx4 v31, s[8:11], s31 offen offset:3072  lds
    v_mfma_f32_16x16x32_bf16 a[92:95], a[188:191], v[216:219], a[92:95]
    v_exp_f32 v37, v147
    v_mfma_f32_16x16x32_bf16 a[124:127], a[188:191], v[220:223], a[124:127]
    v_cvt_pk_bf16_f32 v201, v36, v37
    s_waitcnt lgkmcnt(5)
    v_mfma_f32_16x16x32_bf16 v[160:163], a[128:131], v[64:67], v[224:227]
    v_exp_f32 v34, v148
    v_mfma_f32_16x16x32_bf16 v[160:163], a[132:135], v[68:71], v[160:163]
    s_add_u32 m0, s34, 0
    ds_read_b64_tr_b16 a[170:171], v22 offset:36864
    v_mfma_f32_16x16x32_bf16 v[160:163], a[136:139], v[72:75], v[160:163]
    v_exp_f32 v35, v149
    v_mfma_f32_16x16x32_bf16 v[160:163], a[140:143], v[76:79], v[160:163]
    ds_read_b64_tr_b16 a[172:173], v23 offset:32768
    v_cvt_pk_bf16_f32 v202, v34, v35
    v_mfma_f32_16x16x32_bf16 v[164:167], a[144:147], v[64:67], v[224:227]
    v_exp_f32 v36, v150
    v_mfma_f32_16x16x32_bf16 v[164:167], a[148:151], v[68:71], v[164:167]
    s_add_u32 s32, s32, 16384
    ds_read_b64_tr_b16 a[174:175], v23 offset:36864
    v_mfma_f32_16x16x32_bf16 v[164:167], a[152:155], v[72:75], v[164:167]
    v_exp_f32 v37, v151
    v_mfma_f32_16x16x32_bf16 v[164:167], a[156:159], v[76:79], v[164:167]
    ds_read_b64_tr_b16 a[176:177], v24 offset:32768
    v_cvt_pk_bf16_f32 v203, v36, v37
    v_mfma_f32_16x16x32_bf16 v[168:171], a[128:131], v[80:83], v[228:231]
    v_exp_f32 v34, v152
    v_mfma_f32_16x16x32_bf16 v[168:171], a[132:135], v[84:87], v[168:171]
    ds_read_b64_tr_b16 a[178:179], v24 offset:36864
    v_mfma_f32_16x16x32_bf16 v[56:59], v[244:247], v[200:203], v[4:7]
    v_mfma_f32_16x16x32_bf16 v[168:171], a[136:139], v[88:91], v[168:171]
    v_exp_f32 v35, v153
    v_mfma_f32_16x16x32_bf16 v[168:171], a[140:143], v[92:95], v[168:171]
    ds_read_b64_tr_b16 a[180:181], v25 offset:32768
    v_cvt_pk_bf16_f32 v204, v34, v35
    v_mfma_f32_16x16x32_bf16 v[172:175], a[144:147], v[80:83], v[228:231]
    v_exp_f32 v36, v154
    v_mfma_f32_16x16x32_bf16 v[172:175], a[148:151], v[84:87], v[172:175]
    buffer_load_dwordx4 v32, s[12:15], s32 offen offset:0  lds
    v_mfma_f32_16x16x32_bf16 v[172:175], a[152:155], v[88:91], v[172:175]
    v_exp_f32 v37, v155
    v_mfma_f32_16x16x32_bf16 v[172:175], a[156:159], v[92:95], v[172:175]
    ds_read_b64_tr_b16 a[182:183], v25 offset:36864
    v_cvt_pk_bf16_f32 v205, v36, v37
    v_mfma_f32_16x16x32_bf16 v[176:179], a[128:131], v[96:99], v[232:235]
    v_exp_f32 v34, v156
    v_mfma_f32_16x16x32_bf16 v[176:179], a[132:135], v[100:103], v[176:179]
    ds_read_b64_tr_b16 a[184:185], v26 offset:32768
    v_max3_f32 v50, v40, v44, v56
    v_mfma_f32_16x16x32_bf16 v[176:179], a[136:139], v[104:107], v[176:179]
    v_exp_f32 v35, v157
    v_mfma_f32_16x16x32_bf16 v[176:179], a[140:143], v[108:111], v[176:179]
    ds_read_b64_tr_b16 a[186:187], v26 offset:36864
    v_cvt_pk_bf16_f32 v206, v34, v35
    v_mfma_f32_16x16x32_bf16 v[180:183], a[144:147], v[96:99], v[232:235]
    v_exp_f32 v36, v158
    v_mfma_f32_16x16x32_bf16 v[180:183], a[148:151], v[100:103], v[180:183]
    ds_read_b64_tr_b16 a[188:189], v27 offset:32768
    v_mfma_f32_16x16x32_bf16 v[180:183], a[152:155], v[104:107], v[180:183]
    v_exp_f32 v37, v159
    v_mfma_f32_16x16x32_bf16 v[180:183], a[156:159], v[108:111], v[180:183]
    ds_read_b64_tr_b16 a[190:191], v27 offset:36864
    v_cvt_pk_bf16_f32 v207, v36, v37
    v_mfma_f32_16x16x32_bf16 v[184:187], a[128:131], v[112:115], v[236:239]
    v_exp_f32 v34, v160
    v_mfma_f32_16x16x32_bf16 v[184:187], a[132:135], v[116:119], v[184:187]
    buffer_load_dwordx4 v33, s[12:15], s32 offen offset:1024  lds
    v_mfma_f32_16x16x32_bf16 v[60:63], v[244:247], v[204:207], v[8:11]
    v_mfma_f32_16x16x32_bf16 v[184:187], a[136:139], v[120:123], v[184:187]
    v_exp_f32 v35, v161
    v_mfma_f32_16x16x32_bf16 v[184:187], a[140:143], v[124:127], v[184:187]
    v_cvt_pk_bf16_f32 v208, v34, v35
    s_waitcnt lgkmcnt(0)
    v_mfma_f32_16x16x32_bf16 v[188:191], a[144:147], v[112:115], v[236:239]
    v_exp_f32 v36, v162
    v_mfma_f32_16x16x32_bf16 v[188:191], a[148:151], v[116:119], v[188:191]
    v_max_f32 v50, v50, v60
    v_cmp_nge_f32 vcc, s36, v50
    v_mfma_f32_16x16x32_bf16 v[188:191], a[152:155], v[120:123], v[188:191]
    v_exp_f32 v37, v163
    v_mfma_f32_16x16x32_bf16 v[188:191], a[156:159], v[124:127], v[188:191]
    v_cvt_pk_bf16_f32 v209, v36, v37
    s_cbranch_vccnz slow_5
resume_5:
    v_mfma_f32_16x16x32_bf16 a[0:3], a[160:163], v[192:195], a[0:3]
    v_exp_f32 v34, v164
    v_mfma_f32_16x16x32_bf16 a[32:35], a[160:163], v[196:199], a[32:35]
    ds_read_b128 a[128:131], v16 offset:49152
    v_mfma_f32_16x16x32_bf16 a[64:67], a[160:163], v[200:203], a[64:67]
    v_exp_f32 v35, v165
    v_mfma_f32_16x16x32_bf16 a[96:99], a[160:163], v[204:207], a[96:99]
    ds_read_b128 a[132:135], v17 offset:49152
    v_cvt_pk_bf16_f32 v210, v34, v35
    v_mfma_f32_16x16x32_bf16 a[4:7], a[164:167], v[192:195], a[4:7]
    v_exp_f32 v36, v166
    v_mfma_f32_16x16x32_bf16 a[36:39], a[164:167], v[196:199], a[36:39]
    ds_read_b128 a[136:139], v18 offset:49152
    v_mfma_f32_16x16x32_bf16 a[68:71], a[164:167], v[200:203], a[68:71]
    v_exp_f32 v37, v167
    v_mfma_f32_16x16x32_bf16 a[100:103], a[164:167], v[204:207], a[100:103]
    ds_read_b128 a[140:143], v19 offset:49152
    v_cvt_pk_bf16_f32 v211, v36, v37
    v_mfma_f32_16x16x32_bf16 a[8:11], a[168:171], v[192:195], a[8:11]
    v_exp_f32 v34, v168
    v_mfma_f32_16x16x32_bf16 a[40:43], a[168:171], v[196:199], a[40:43]
    ds_read_b128 a[144:147], v16 offset:53248
    v_mfma_f32_16x16x32_bf16 v[240:243], v[244:247], v[208:211], v[40:43]
    v_mfma_f32_16x16x32_bf16 a[72:75], a[168:171], v[200:203], a[72:75]
    v_exp_f32 v35, v169
    v_mfma_f32_16x16x32_bf16 a[104:107], a[168:171], v[204:207], a[104:107]
    ds_read_b128 a[148:151], v17 offset:53248
    v_cvt_pk_bf16_f32 v212, v34, v35
    v_mfma_f32_16x16x32_bf16 a[12:15], a[172:175], v[192:195], a[12:15]
    v_exp_f32 v36, v170
    v_mfma_f32_16x16x32_bf16 a[44:47], a[172:175], v[196:199], a[44:47]
    buffer_load_dwordx4 v32, s[12:15], s32 offen offset:2048  lds
    v_mfma_f32_16x16x32_bf16 a[76:79], a[172:175], v[200:203], a[76:79]
    v_exp_f32 v37, v171
    v_mfma_f32_16x16x32_bf16 a[108:111], a[172:175], v[204:207], a[108:111]
    ds_read_b128 a[152:155], v18 offset:53248
    v_cvt_pk_bf16_f32 v213, v36, v37
    v_mfma_f32_16x16x32_bf16 a[16:19], a[176:179], v[192:195], a[16:19]
    v_exp_f32 v34, v172
    v_mfma_f32_16x16x32_bf16 a[48:51], a[176:179], v[196:199], a[48:51]
    ds_read_b128 a[156:159], v19 offset:53248
    v_mfma_f32_16x16x32_bf16 a[80:83], a[176:179], v[200:203], a[80:83]
    v_exp_f32 v35, v173
    v_mfma_f32_16x16x32_bf16 a[112:115], a[176:179], v[204:207], a[112:115]
    ds_read_b64_tr_b16 a[160:161], v20 offset:40960
    v_cvt_pk_bf16_f32 v214, v34, v35
    v_mfma_f32_16x16x32_bf16 a[20:23], a[180:183], v[192:195], a[20:23]
    v_exp_f32 v36, v174
    v_mfma_f32_16x16x32_bf16 a[52:55], a[180:183], v[196:199], a[52:55]
    ds_read_b64_tr_b16 a[162:163], v20 offset:45056
    v_mfma_f32_16x16x32_bf16 a[84:87], a[180:183], v[200:203], a[84:87]
    v_exp_f32 v37, v175
    v_mfma_f32_16x16x32_bf16 a[116:119], a[180:183], v[204:207], a[116:119]
    ds_read_b64_tr_b16 a[164:165], v21 offset:40960
    v_cvt_pk_bf16_f32 v215, v36, v37
    v_mfma_f32_16x16x32_bf16 a[24:27], a[184:187], v[192:195], a[24:27]
    v_exp_f32 v34, v176
    v_mfma_f32_16x16x32_bf16 a[56:59], a[184:187], v[196:199], a[56:59]
    ds_read_b64_tr_b16 a[166:167], v21 offset:45056
    v_mfma_f32_16x16x32_bf16 v[252:255], v[244:247], v[212:215], v[44:47]
    v_mfma_f32_16x16x32_bf16 a[88:91], a[184:187], v[200:203], a[88:91]
    v_exp_f32 v35, v177
    v_mfma_f32_16x16x32_bf16 a[120:123], a[184:187], v[204:207], a[120:123]
    ds_read_b64_tr_b16 a[168:169], v22 offset:40960
    v_cvt_pk_bf16_f32 v216, v34, v35
    v_mfma_f32_16x16x32_bf16 a[28:31], a[188:191], v[192:195], a[28:31]
    v_exp_f32 v36, v178
    v_mfma_f32_16x16x32_bf16 a[60:63], a[188:191], v[196:199], a[60:63]
    buffer_load_dwordx4 v33, s[12:15], s32 offen offset:3072  lds
    v_mfma_f32_16x16x32_bf16 a[92:95], a[188:191], v[200:203], a[92:95]
    v_exp_f32 v37, v179
    v_mfma_f32_16x16x32_bf16 a[124:127], a[188:191], v[204:207], a[124:127]
    v_cvt_pk_bf16_f32 v217, v36, v37
    s_waitcnt vmcnt(9) lgkmcnt(5)
    s_barrier
    v_mfma_f32_16x16x32_bf16 v[128:131], a[128:131], v[64:67], v[224:227]
    v_exp_f32 v34, v180
    v_mfma_f32_16x16x32_bf16 v[128:131], a[132:135], v[68:71], v[128:131]
    s_add_u32 m0, s33, 32768
    ds_read_b64_tr_b16 a[170:171], v22 offset:45056
    v_mfma_f32_16x16x32_bf16 v[128:131], a[136:139], v[72:75], v[128:131]
    v_exp_f32 v35, v181
    v_mfma_f32_16x16x32_bf16 v[128:131], a[140:143], v[76:79], v[128:131]
    ds_read_b64_tr_b16 a[172:173], v23 offset:40960
    v_cvt_pk_bf16_f32 v218, v34, v35
    v_mfma_f32_16x16x32_bf16 v[132:135], a[144:147], v[64:67], v[224:227]
    v_exp_f32 v36, v182
    v_mfma_f32_16x16x32_bf16 v[132:135], a[148:151], v[68:71], v[132:135]
    s_add_u32 s31, s31, 16384
    ds_read_b64_tr_b16 a[174:175], v23 offset:45056
    v_mfma_f32_16x16x32_bf16 v[132:135], a[152:155], v[72:75], v[132:135]
    v_exp_f32 v37, v183
    v_mfma_f32_16x16x32_bf16 v[132:135], a[156:159], v[76:79], v[132:135]
    ds_read_b64_tr_b16 a[176:177], v24 offset:40960
    v_cvt_pk_bf16_f32 v219, v36, v37
    v_mfma_f32_16x16x32_bf16 v[136:139], a[128:131], v[80:83], v[228:231]
    v_exp_f32 v34, v184
    v_mfma_f32_16x16x32_bf16 v[136:139], a[132:135], v[84:87], v[136:139]
    ds_read_b64_tr_b16 a[178:179], v24 offset:45056
    v_mfma_f32_16x16x32_bf16 v[4:7], v[244:247], v[216:219], v[56:59]
    v_mfma_f32_16x16x32_bf16 v[136:139], a[136:139], v[88:91], v[136:139]
    v_exp_f32 v35, v185
    v_mfma_f32_16x16x32_bf16 v[136:139], a[140:143], v[92:95], v[136:139]
    ds_read_b64_tr_b16 a[180:181], v25 offset:40960
    v_cvt_pk_bf16_f32 v220, v34, v35
    v_mfma_f32_16x16x32_bf16 v[140:143], a[144:147], v[80:83], v[228:231]
    v_exp_f32 v36, v186
    v_mfma_f32_16x16x32_bf16 v[140:143], a[148:151], v[84:87], v[140:143]
    buffer_load_dwordx4 v28, s[8:11], s31 offen offset:0  lds
    v_mfma_f32_16x16x32_bf16 v[140:143], a[152:155], v[88:91], v[140:143]
    v_exp_f32 v37, v187
    v_mfma_f32_16x16x32_bf16 v[140:143], a[156:159], v[92:95], v[140:143]
    ds_read_b64_tr_b16 a[182:183], v25 offset:45056
    v_cvt_pk_bf16_f32 v221, v36, v37
    v_mfma_f32_16x16x32_bf16 v[144:147], a[128:131], v[96:99], v[232:235]
    v_exp_f32 v34, v188
    v_mfma_f32_16x16x32_bf16 v[144:147], a[132:135], v[100:103], v[144:147]
    ds_read_b64_tr_b16 a[184:185], v26 offset:40960
    v_max3_f32 v50, v240, v252, v4
    v_mfma_f32_16x16x32_bf16 v[144:147], a[136:139], v[104:107], v[144:147]
    v_exp_f32 v35, v189
    v_mfma_f32_16x16x32_bf16 v[144:147], a[140:143], v[108:111], v[144:147]
    ds_read_b64_tr_b16 a[186:187], v26 offset:45056
    v_cvt_pk_bf16_f32 v222, v34, v35
    v_mfma_f32_16x16x32_bf16 v[148:151], a[144:147], v[96:99], v[232:235]
    v_exp_f32 v36, v190
    v_mfma_f32_16x16x32_bf16 v[148:151], a[148:151], v[100:103], v[148:151]
    ds_read_b64_tr_b16 a[188:189], v27 offset:40960
    v_mfma_f32_16x16x32_bf16 v[148:151], a[152:155], v[104:107], v[148:151]
    v_exp_f32 v37, v191
    v_mfma_f32_16x16x32_bf16 v[148:151], a[156:159], v[108:111], v[148:151]
    ds_read_b64_tr_b16 a[190:191], v27 offset:45056
    v_cvt_pk_bf16_f32 v223, v36, v37
    v_mfma_f32_16x16x32_bf16 v[152:155], a[128:131], v[112:115], v[236:239]
    v_exp_f32 v34, v128
    v_mfma_f32_16x16x32_bf16 v[152:155], a[132:135], v[116:119], v[152:155]
    buffer_load_dwordx4 v29, s[8:11], s31 offen offset:1024  lds
    v_mfma_f32_16x16x32_bf16 v[8:11], v[244:247], v[220:223], v[60:63]
    v_mfma_f32_16x16x32_bf16 v[152:155], a[136:139], v[120:123], v[152:155]
    v_exp_f32 v35, v129
    v_mfma_f32_16x16x32_bf16 v[152:155], a[140:143], v[124:127], v[152:155]
    v_cvt_pk_bf16_f32 v192, v34, v35
    s_waitcnt lgkmcnt(0)
    v_mfma_f32_16x16x32_bf16 v[156:159], a[144:147], v[112:115], v[236:239]
    v_exp_f32 v36, v130
    v_mfma_f32_16x16x32_bf16 v[156:159], a[148:151], v[116:119], v[156:159]
    v_max_f32 v50, v50, v8
    v_cmp_nge_f32 vcc, s36, v50
    v_mfma_f32_16x16x32_bf16 v[156:159], a[152:155], v[120:123], v[156:159]
    v_exp_f32 v37, v131
    v_mfma_f32_16x16x32_bf16 v[156:159], a[156:159], v[124:127], v[156:159]
    v_cvt_pk_bf16_f32 v193, v36, v37
    s_cbranch_vccnz slow_6
resume_6:
    v_mfma_f32_16x16x32_bf16 a[0:3], a[160:163], v[208:211], a[0:3]
    v_exp_f32 v34, v132
    v_mfma_f32_16x16x32_bf16 a[32:35], a[160:163], v[212:215], a[32:35]
    ds_read_b128 a[128:131], v16 offset:57344
    v_mfma_f32_16x16x32_bf16 a[64:67], a[160:163], v[216:219], a[64:67]
    v_exp_f32 v35, v133
    v_mfma_f32_16x16x32_bf16 a[96:99], a[160:163], v[220:223], a[96:99]
    ds_read_b128 a[132:135], v17 offset:57344
    v_cvt_pk_bf16_f32 v194, v34, v35
    v_mfma_f32_16x16x32_bf16 a[4:7], a[164:167], v[208:211], a[4:7]
    v_exp_f32 v36, v134
    v_mfma_f32_16x16x32_bf16 a[36:39], a[164:167], v[212:215], a[36:39]
    ds_read_b128 a[136:139], v18 offset:57344
    v_mfma_f32_16x16x32_bf16 a[68:71], a[164:167], v[216:219], a[68:71]
    v_exp_f32 v37, v135
    v_mfma_f32_16x16x32_bf16 a[100:103], a[164:167], v[220:223], a[100:103]
    ds_read_b128 a[140:143], v19 offset:57344
    v_cvt_pk_bf16_f32 v195, v36, v37
    v_mfma_f32_16x16x32_bf16 a[8:11], a[168:171], v[208:211], a[8:11]
    v_exp_f32 v34, v136
    v_mfma_f32_16x16x32_bf16 a[40:43], a[168:171], v[212:215], a[40:43]
    ds_read_b128 a[144:147], v16 offset:61440
    v_mfma_f32_16x16x32_bf16 v[40:43], v[244:247], v[192:195], v[240:243]
    v_mfma_f32_16x16x32_bf16 a[72:75], a[168:171], v[216:219], a[72:75]
    v_exp_f32 v35, v137
    v_mfma_f32_16x16x32_bf16 a[104:107], a[168:171], v[220:223], a[104:107]
    ds_read_b128 a[148:151], v17 offset:61440
    v_cvt_pk_bf16_f32 v196, v34, v35
    v_mfma_f32_16x16x32_bf16 a[12:15], a[172:175], v[208:211], a[12:15]
    v_exp_f32 v36, v138
    v_mfma_f32_16x16x32_bf16 a[44:47], a[172:175], v[212:215], a[44:47]
    buffer_load_dwordx4 v30, s[8:11], s31 offen offset:2048  lds
    v_mfma_f32_16x16x32_bf16 a[76:79], a[172:175], v[216:219], a[76:79]
    v_exp_f32 v37, v139
    v_mfma_f32_16x16x32_bf16 a[108:111], a[172:175], v[220:223], a[108:111]
    ds_read_b128 a[152:155], v18 offset:61440
    v_cvt_pk_bf16_f32 v197, v36, v37
    v_mfma_f32_16x16x32_bf16 a[16:19], a[176:179], v[208:211], a[16:19]
    v_exp_f32 v34, v140
    v_mfma_f32_16x16x32_bf16 a[48:51], a[176:179], v[212:215], a[48:51]
    ds_read_b128 a[156:159], v19 offset:61440
    v_mfma_f32_16x16x32_bf16 a[80:83], a[176:179], v[216:219], a[80:83]
    v_exp_f32 v35, v141
    v_mfma_f32_16x16x32_bf16 a[112:115], a[176:179], v[220:223], a[112:115]
    ds_read_b64_tr_b16 a[160:161], v20 offset:49152
    v_cvt_pk_bf16_f32 v198, v34, v35
    v_mfma_f32_16x16x32_bf16 a[20:23], a[180:183], v[208:211], a[20:23]
    v_exp_f32 v36, v142
    v_mfma_f32_16x16x32_bf16 a[52:55], a[180:183], v[212:215], a[52:55]
    ds_read_b64_tr_b16 a[162:163], v20 offset:53248
    v_mfma_f32_16x16x32_bf16 a[84:87], a[180:183], v[216:219], a[84:87]
    v_exp_f32 v37, v143
    v_mfma_f32_16x16x32_bf16 a[116:119], a[180:183], v[220:223], a[116:119]
    ds_read_b64_tr_b16 a[164:165], v21 offset:49152
    v_cvt_pk_bf16_f32 v199, v36, v37
    v_mfma_f32_16x16x32_bf16 a[24:27], a[184:187], v[208:211], a[24:27]
    v_exp_f32 v34, v144
    v_mfma_f32_16x16x32_bf16 a[56:59], a[184:187], v[212:215], a[56:59]
    ds_read_b64_tr_b16 a[166:167], v21 offset:53248
    v_mfma_f32_16x16x32_bf16 v[44:47], v[244:247], v[196:199], v[252:255]
    v_mfma_f32_16x16x32_bf16 a[88:91], a[184:187], v[216:219], a[88:91]
    v_exp_f32 v35, v145
    v_mfma_f32_16x16x32_bf16 a[120:123], a[184:187], v[220:223], a[120:123]
    ds_read_b64_tr_b16 a[168:169], v22 offset:49152
    v_cvt_pk_bf16_f32 v200, v34, v35
    v_mfma_f32_16x16x32_bf16 a[28:31], a[188:191], v[208:211], a[28:31]
    v_exp_f32 v36, v146
    v_mfma_f32_16x16x32_bf16 a[60:63], a[188:191], v[212:215], a[60:63]
    buffer_load_dwordx4 v31, s[8:11], s31 offen offset:3072  lds
    v_mfma_f32_16x16x32_bf16 a[92:95], a[188:191], v[216:219], a[92:95]
    v_exp_f32 v37, v147
    v_mfma_f32_16x16x32_bf16 a[124:127], a[188:191], v[220:223], a[124:127]
    v_cvt_pk_bf16_f32 v201, v36, v37
    s_waitcnt lgkmcnt(5)
    v_mfma_f32_16x16x32_bf16 v[160:163], a[128:131], v[64:67], v[224:227]
    v_exp_f32 v34, v148
    v_mfma_f32_16x16x32_bf16 v[160:163], a[132:135], v[68:71], v[160:163]
    s_add_u32 m0, s34, 16384
    ds_read_b64_tr_b16 a[170:171], v22 offset:53248
    v_mfma_f32_16x16x32_bf16 v[160:163], a[136:139], v[72:75], v[160:163]
    v_exp_f32 v35, v149
    v_mfma_f32_16x16x32_bf16 v[160:163], a[140:143], v[76:79], v[160:163]
    ds_read_b64_tr_b16 a[172:173], v23 offset:49152
    v_cvt_pk_bf16_f32 v202, v34, v35
    v_mfma_f32_16x16x32_bf16 v[164:167], a[144:147], v[64:67], v[224:227]
    v_exp_f32 v36, v150
    v_mfma_f32_16x16x32_bf16 v[164:167], a[148:151], v[68:71], v[164:167]
    s_add_u32 s32, s32, 16384
    ds_read_b64_tr_b16 a[174:175], v23 offset:53248
    v_mfma_f32_16x16x32_bf16 v[164:167], a[152:155], v[72:75], v[164:167]
    v_exp_f32 v37, v151
    v_mfma_f32_16x16x32_bf16 v[164:167], a[156:159], v[76:79], v[164:167]
    ds_read_b64_tr_b16 a[176:177], v24 offset:49152
    v_cvt_pk_bf16_f32 v203, v36, v37
    v_mfma_f32_16x16x32_bf16 v[168:171], a[128:131], v[80:83], v[228:231]
    v_exp_f32 v34, v152
    v_mfma_f32_16x16x32_bf16 v[168:171], a[132:135], v[84:87], v[168:171]
    ds_read_b64_tr_b16 a[178:179], v24 offset:53248
    v_mfma_f32_16x16x32_bf16 v[56:59], v[244:247], v[200:203], v[4:7]
    v_mfma_f32_16x16x32_bf16 v[168:171], a[136:139], v[88:91], v[168:171]
    v_exp_f32 v35, v153
    v_mfma_f32_16x16x32_bf16 v[168:171], a[140:143], v[92:95], v[168:171]
    ds_read_b64_tr_b16 a[180:181], v25 offset:49152
    v_cvt_pk_bf16_f32 v204, v34, v35
    v_mfma_f32_16x16x32_bf16 v[172:175], a[144:147], v[80:83], v[228:231]
    v_exp_f32 v36, v154
    v_mfma_f32_16x16x32_bf16 v[172:175], a[148:151], v[84:87], v[172:175]
    buffer_load_dwordx4 v32, s[12:15], s32 offen offset:0  lds
    v_mfma_f32_16x16x32_bf16 v[172:175], a[152:155], v[88:91], v[172:175]
    v_exp_f32 v37, v155
    v_mfma_f32_16x16x32_bf16 v[172:175], a[156:159], v[92:95], v[172:175]
    ds_read_b64_tr_b16 a[182:183], v25 offset:53248
    v_cvt_pk_bf16_f32 v205, v36, v37
    v_mfma_f32_16x16x32_bf16 v[176:179], a[128:131], v[96:99], v[232:235]
    v_exp_f32 v34, v156
    v_mfma_f32_16x16x32_bf16 v[176:179], a[132:135], v[100:103], v[176:179]
    ds_read_b64_tr_b16 a[184:185], v26 offset:49152
    v_max3_f32 v50, v40, v44, v56
    v_mfma_f32_16x16x32_bf16 v[176:179], a[136:139], v[104:107], v[176:179]
    v_exp_f32 v35, v157
    v_mfma_f32_16x16x32_bf16 v[176:179], a[140:143], v[108:111], v[176:179]
    ds_read_b64_tr_b16 a[186:187], v26 offset:53248
    v_cvt_pk_bf16_f32 v206, v34, v35
    v_mfma_f32_16x16x32_bf16 v[180:183], a[144:147], v[96:99], v[232:235]
    v_exp_f32 v36, v158
    v_mfma_f32_16x16x32_bf16 v[180:183], a[148:151], v[100:103], v[180:183]
    ds_read_b64_tr_b16 a[188:189], v27 offset:49152
    v_mfma_f32_16x16x32_bf16 v[180:183], a[152:155], v[104:107], v[180:183]
    v_exp_f32 v37, v159
    v_mfma_f32_16x16x32_bf16 v[180:183], a[156:159], v[108:111], v[180:183]
    ds_read_b64_tr_b16 a[190:191], v27 offset:53248
    v_cvt_pk_bf16_f32 v207, v36, v37
    v_mfma_f32_16x16x32_bf16 v[184:187], a[128:131], v[112:115], v[236:239]
    v_exp_f32 v34, v160
    v_mfma_f32_16x16x32_bf16 v[184:187], a[132:135], v[116:119], v[184:187]
    buffer_load_dwordx4 v33, s[12:15], s32 offen offset:1024  lds
    v_mfma_f32_16x16x32_bf16 v[60:63], v[244:247], v[204:207], v[8:11]
    v_mfma_f32_16x16x32_bf16 v[184:187], a[136:139], v[120:123], v[184:187]
    v_exp_f32 v35, v161
    v_mfma_f32_16x16x32_bf16 v[184:187], a[140:143], v[124:127], v[184:187]
    v_cvt_pk_bf16_f32 v208, v34, v35
    s_waitcnt lgkmcnt(0)
    v_mfma_f32_16x16x32_bf16 v[188:191], a[144:147], v[112:115], v[236:239]
    v_exp_f32 v36, v162
    v_mfma_f32_16x16x32_bf16 v[188:191], a[148:151], v[116:119], v[188:191]
    v_max_f32 v50, v50, v60
    v_cmp_nge_f32 vcc, s36, v50
    v_mfma_f32_16x16x32_bf16 v[188:191], a[152:155], v[120:123], v[188:191]
    v_exp_f32 v37, v163
    v_mfma_f32_16x16x32_bf16 v[188:191], a[156:159], v[124:127], v[188:191]
    v_cvt_pk_bf16_f32 v209, v36, v37
    s_cbranch_vccnz slow_7
resume_7:
    v_mfma_f32_16x16x32_bf16 a[0:3], a[160:163], v[192:195], a[0:3]
    v_exp_f32 v34, v164
    v_mfma_f32_16x16x32_bf16 a[32:35], a[160:163], v[196:199], a[32:35]
    ds_read_b128 a[128:131], v16 offset:0
    v_mfma_f32_16x16x32_bf16 a[64:67], a[160:163], v[200:203], a[64:67]
    v_exp_f32 v35, v165
    v_mfma_f32_16x16x32_bf16 a[96:99], a[160:163], v[204:207], a[96:99]
    ds_read_b128 a[132:135], v17 offset:0
    v_cvt_pk_bf16_f32 v210, v34, v35
    v_mfma_f32_16x16x32_bf16 a[4:7], a[164:167], v[192:195], a[4:7]
    v_exp_f32 v36, v166
    v_mfma_f32_16x16x32_bf16 a[36:39], a[164:167], v[196:199], a[36:39]
    ds_read_b128 a[136:139], v18 offset:0
    v_mfma_f32_16x16x32_bf16 a[68:71], a[164:167], v[200:203], a[68:71]
    v_exp_f32 v37, v167
    v_mfma_f32_16x16x32_bf16 a[100:103], a[164:167], v[204:207], a[100:103]
    ds_read_b128 a[140:143], v19 offset:0
    v_cvt_pk_bf16_f32 v211, v36, v37
    v_mfma_f32_16x16x32_bf16 a[8:11], a[168:171], v[192:195], a[8:11]
    v_exp_f32 v34, v168
    v_mfma_f32_16x16x32_bf16 a[40:43], a[168:171], v[196:199], a[40:43]
    ds_read_b128 a[144:147], v16 offset:4096
    v_mfma_f32_16x16x32_bf16 v[240:243], v[244:247], v[208:211], v[40:43]
    v_mfma_f32_16x16x32_bf16 a[72:75], a[168:171], v[200:203], a[72:75]
    v_exp_f32 v35, v169
    v_mfma_f32_16x16x32_bf16 a[104:107], a[168:171], v[204:207], a[104:107]
    ds_read_b128 a[148:151], v17 offset:4096
    v_cvt_pk_bf16_f32 v212, v34, v35
    v_mfma_f32_16x16x32_bf16 a[12:15], a[172:175], v[192:195], a[12:15]
    v_exp_f32 v36, v170
    v_mfma_f32_16x16x32_bf16 a[44:47], a[172:175], v[196:199], a[44:47]
    buffer_load_dwordx4 v32, s[12:15], s32 offen offset:2048  lds
    v_mfma_f32_16x16x32_bf16 a[76:79], a[172:175], v[200:203], a[76:79]
    v_exp_f32 v37, v171
    v_mfma_f32_16x16x32_bf16 a[108:111], a[172:175], v[204:207], a[108:111]
    ds_read_b128 a[152:155], v18 offset:4096
    v_cvt_pk_bf16_f32 v213, v36, v37
    v_mfma_f32_16x16x32_bf16 a[16:19], a[176:179], v[192:195], a[16:19]
    v_exp_f32 v34, v172
    v_mfma_f32_16x16x32_bf16 a[48:51], a[176:179], v[196:199], a[48:51]
    ds_read_b128 a[156:159], v19 offset:4096
    v_mfma_f32_16x16x32_bf16 a[80:83], a[176:179], v[200:203], a[80:83]
    v_exp_f32 v35, v173
    v_mfma_f32_16x16x32_bf16 a[112:115], a[176:179], v[204:207], a[112:115]
    ds_read_b64_tr_b16 a[160:161], v20 offset:57344
    v_cvt_pk_bf16_f32 v214, v34, v35
    v_mfma_f32_16x16x32_bf16 a[20:23], a[180:183], v[192:195], a[20:23]
    v_exp_f32 v36, v174
    v_mfma_f32_16x16x32_bf16 a[52:55], a[180:183], v[196:199], a[52:55]
    ds_read_b64_tr_b16 a[162:163], v20 offset:61440
    v_mfma_f32_16x16x32_bf16 a[84:87], a[180:183], v[200:203], a[84:87]
    v_exp_f32 v37, v175
    v_mfma_f32_16x16x32_bf16 a[116:119], a[180:183], v[204:207], a[116:119]
    ds_read_b64_tr_b16 a[164:165], v21 offset:57344
    v_cvt_pk_bf16_f32 v215, v36, v37
    v_mfma_f32_16x16x32_bf16 a[24:27], a[184:187], v[192:195], a[24:27]
    v_exp_f32 v34, v176
    v_mfma_f32_16x16x32_bf16 a[56:59], a[184:187], v[196:199], a[56:59]
    ds_read_b64_tr_b16 a[166:167], v21 offset:61440
    v_mfma_f32_16x16x32_bf16 v[252:255], v[244:247], v[212:215], v[44:47]
    v_mfma_f32_16x16x32_bf16 a[88:91], a[184:187], v[200:203], a[88:91]
    v_exp_f32 v35, v177
    v_mfma_f32_16x16x32_bf16 a[120:123], a[184:187], v[204:207], a[120:123]
    ds_read_b64_tr_b16 a[168:169], v22 offset:57344
    v_cvt_pk_bf16_f32 v216, v34, v35
    v_mfma_f32_16x16x32_bf16 a[28:31], a[188:191], v[192:195], a[28:31]
    v_exp_f32 v36, v178
    v_mfma_f32_16x16x32_bf16 a[60:63], a[188:191], v[196:199], a[60:63]
    buffer_load_dwordx4 v33, s[12:15], s32 offen offset:3072  lds
    v_mfma_f32_16x16x32_bf16 a[92:95], a[188:191], v[200:203], a[92:95]
    v_exp_f32 v37, v179
    v_mfma_f32_16x16x32_bf16 a[124:127], a[188:191], v[204:207], a[124:127]
    v_cvt_pk_bf16_f32 v217, v36, v37
    s_waitcnt vmcnt(8) lgkmcnt(5)
    s_barrier
    s_add_u32 s35, s35, 1
    s_cmp_lt_u32 s35, 7
    s_cbranch_scc1 attn_loop
    s_cmp_eq_u32 s35, 7
    s_cbranch_scc1 attn_warm
    s_cmp_lt_u32 s35, 8
    s_cbranch_scc1 attn_loop
    s_load_dwordx2 s[48:49], s[0:1], 0
    s_load_dwordx4 s[60:63], s[0:1], 72
    s_lshl_b32 s50, s30, 12
    s_add_u32 s50, s50, 32768
    buffer_load_dwordx2 v[38:39], v1, s[92:95], s50 offen sc1
    v_exp_f32 v34, v180
    s_nop 0
    ds_read_b64_tr_b16 a[170:171], v22 offset:61440
    v_exp_f32 v35, v181
    s_nop 0
    ds_read_b64_tr_b16 a[172:173], v23 offset:57344
    v_cvt_pk_bf16_f32 v218, v34, v35
    v_exp_f32 v36, v182
    s_nop 0
    ds_read_b64_tr_b16 a[174:175], v23 offset:61440
    v_exp_f32 v37, v183
    s_nop 0
    ds_read_b64_tr_b16 a[176:177], v24 offset:57344
    v_cvt_pk_bf16_f32 v219, v36, v37
    v_exp_f32 v34, v184
    s_nop 0
    ds_read_b64_tr_b16 a[178:179], v24 offset:61440
    s_nop 1
    v_mfma_f32_16x16x32_bf16 v[4:7], v[244:247], v[216:219], v[56:59]
    v_exp_f32 v35, v185
    s_nop 0
    ds_read_b64_tr_b16 a[180:181], v25 offset:57344
    v_cvt_pk_bf16_f32 v220, v34, v35
    v_exp_f32 v36, v186
    v_exp_f32 v37, v187
    s_nop 0
    ds_read_b64_tr_b16 a[182:183], v25 offset:61440
    v_cvt_pk_bf16_f32 v221, v36, v37
    v_exp_f32 v34, v188
    s_nop 0
    ds_read_b64_tr_b16 a[184:185], v26 offset:57344
    v_max3_f32 v50, v240, v252, v4
    v_exp_f32 v35, v189
    s_nop 0
    ds_read_b64_tr_b16 a[186:187], v26 offset:61440
    v_cvt_pk_bf16_f32 v222, v34, v35
    v_exp_f32 v36, v190
    s_nop 0
    ds_read_b64_tr_b16 a[188:189], v27 offset:57344
    v_exp_f32 v37, v191
    s_nop 0
    ds_read_b64_tr_b16 a[190:191], v27 offset:61440
    v_cvt_pk_bf16_f32 v223, v36, v37
    s_nop 1
    v_mfma_f32_16x16x32_bf16 v[8:11], v[244:247], v[220:223], v[60:63]
    s_nop 7
    s_waitcnt lgkmcnt(0)
    s_nop 0
    v_max_f32 v50, v50, v8
    v_cmp_nge_f32 vcc, s36, v50
    s_cbranch_vccnz slow_8
resume_8:
    v_mfma_f32_16x16x32_bf16 a[0:3], a[160:163], v[208:211], a[0:3]
    v_rcp_f32 v12, v240
    v_mfma_f32_16x16x32_bf16 a[4:7], a[164:167], v[208:211], a[4:7]
    v_rcp_f32 v13, v252
    v_mfma_f32_16x16x32_bf16 a[8:11], a[168:171], v[208:211], a[8:11]
    v_rcp_f32 v14, v4
    v_mfma_f32_16x16x32_bf16 a[12:15], a[172:175], v[208:211], a[12:15]
    v_rcp_f32 v15, v8
    v_mfma_f32_16x16x32_bf16 a[16:19], a[176:179], v[208:211], a[16:19]
    v_mfma_f32_16x16x32_bf16 a[20:23], a[180:183], v[208:211], a[20:23]
    v_mfma_f32_16x16x32_bf16 a[24:27], a[184:187], v[208:211], a[24:27]
    v_mfma_f32_16x16x32_bf16 a[28:31], a[188:191], v[208:211], a[28:31]
    v_mfma_f32_16x16x32_bf16 a[32:35], a[160:163], v[212:215], a[32:35]
    v_mfma_f32_16x16x32_bf16 a[36:39], a[164:167], v[212:215], a[36:39]
    v_mfma_f32_16x16x32_bf16 a[40:43], a[168:171], v[212:215], a[40:43]
    v_mfma_f32_16x16x32_bf16 a[44:47], a[172:175], v[212:215], a[44:47]
    v_accvgpr_read_b32 v128, a0
    v_accvgpr_read_b32 v129, a1
    v_mfma_f32_16x16x32_bf16 a[48:51], a[176:179], v[212:215], a[48:51]
    v_accvgpr_read_b32 v130, a2
    v_accvgpr_read_b32 v131, a3
    v_mfma_f32_16x16x32_bf16 a[52:55], a[180:183], v[212:215], a[52:55]
    v_accvgpr_read_b32 v132, a4
    v_accvgpr_read_b32 v133, a5
    v_mfma_f32_16x16x32_bf16 a[56:59], a[184:187], v[212:215], a[56:59]
    v_accvgpr_read_b32 v134, a6
    v_accvgpr_read_b32 v135, a7
    v_mfma_f32_16x16x32_bf16 a[60:63], a[188:191], v[212:215], a[60:63]
    v_mul_f32 v128, v128, v12
    v_mul_f32 v129, v129, v12
    v_mfma_f32_16x16x32_bf16 a[64:67], a[160:163], v[216:219], a[64:67]
    v_mul_f32 v130, v130, v12
    v_mul_f32 v131, v131, v12
    v_mfma_f32_16x16x32_bf16 a[68:71], a[164:167], v[216:219], a[68:71]
    v_mul_f32 v132, v132, v12
    v_mul_f32 v133, v133, v12
    v_mfma_f32_16x16x32_bf16 a[72:75], a[168:171], v[216:219], a[72:75]
    v_mul_f32 v134, v134, v12
    v_mul_f32 v135, v135, v12
    v_mfma_f32_16x16x32_bf16 a[76:79], a[172:175], v[216:219], a[76:79]
    s_add_u32 s37, s80, 0
    s_mul_i32 s37, s37, 132096
    v_mfma_f32_16x16x32_bf16 a[80:83], a[176:179], v[216:219], a[80:83]
    v_cvt_pk_bf16_f32 v136, v128, v129
    v_cvt_pk_bf16_f32 v137, v130, v131
    v_mfma_f32_16x16x32_bf16 a[84:87], a[180:183], v[216:219], a[84:87]
    v_cvt_pk_bf16_f32 v138, v132, v133
    v_cvt_pk_bf16_f32 v139, v134, v135
    v_mfma_f32_16x16x32_bf16 a[88:91], a[184:187], v[216:219], a[88:91]
    buffer_store_dwordx4 v[136:139], v54, s[24:27], s37 offen offset:0 sc1
    v_mfma_f32_16x16x32_bf16 a[92:95], a[188:191], v[216:219], a[92:95]
    v_accvgpr_read_b32 v144, a8
    v_accvgpr_read_b32 v145, a9
    v_mfma_f32_16x16x32_bf16 a[96:99], a[160:163], v[220:223], a[96:99]
    v_accvgpr_read_b32 v146, a10
    v_accvgpr_read_b32 v147, a11
    v_mfma_f32_16x16x32_bf16 a[100:103], a[164:167], v[220:223], a[100:103]
    v_accvgpr_read_b32 v148, a12
    v_accvgpr_read_b32 v149, a13
    v_mfma_f32_16x16x32_bf16 a[104:107], a[168:171], v[220:223], a[104:107]
    v_accvgpr_read_b32 v150, a14
    v_accvgpr_read_b32 v151, a15
    v_mfma_f32_16x16x32_bf16 a[108:111], a[172:175], v[220:223], a[108:111]
    v_mul_f32 v144, v144, v12
    v_mul_f32 v145, v145, v12
    v_mfma_f32_16x16x32_bf16 a[112:115], a[176:179], v[220:223], a[112:115]
    v_mul_f32 v146, v146, v12
    v_mul_f32 v147, v147, v12
    v_mfma_f32_16x16x32_bf16 a[116:119], a[180:183], v[220:223], a[116:119]
    v_mul_f32 v148, v148, v12
    v_mul_f32 v149, v149, v12
    v_mfma_f32_16x16x32_bf16 a[120:123], a[184:187], v[220:223], a[120:123]
    v_mul_f32 v150, v150, v12
    v_mul_f32 v151, v151, v12
    v_mfma_f32_16x16x32_bf16 a[124:127], a[188:191], v[220:223], a[124:127]
    v_cvt_pk_bf16_f32 v152, v144, v145
    v_cvt_pk_bf16_f32 v153, v146, v147
    v_cvt_pk_bf16_f32 v154, v148, v149
    v_cvt_pk_bf16_f32 v155, v150, v151
    buffer_store_dwordx4 v[152:155], v54, s[24:27], s37 offen offset:1024 sc1
    v_accvgpr_read_b32 v160, a16
    v_accvgpr_read_b32 v161, a17
    v_accvgpr_read_b32 v162, a18
    v_accvgpr_read_b32 v163, a19
    v_accvgpr_read_b32 v164, a20
    v_accvgpr_read_b32 v165, a21
    v_accvgpr_read_b32 v166, a22
    v_accvgpr_read_b32 v167, a23
    v_mul_f32 v160, v160, v12
    v_mul_f32 v161, v161, v12
    v_mul_f32 v162, v162, v12
    v_mul_f32 v163, v163, v12
    v_mul_f32 v164, v164, v12
    v_mul_f32 v165, v165, v12
    v_mul_f32 v166, v166, v12
    v_mul_f32 v167, v167, v12
    v_cvt_pk_bf16_f32 v168, v160, v161
    v_cvt_pk_bf16_f32 v169, v162, v163
    v_cvt_pk_bf16_f32 v170, v164, v165
    v_cvt_pk_bf16_f32 v171, v166, v167
    buffer_store_dwordx4 v[168:171], v54, s[24:27], s37 offen offset:2048 sc1
    v_accvgpr_read_b32 v176, a24
    v_accvgpr_read_b32 v177, a25
    v_accvgpr_read_b32 v178, a26
    v_accvgpr_read_b32 v179, a27
    v_accvgpr_read_b32 v180, a28
    v_accvgpr_read_b32 v181, a29
    v_accvgpr_read_b32 v182, a30
    v_accvgpr_read_b32 v183, a31
    v_mul_f32 v176, v176, v12
    v_mul_f32 v177, v177, v12
    v_mul_f32 v178, v178, v12
    v_mul_f32 v179, v179, v12
    v_mul_f32 v180, v180, v12
    v_mul_f32 v181, v181, v12
    v_mul_f32 v182, v182, v12
    v_mul_f32 v183, v183, v12
    v_cvt_pk_bf16_f32 v184, v176, v177
    v_cvt_pk_bf16_f32 v185, v178, v179
    v_cvt_pk_bf16_f32 v186, v180, v181
    v_cvt_pk_bf16_f32 v187, v182, v183
    buffer_store_dwordx4 v[184:187], v54, s[24:27], s37 offen offset:3072 sc1
    v_accvgpr_read_b32 v128, a32
    v_accvgpr_read_b32 v129, a33
    v_accvgpr_read_b32 v130, a34
    v_accvgpr_read_b32 v131, a35
    v_accvgpr_read_b32 v132, a36
    v_accvgpr_read_b32 v133, a37
    v_accvgpr_read_b32 v134, a38
    v_accvgpr_read_b32 v135, a39
    v_pk_mul_f32 v[128:129], v[128:129], v[12:13] op_sel:[0,1] op_sel_hi:[1,1]
    v_pk_mul_f32 v[130:131], v[130:131], v[12:13] op_sel:[0,1] op_sel_hi:[1,1]
    v_pk_mul_f32 v[132:133], v[132:133], v[12:13] op_sel:[0,1] op_sel_hi:[1,1]
    v_pk_mul_f32 v[134:135], v[134:135], v[12:13] op_sel:[0,1] op_sel_hi:[1,1]
    s_add_u32 s37, s80, 1
    s_mul_i32 s37, s37, 132096
    v_cvt_pk_bf16_f32 v136, v128, v129
    v_cvt_pk_bf16_f32 v137, v130, v131
    v_cvt_pk_bf16_f32 v138, v132, v133
    v_cvt_pk_bf16_f32 v139, v134, v135
    buffer_store_dwordx4 v[136:139], v54, s[24:27], s37 offen offset:0 sc1
    v_accvgpr_read_b32 v144, a40
    v_accvgpr_read_b32 v145, a41
    v_accvgpr_read_b32 v146, a42
    v_accvgpr_read_b32 v147, a43
    v_accvgpr_read_b32 v148, a44
    v_accvgpr_read_b32 v149, a45
    v_accvgpr_read_b32 v150, a46
    v_accvgpr_read_b32 v151, a47
    v_pk_mul_f32 v[144:145], v[144:145], v[12:13] op_sel:[0,1] op_sel_hi:[1,1]
    v_pk_mul_f32 v[146:147], v[146:147], v[12:13] op_sel:[0,1] op_sel_hi:[1,1]
    v_pk_mul_f32 v[148:149], v[148:149], v[12:13] op_sel:[0,1] op_sel_hi:[1,1]
    v_pk_mul_f32 v[150:151], v[150:151], v[12:13] op_sel:[0,1] op_sel_hi:[1,1]
    v_cvt_pk_bf16_f32 v152, v144, v145
    v_cvt_pk_bf16_f32 v153, v146, v147
    v_cvt_pk_bf16_f32 v154, v148, v149
    v_cvt_pk_bf16_f32 v155, v150, v151
    buffer_store_dwordx4 v[152:155], v54, s[24:27], s37 offen offset:1024 sc1
    v_accvgpr_read_b32 v160, a48
    v_accvgpr_read_b32 v161, a49
    v_accvgpr_read_b32 v162, a50
    v_accvgpr_read_b32 v163, a51
    v_accvgpr_read_b32 v164, a52
    v_accvgpr_read_b32 v165, a53
    v_accvgpr_read_b32 v166, a54
    v_accvgpr_read_b32 v167, a55
    v_pk_mul_f32 v[160:161], v[160:161], v[12:13] op_sel:[0,1] op_sel_hi:[1,1]
    v_pk_mul_f32 v[162:163], v[162:163], v[12:13] op_sel:[0,1] op_sel_hi:[1,1]
    v_pk_mul_f32 v[164:165], v[164:165], v[12:13] op_sel:[0,1] op_sel_hi:[1,1]
    v_pk_mul_f32 v[166:167], v[166:167], v[12:13] op_sel:[0,1] op_sel_hi:[1,1]
    v_cvt_pk_bf16_f32 v168, v160, v161
    v_cvt_pk_bf16_f32 v169, v162, v163
    v_cvt_pk_bf16_f32 v170, v164, v165
    v_cvt_pk_bf16_f32 v171, v166, v167
    buffer_store_dwordx4 v[168:171], v54, s[24:27], s37 offen offset:2048 sc1
    v_accvgpr_read_b32 v176, a56
    v_accvgpr_read_b32 v177, a57
    v_accvgpr_read_b32 v178, a58
    v_accvgpr_read_b32 v179, a59
    v_accvgpr_read_b32 v180, a60
    v_accvgpr_read_b32 v181, a61
    v_accvgpr_read_b32 v182, a62
    v_accvgpr_read_b32 v183, a63
    v_pk_mul_f32 v[176:177], v[176:177], v[12:13] op_sel:[0,1] op_sel_hi:[1,1]
    v_pk_mul_f32 v[178:179], v[178:179], v[12:13] op_sel:[0,1] op_sel_hi:[1,1]
    v_pk_mul_f32 v[180:181], v[180:181], v[12:13] op_sel:[0,1] op_sel_hi:[1,1]
    v_pk_mul_f32 v[182:183], v[182:183], v[12:13] op_sel:[0,1] op_sel_hi:[1,1]
    v_cvt_pk_bf16_f32 v184, v176, v177
    v_cvt_pk_bf16_f32 v185, v178, v179
    v_cvt_pk_bf16_f32 v186, v180, v181
    v_cvt_pk_bf16_f32 v187, v182, v183
    buffer_store_dwordx4 v[184:187], v54, s[24:27], s37 offen offset:3072 sc1
    v_accvgpr_read_b32 v128, a64
    v_accvgpr_read_b32 v129, a65
    v_accvgpr_read_b32 v130, a66
    v_accvgpr_read_b32 v131, a67
    v_accvgpr_read_b32 v132, a68
    v_accvgpr_read_b32 v133, a69
    v_accvgpr_read_b32 v134, a70
    v_accvgpr_read_b32 v135, a71
    v_pk_mul_f32 v[128:129], v[128:129], v[14:15] op_sel:[0,0] op_sel_hi:[1,0]
    v_pk_mul_f32 v[130:131], v[130:131], v[14:15] op_sel:[0,0] op_sel_hi:[1,0]
    v_pk_mul_f32 v[132:133], v[132:133], v[14:15] op_sel:[0,0] op_sel_hi:[1,0]
    v_pk_mul_f32 v[134:135], v[134:135], v[14:15] op_sel:[0,0] op_sel_hi:[1,0]
    s_add_u32 s37, s81, 0
    s_mul_i32 s37, s37, 132096
    v_cvt_pk_bf16_f32 v136, v128, v129
    v_cvt_pk_bf16_f32 v137, v130, v131
    v_cvt_pk_bf16_f32 v138, v132, v133
    v_cvt_pk_bf16_f32 v139, v134, v135
    buffer_store_dwordx4 v[136:139], v54, s[24:27], s37 offen offset:0 sc1
    v_accvgpr_read_b32 v144, a72
    v_accvgpr_read_b32 v145, a73
    v_accvgpr_read_b32 v146, a74
    v_accvgpr_read_b32 v147, a75
    v_accvgpr_read_b32 v148, a76
    v_accvgpr_read_b32 v149, a77
    v_accvgpr_read_b32 v150, a78
    v_accvgpr_read_b32 v151, a79
    v_pk_mul_f32 v[144:145], v[144:145], v[14:15] op_sel:[0,0] op_sel_hi:[1,0]
    v_pk_mul_f32 v[146:147], v[146:147], v[14:15] op_sel:[0,0] op_sel_hi:[1,0]
    v_pk_mul_f32 v[148:149], v[148:149], v[14:15] op_sel:[0,0] op_sel_hi:[1,0]
    v_pk_mul_f32 v[150:151], v[150:151], v[14:15] op_sel:[0,0] op_sel_hi:[1,0]
    v_cvt_pk_bf16_f32 v152, v144, v145
    v_cvt_pk_bf16_f32 v153, v146, v147
    v_cvt_pk_bf16_f32 v154, v148, v149
    v_cvt_pk_bf16_f32 v155, v150, v151
    buffer_store_dwordx4 v[152:155], v54, s[24:27], s37 offen offset:1024 sc1
    v_accvgpr_read_b32 v160, a80
    v_accvgpr_read_b32 v161, a81
    v_accvgpr_read_b32 v162, a82
    v_accvgpr_read_b32 v163, a83
    v_accvgpr_read_b32 v164, a84
    v_accvgpr_read_b32 v165, a85
    v_accvgpr_read_b32 v166, a86
    v_accvgpr_read_b32 v167, a87
    v_pk_mul_f32 v[160:161], v[160:161], v[14:15] op_sel:[0,0] op_sel_hi:[1,0]
    v_pk_mul_f32 v[162:163], v[162:163], v[14:15] op_sel:[0,0] op_sel_hi:[1,0]
    v_pk_mul_f32 v[164:165], v[164:165], v[14:15] op_sel:[0,0] op_sel_hi:[1,0]
    v_pk_mul_f32 v[166:167], v[166:167], v[14:15] op_sel:[0,0] op_sel_hi:[1,0]
    v_cvt_pk_bf16_f32 v168, v160, v161
    v_cvt_pk_bf16_f32 v169, v162, v163
    v_cvt_pk_bf16_f32 v170, v164, v165
    v_cvt_pk_bf16_f32 v171, v166, v167
    buffer_store_dwordx4 v[168:171], v54, s[24:27], s37 offen offset:2048 sc1
    v_accvgpr_read_b32 v176, a88
    v_accvgpr_read_b32 v177, a89
    v_accvgpr_read_b32 v178, a90
    v_accvgpr_read_b32 v179, a91
    v_accvgpr_read_b32 v180, a92
    v_accvgpr_read_b32 v181, a93
    v_accvgpr_read_b32 v182, a94
    v_accvgpr_read_b32 v183, a95
    v_pk_mul_f32 v[176:177], v[176:177], v[14:15] op_sel:[0,0] op_sel_hi:[1,0]
    v_pk_mul_f32 v[178:179], v[178:179], v[14:15] op_sel:[0,0] op_sel_hi:[1,0]
    v_pk_mul_f32 v[180:181], v[180:181], v[14:15] op_sel:[0,0] op_sel_hi:[1,0]
    v_pk_mul_f32 v[182:183], v[182:183], v[14:15] op_sel:[0,0] op_sel_hi:[1,0]
    v_cvt_pk_bf16_f32 v184, v176, v177
    v_cvt_pk_bf16_f32 v185, v178, v179
    v_cvt_pk_bf16_f32 v186, v180, v181
    v_cvt_pk_bf16_f32 v187, v182, v183
    buffer_store_dwordx4 v[184:187], v54, s[24:27], s37 offen offset:3072 sc1
    v_accvgpr_read_b32 v128, a96
    v_accvgpr_read_b32 v129, a97
    v_accvgpr_read_b32 v130, a98
    v_accvgpr_read_b32 v131, a99
    v_accvgpr_read_b32 v132, a100
    v_accvgpr_read_b32 v133, a101
    v_accvgpr_read_b32 v134, a102
    v_accvgpr_read_b32 v135, a103
    v_pk_mul_f32 v[128:129], v[128:129], v[14:15] op_sel:[0,1] op_sel_hi:[1,1]
    v_pk_mul_f32 v[130:131], v[130:131], v[14:15] op_sel:[0,1] op_sel_hi:[1,1]
    v_pk_mul_f32 v[132:133], v[132:133], v[14:15] op_sel:[0,1] op_sel_hi:[1,1]
    v_pk_mul_f32 v[134:135], v[134:135], v[14:15] op_sel:[0,1] op_sel_hi:[1,1]
    s_add_u32 s37, s81, 1
    s_mul_i32 s37, s37, 132096
    v_cvt_pk_bf16_f32 v136, v128, v129
    v_cvt_pk_bf16_f32 v137, v130, v131
    v_cvt_pk_bf16_f32 v138, v132, v133
    v_cvt_pk_bf16_f32 v139, v134, v135
    buffer_store_dwordx4 v[136:139], v54, s[24:27], s37 offen offset:0 sc1
    v_accvgpr_read_b32 v144, a104
    v_accvgpr_read_b32 v145, a105
    v_accvgpr_read_b32 v146, a106
    v_accvgpr_read_b32 v147, a107
    v_accvgpr_read_b32 v148, a108
    v_accvgpr_read_b32 v149, a109
    v_accvgpr_read_b32 v150, a110
    v_accvgpr_read_b32 v151, a111
    v_pk_mul_f32 v[144:145], v[144:145], v[14:15] op_sel:[0,1] op_sel_hi:[1,1]
    v_pk_mul_f32 v[146:147], v[146:147], v[14:15] op_sel:[0,1] op_sel_hi:[1,1]
    v_pk_mul_f32 v[148:149], v[148:149], v[14:15] op_sel:[0,1] op_sel_hi:[1,1]
    v_pk_mul_f32 v[150:151], v[150:151], v[14:15] op_sel:[0,1] op_sel_hi:[1,1]
    v_cvt_pk_bf16_f32 v152, v144, v145
    v_cvt_pk_bf16_f32 v153, v146, v147
    v_cvt_pk_bf16_f32 v154, v148, v149
    v_cvt_pk_bf16_f32 v155, v150, v151
    buffer_store_dwordx4 v[152:155], v54, s[24:27], s37 offen offset:1024 sc1
    v_accvgpr_read_b32 v160, a112
    v_accvgpr_read_b32 v161, a113
    v_accvgpr_read_b32 v162, a114
    v_accvgpr_read_b32 v163, a115
    v_accvgpr_read_b32 v164, a116
    v_accvgpr_read_b32 v165, a117
    v_accvgpr_read_b32 v166, a118
    v_accvgpr_read_b32 v167, a119
    v_pk_mul_f32 v[160:161], v[160:161], v[14:15] op_sel:[0,1] op_sel_hi:[1,1]
    v_pk_mul_f32 v[162:163], v[162:163], v[14:15] op_sel:[0,1] op_sel_hi:[1,1]
    v_pk_mul_f32 v[164:165], v[164:165], v[14:15] op_sel:[0,1] op_sel_hi:[1,1]
    v_pk_mul_f32 v[166:167], v[166:167], v[14:15] op_sel:[0,1] op_sel_hi:[1,1]
    v_cvt_pk_bf16_f32 v168, v160, v161
    v_cvt_pk_bf16_f32 v169, v162, v163
    v_cvt_pk_bf16_f32 v170, v164, v165
    v_cvt_pk_bf16_f32 v171, v166, v167
    buffer_store_dwordx4 v[168:171], v54, s[24:27], s37 offen offset:2048 sc1
    v_accvgpr_read_b32 v176, a120
    v_accvgpr_read_b32 v177, a121
    v_accvgpr_read_b32 v178, a122
    v_accvgpr_read_b32 v179, a123
    v_accvgpr_read_b32 v180, a124
    v_accvgpr_read_b32 v181, a125
    v_accvgpr_read_b32 v182, a126
    v_accvgpr_read_b32 v183, a127
    v_pk_mul_f32 v[176:177], v[176:177], v[14:15] op_sel:[0,1] op_sel_hi:[1,1]
    v_pk_mul_f32 v[178:179], v[178:179], v[14:15] op_sel:[0,1] op_sel_hi:[1,1]
    v_pk_mul_f32 v[180:181], v[180:181], v[14:15] op_sel:[0,1] op_sel_hi:[1,1]
    v_pk_mul_f32 v[182:183], v[182:183], v[14:15] op_sel:[0,1] op_sel_hi:[1,1]
    v_cvt_pk_bf16_f32 v184, v176, v177
    v_cvt_pk_bf16_f32 v185, v178, v179
    v_cvt_pk_bf16_f32 v186, v180, v181
    v_cvt_pk_bf16_f32 v187, v182, v183
    buffer_store_dwordx4 v[184:187], v54, s[24:27], s37 offen offset:3072 sc1
attn_proj:
    s_mov_b64 exec, 0xffffffff
    s_waitcnt vmcnt(16)
proj_hwait:
    v_cmp_ne_u64 vcc, s[100:101], v[38:39]
    s_cbranch_vccz proj_hready
    buffer_load_dwordx2 v[38:39], v1, s[92:95], s50 offen sc1
    s_waitcnt vmcnt(0)
    s_branch proj_hwait
proj_hready:
    s_mov_b64 exec, -1
    s_lshl_b32 s58, s42, 3
    s_lshl_b32 s59, s28, 1
    s_add_u32 s58, s58, s59
    s_cmp_eq_u32 s39, 3
    s_cselect_b32 s20, 10, 11
    s_lshl_b32 s56, s20, 15
    s_sub_u32 s56, s56, 768
    s_lshl_b32 s20, s20, 10
    s_lshl_b32 s59, s43, 8
    s_mul_i32 s57, s39, 360448
    s_add_u32 s57, s57, s59
    s_add_u32 s24, s46, s57
    s_addc_u32 s25, s47, 0
    s_mov_b32 s26, s56
    s_mov_b32 s27, 0x20000
    s_mul_i32 s57, s58, 44032
    s_mul_i32 s56, s39, 11264
    s_add_u32 s57, s57, s56
    s_add_u32 s57, s57, 4194304
    s_add_u32 s76, s54, s57
    s_addc_u32 s77, s55, 0
    s_mov_b32 s78, s20
    s_mov_b32 s79, 0x20000
    s_add_u32 s57, s57, 44032
    s_add_u32 s4, s54, s57
    s_addc_u32 s5, s55, 0
    s_mov_b32 s6, s20
    s_mov_b32 s7, 0x20000
    v_lshrrev_b32 v38, 8, v54
    v_mul_u32_u24 v38, 768, v38
    v_subrev_u32 v38, s33, v38
    v_add_u32 v32, v32, v38
    v_add_u32 v33, v33, v38
    v_add_u32 v33, 3072, v33
    s_lshl_b32 s82, s28, 13
    s_lshl_b32 s99, s28, 11
    s_mov_b32 s83, 0
    s_add_u32 m0, s99, 0
    buffer_load_dwordx4 a[128:131], v54, s[76:79], s83 offen offset:0 sc1
    v_and_b32 v2, 63, v0
    v_and_b32 v3, 15, v2
    v_lshrrev_b32 v4, 4, v2
    v_lshrrev_b32 v7, 2, v3
    v_and_b32 v8, 3, v2
    v_and_b32 v9, 1, v4
    buffer_load_dwordx4 v32, s[24:27], s82 offen lds
    v_lshl_add_u32 v9, v9, 2, v7
    v_lshl_add_u32 v13, v4, 2, v7
    v_lshlrev_b32 v13, 8, v13
    v_lshrrev_b32 v11, 1, v8
    v_lshl_add_u32 v13, v11, 4, v13
    v_and_b32 v11, 1, v8
    buffer_load_dwordx4 v33, s[24:27], s82 offen offset:1024 lds
    v_lshl_add_u32 v13, v11, 3, v13
    s_lshl_b32 s64, s39, 1
    s_add_u32 s65, s64, 0
    s_and_b32 s65, s65, 7
    v_xor_b32 v10, s65, v9
    v_lshl_add_u32 v16, v10, 5, v13
    buffer_load_dwordx4 a[132:135], v54, s[4:7], s83 offen offset:0 sc1
    s_add_u32 s82, s82, 32768
    s_add_u32 s65, s64, 1
    s_and_b32 s65, s65, 7
    v_xor_b32 v10, s65, v9
    v_lshl_add_u32 v17, v10, 5, v13
    s_add_u32 s65, s64, 2
    s_and_b32 s65, s65, 7
    s_add_u32 m0, s99, 8192
    buffer_load_dwordx4 a[136:139], v54, s[76:79], s83 offen offset:1024 sc1
    v_xor_b32 v10, s65, v9
    v_lshl_add_u32 v18, v10, 5, v13
    s_add_u32 s65, s64, 3
    s_and_b32 s65, s65, 7
    v_xor_b32 v10, s65, v9
    v_lshl_add_u32 v19, v10, 5, v13
    buffer_load_dwordx4 v32, s[24:27], s82 offen lds
    s_add_u32 s65, s64, 4
    s_and_b32 s65, s65, 7
    v_xor_b32 v10, s65, v9
    v_lshl_add_u32 v20, v10, 5, v13
    s_add_u32 s65, s64, 5
    s_and_b32 s65, s65, 7
    buffer_load_dwordx4 v33, s[24:27], s82 offen offset:1024 lds
    v_xor_b32 v10, s65, v9
    v_lshl_add_u32 v21, v10, 5, v13
    s_add_u32 s65, s64, 6
    s_and_b32 s65, s65, 7
    v_xor_b32 v10, s65, v9
    v_lshl_add_u32 v22, v10, 5, v13
    buffer_load_dwordx4 a[140:143], v54, s[4:7], s83 offen offset:1024 sc1
    s_add_u32 s82, s82, 32768
    s_add_u32 s65, s64, 7
    s_and_b32 s65, s65, 7
    v_xor_b32 v10, s65, v9
    v_lshl_add_u32 v23, v10, 5, v13
    s_lshl_b32 s57, s39, 20
    s_add_u32 s57, s57, s59
    s_add_u32 m0, s99, 16384
    buffer_load_dwordx4 a[144:147], v54, s[76:79], s83 offen offset:2048 sc1
    s_add_u32 s8, s44, s57
    s_addc_u32 s9, s45, 0
    s_mov_b32 s10, 1047808
    s_mov_b32 s11, 0x20000
    s_mul_i32 s57, s58, 132096
    s_lshl_b32 s56, s39, 15
    buffer_load_dwordx4 v32, s[24:27], s82 offen lds
    s_add_u32 s57, s57, s56
    s_add_u32 s57, s57, 16774144
    s_add_u32 s12, s54, s57
    s_addc_u32 s13, s55, 0
    s_mov_b32 s14, 35840
    s_mov_b32 s15, 0x20000
    buffer_load_dwordx4 v33, s[24:27], s82 offen offset:1024 lds
    s_add_u32 s57, s57, 132096
    s_add_u32 s16, s54, s57
    s_addc_u32 s17, s55, 0
    s_mov_b32 s18, 35840
    s_mov_b32 s19, 0x20000
    s_lshl_b32 s21, s28, 13
    buffer_load_dwordx4 a[148:151], v54, s[4:7], s83 offen offset:2048 sc1
    s_add_u32 s82, s82, 32768
    s_mov_b32 s22, 0
    s_mov_b32 s23, 1114112
    s_lshl_b32 s64, s58, 14
    s_lshl_b32 s65, s39, 6
    s_add_u32 s65, s65, s59
    s_add_u32 s64, s64, s65
    s_add_u32 m0, s99, 24576
    buffer_load_dwordx4 a[152:155], v54, s[76:79], s83 offen offset:3072 sc1
    v_lshlrev_b32 v12, 3, v4
    v_lshl_add_u32 v35, v3, 10, v12
    v_add_u32 v35, s64, v35
    v_add_u32 v12, s65, v12
    s_add_u32 s64, s48, 0
    s_addc_u32 s65, s49, 0
    buffer_load_dwordx4 v32, s[24:27], s82 offen lds
    s_mov_b32 s66, 2097152
    s_mov_b32 s67, 0x20000
    s_add_u32 s68, s60, 0
    s_addc_u32 s69, s61, 0
    s_mov_b32 s70, 1024
    s_mov_b32 s71, 0x20000
    buffer_load_dwordx4 v33, s[24:27], s82 offen offset:1024 lds
    s_add_u32 s72, s62, 0
    s_addc_u32 s73, s63, 0
    s_mov_b32 s74, 2097152
    s_mov_b32 s75, 0x20000
    s_mul_i32 s62, s3, 196608
    s_mul_i32 s63, s28, 12288
    buffer_load_dwordx4 a[156:159], v54, s[4:7], s83 offen offset:3072 sc1
    s_add_u32 s82, s82, 32768
    s_add_u32 s83, s83, 4096
    s_add_u32 s62, s62, s63
    s_add_u32 s62, s62, 41943040
    s_add_u32 s32, s54, s62
    s_addc_u32 s33, s55, 0
    s_mov_b32 s34, 159744
    s_mov_b32 s35, 0x20000
    s_add_u32 m0, s99, 49152
    buffer_load_dwordx4 a[160:163], v54, s[76:79], s83 offen offset:0 sc1
    s_add_u32 s63, s39, 0
    s_and_b32 s63, s63, 3
    s_mul_i32 s63, s63, 49152
    s_add_u32 s85, s39, 1
    s_and_b32 s85, s85, 3
    s_mul_i32 s85, s85, 49152
    buffer_load_dwordx4 v32, s[24:27], s82 offen lds
    s_add_u32 s86, s39, 2
    s_and_b32 s86, s86, 3
    s_mul_i32 s86, s86, 49152
    s_add_u32 s87, s39, 3
    s_and_b32 s87, s87, 3
    s_mul_i32 s87, s87, 49152
    buffer_load_dwordx4 v33, s[24:27], s82 offen offset:1024 lds
    v_mov_b32 v14, s100
    v_mov_b32 v15, s101
    v_mov_b32 v13, 0x10000
    s_lshl_b32 s62, s30, 5
    s_add_u32 s62, s62, s29
    s_lshl_b32 s62, s62, 7
    buffer_load_dwordx4 a[164:167], v54, s[4:7], s83 offen offset:0 sc1
    s_add_u32 s82, s82, 32768
    s_lshl_b32 s61, s30, 12
    s_lshl_b32 s60, s39, 10
    s_add_u32 s61, s61, s60
    s_add_u32 s61, s61, 0x10000
    s_waitcnt vmcnt(16)
    s_barrier
    s_cmp_lg_u32 s28, 0
    s_cbranch_scc1 proj_flagged
    s_mov_b64 exec, 1
    buffer_store_dwordx2 v[14:15], v13, s[92:95], s62 offen sc1
    s_mov_b64 exec, -1
proj_flagged:
    ds_read_b64_tr_b16 a[64:65], v16 offset:0
    ds_read_b64_tr_b16 a[66:67], v16 offset:4096
    ds_read_b64_tr_b16 a[68:69], v17 offset:0
    ds_read_b64_tr_b16 a[70:71], v17 offset:4096
    ds_read_b64_tr_b16 a[72:73], v18 offset:0
    ds_read_b64_tr_b16 a[74:75], v18 offset:4096
    ds_read_b64_tr_b16 a[76:77], v19 offset:0
    ds_read_b64_tr_b16 a[78:79], v19 offset:4096
    ds_read_b64_tr_b16 a[80:81], v20 offset:0
    ds_read_b64_tr_b16 a[82:83], v20 offset:4096
    ds_read_b64_tr_b16 a[84:85], v21 offset:0
    ds_read_b64_tr_b16 a[86:87], v21 offset:4096
    ds_read_b64_tr_b16 a[88:89], v22 offset:0
    ds_read_b64_tr_b16 a[90:91], v22 offset:4096
    ds_read_b64_tr_b16 a[92:93], v23 offset:0
    ds_read_b64_tr_b16 a[94:95], v23 offset:4096
    s_waitcnt vmcnt(8) lgkmcnt(0)
    s_barrier
    v_mfma_f32_16x16x32_bf16 v[64:67], a[64:67], a[128:131], 0
    ds_read_b64_tr_b16 a[96:97], v16 offset:8192
    ds_read_b64_tr_b16 a[98:99], v16 offset:12288
    v_mfma_f32_16x16x32_bf16 v[68:71], a[64:67], a[132:135], 0
    buffer_load_dwordx4 a[168:171], v54, s[76:79], s83 offen offset:1024 sc1
    v_mfma_f32_16x16x32_bf16 v[72:75], a[68:71], a[128:131], 0
    ds_read_b64_tr_b16 a[100:101], v17 offset:8192
    ds_read_b64_tr_b16 a[102:103], v17 offset:12288
    v_mfma_f32_16x16x32_bf16 v[76:79], a[68:71], a[132:135], 0
    s_add_u32 m0, s99, 57344
    v_mfma_f32_16x16x32_bf16 v[80:83], a[72:75], a[128:131], 0
    ds_read_b64_tr_b16 a[104:105], v18 offset:8192
    ds_read_b64_tr_b16 a[106:107], v18 offset:12288
    v_mfma_f32_16x16x32_bf16 v[84:87], a[72:75], a[132:135], 0
    buffer_load_dwordx4 v32, s[24:27], s82 offen lds
    v_mfma_f32_16x16x32_bf16 v[88:91], a[76:79], a[128:131], 0
    ds_read_b64_tr_b16 a[108:109], v19 offset:8192
    ds_read_b64_tr_b16 a[110:111], v19 offset:12288
    v_mfma_f32_16x16x32_bf16 v[92:95], a[76:79], a[132:135], 0
    s_waitcnt lgkmcnt(8)
    v_mfma_f32_16x16x32_bf16 v[96:99], a[80:83], a[128:131], 0
    ds_read_b64_tr_b16 a[112:113], v20 offset:8192
    ds_read_b64_tr_b16 a[114:115], v20 offset:12288
    v_mfma_f32_16x16x32_bf16 v[100:103], a[80:83], a[132:135], 0
    buffer_load_dwordx4 v33, s[24:27], s82 offen offset:1024 lds
    v_mfma_f32_16x16x32_bf16 v[104:107], a[84:87], a[128:131], 0
    ds_read_b64_tr_b16 a[116:117], v21 offset:8192
    ds_read_b64_tr_b16 a[118:119], v21 offset:12288
    v_mfma_f32_16x16x32_bf16 v[108:111], a[84:87], a[132:135], 0
    s_add_u32 s82, s82, 32768
    v_mfma_f32_16x16x32_bf16 v[112:115], a[88:91], a[128:131], 0
    ds_read_b64_tr_b16 a[120:121], v22 offset:8192
    ds_read_b64_tr_b16 a[122:123], v22 offset:12288
    v_mfma_f32_16x16x32_bf16 v[116:119], a[88:91], a[132:135], 0
    buffer_load_dwordx4 a[172:175], v54, s[4:7], s83 offen offset:1024 sc1
    v_mfma_f32_16x16x32_bf16 v[120:123], a[92:95], a[128:131], 0
    ds_read_b64_tr_b16 a[124:125], v23 offset:8192
    ds_read_b64_tr_b16 a[126:127], v23 offset:12288
    v_mfma_f32_16x16x32_bf16 v[124:127], a[92:95], a[132:135], 0
    s_waitcnt lgkmcnt(8)
    v_mfma_f32_16x16x32_bf16 v[64:67], a[96:99], a[136:139], v[64:67]
    ds_read_b64_tr_b16 a[64:65], v16 offset:16384
    ds_read_b64_tr_b16 a[66:67], v16 offset:20480
    v_mfma_f32_16x16x32_bf16 v[68:71], a[96:99], a[140:143], v[68:71]
    buffer_load_dwordx4 a[176:179], v54, s[76:79], s83 offen offset:2048 sc1
    v_mfma_f32_16x16x32_bf16 v[72:75], a[100:103], a[136:139], v[72:75]
    ds_read_b64_tr_b16 a[68:69], v17 offset:16384
    ds_read_b64_tr_b16 a[70:71], v17 offset:20480
    v_mfma_f32_16x16x32_bf16 v[76:79], a[100:103], a[140:143], v[76:79]
    s_add_u32 m0, s99, 32768
    v_mfma_f32_16x16x32_bf16 v[80:83], a[104:107], a[136:139], v[80:83]
    ds_read_b64_tr_b16 a[72:73], v18 offset:16384
    ds_read_b64_tr_b16 a[74:75], v18 offset:20480
    v_mfma_f32_16x16x32_bf16 v[84:87], a[104:107], a[140:143], v[84:87]
    buffer_load_dwordx4 v32, s[24:27], s82 offen lds
    v_mfma_f32_16x16x32_bf16 v[88:91], a[108:111], a[136:139], v[88:91]
    ds_read_b64_tr_b16 a[76:77], v19 offset:16384
    ds_read_b64_tr_b16 a[78:79], v19 offset:20480
    v_mfma_f32_16x16x32_bf16 v[92:95], a[108:111], a[140:143], v[92:95]
    s_waitcnt lgkmcnt(8)
    v_mfma_f32_16x16x32_bf16 v[96:99], a[112:115], a[136:139], v[96:99]
    ds_read_b64_tr_b16 a[80:81], v20 offset:16384
    ds_read_b64_tr_b16 a[82:83], v20 offset:20480
    v_mfma_f32_16x16x32_bf16 v[100:103], a[112:115], a[140:143], v[100:103]
    buffer_load_dwordx4 v33, s[24:27], s82 offen offset:1024 lds
    v_mfma_f32_16x16x32_bf16 v[104:107], a[116:119], a[136:139], v[104:107]
    ds_read_b64_tr_b16 a[84:85], v21 offset:16384
    ds_read_b64_tr_b16 a[86:87], v21 offset:20480
    v_mfma_f32_16x16x32_bf16 v[108:111], a[116:119], a[140:143], v[108:111]
    s_add_u32 s82, s82, 32768
    v_mfma_f32_16x16x32_bf16 v[112:115], a[120:123], a[136:139], v[112:115]
    ds_read_b64_tr_b16 a[88:89], v22 offset:16384
    ds_read_b64_tr_b16 a[90:91], v22 offset:20480
    v_mfma_f32_16x16x32_bf16 v[116:119], a[120:123], a[140:143], v[116:119]
    buffer_load_dwordx4 a[180:183], v54, s[4:7], s83 offen offset:2048 sc1
    v_mfma_f32_16x16x32_bf16 v[120:123], a[124:127], a[136:139], v[120:123]
    ds_read_b64_tr_b16 a[92:93], v23 offset:16384
    ds_read_b64_tr_b16 a[94:95], v23 offset:20480
    v_mfma_f32_16x16x32_bf16 v[124:127], a[124:127], a[140:143], v[124:127]
    s_waitcnt vmcnt(8) lgkmcnt(8)
    s_barrier
    v_mfma_f32_16x16x32_bf16 v[64:67], a[64:67], a[144:147], v[64:67]
    ds_read_b64_tr_b16 a[96:97], v16 offset:24576
    ds_read_b64_tr_b16 a[98:99], v16 offset:28672
    v_mfma_f32_16x16x32_bf16 v[68:71], a[64:67], a[148:151], v[68:71]
    buffer_load_dwordx4 a[184:187], v54, s[76:79], s83 offen offset:3072 sc1
    v_mfma_f32_16x16x32_bf16 v[72:75], a[68:71], a[144:147], v[72:75]
    ds_read_b64_tr_b16 a[100:101], v17 offset:24576
    ds_read_b64_tr_b16 a[102:103], v17 offset:28672
    v_mfma_f32_16x16x32_bf16 v[76:79], a[68:71], a[148:151], v[76:79]
    s_add_u32 m0, s99, 40960
    v_mfma_f32_16x16x32_bf16 v[80:83], a[72:75], a[144:147], v[80:83]
    ds_read_b64_tr_b16 a[104:105], v18 offset:24576
    ds_read_b64_tr_b16 a[106:107], v18 offset:28672
    v_mfma_f32_16x16x32_bf16 v[84:87], a[72:75], a[148:151], v[84:87]
    buffer_load_dwordx4 v32, s[24:27], s82 offen lds
    v_mfma_f32_16x16x32_bf16 v[88:91], a[76:79], a[144:147], v[88:91]
    ds_read_b64_tr_b16 a[108:109], v19 offset:24576
    ds_read_b64_tr_b16 a[110:111], v19 offset:28672
    v_mfma_f32_16x16x32_bf16 v[92:95], a[76:79], a[148:151], v[92:95]
    s_waitcnt lgkmcnt(8)
    v_mfma_f32_16x16x32_bf16 v[96:99], a[80:83], a[144:147], v[96:99]
    ds_read_b64_tr_b16 a[112:113], v20 offset:24576
    ds_read_b64_tr_b16 a[114:115], v20 offset:28672
    v_mfma_f32_16x16x32_bf16 v[100:103], a[80:83], a[148:151], v[100:103]
    buffer_load_dwordx4 v33, s[24:27], s82 offen offset:1024 lds
    v_mfma_f32_16x16x32_bf16 v[104:107], a[84:87], a[144:147], v[104:107]
    ds_read_b64_tr_b16 a[116:117], v21 offset:24576
    ds_read_b64_tr_b16 a[118:119], v21 offset:28672
    v_mfma_f32_16x16x32_bf16 v[108:111], a[84:87], a[148:151], v[108:111]
    s_add_u32 s82, s82, 32768
    v_mfma_f32_16x16x32_bf16 v[112:115], a[88:91], a[144:147], v[112:115]
    ds_read_b64_tr_b16 a[120:121], v22 offset:24576
    ds_read_b64_tr_b16 a[122:123], v22 offset:28672
    v_mfma_f32_16x16x32_bf16 v[116:119], a[88:91], a[148:151], v[116:119]
    buffer_load_dwordx4 a[188:191], v54, s[4:7], s83 offen offset:3072 sc1
    v_mfma_f32_16x16x32_bf16 v[120:123], a[92:95], a[144:147], v[120:123]
    ds_read_b64_tr_b16 a[124:125], v23 offset:24576
    ds_read_b64_tr_b16 a[126:127], v23 offset:28672
    v_mfma_f32_16x16x32_bf16 v[124:127], a[92:95], a[148:151], v[124:127]
    s_add_u32 s83, s83, 4096
    s_waitcnt lgkmcnt(8)
    s_cmp_lg_u32 s28, 3
    s_cbranch_scc1 proj_nopoll
    buffer_load_dwordx2 v[10:11], v1, s[92:95], s61 offen sc1
proj_nopoll:
    v_mfma_f32_16x16x32_bf16 v[64:67], a[96:99], a[152:155], v[64:67]
    ds_read_b64_tr_b16 a[64:65], v16 offset:49152
    ds_read_b64_tr_b16 a[66:67], v16 offset:53248
    v_mfma_f32_16x16x32_bf16 v[68:71], a[96:99], a[156:159], v[68:71]
    buffer_load_dwordx4 a[128:131], v54, s[76:79], s83 offen offset:0 sc1
    v_mfma_f32_16x16x32_bf16 v[72:75], a[100:103], a[152:155], v[72:75]
    ds_read_b64_tr_b16 a[68:69], v17 offset:49152
    ds_read_b64_tr_b16 a[70:71], v17 offset:53248
    v_mfma_f32_16x16x32_bf16 v[76:79], a[100:103], a[156:159], v[76:79]
    s_add_u32 m0, s99, 0
    v_mfma_f32_16x16x32_bf16 v[80:83], a[104:107], a[152:155], v[80:83]
    ds_read_b64_tr_b16 a[72:73], v18 offset:49152
    ds_read_b64_tr_b16 a[74:75], v18 offset:53248
    v_mfma_f32_16x16x32_bf16 v[84:87], a[104:107], a[156:159], v[84:87]
    buffer_load_dwordx4 v32, s[24:27], s82 offen lds
    v_mfma_f32_16x16x32_bf16 v[88:91], a[108:111], a[152:155], v[88:91]
    ds_read_b64_tr_b16 a[76:77], v19 offset:49152
    ds_read_b64_tr_b16 a[78:79], v19 offset:53248
    v_mfma_f32_16x16x32_bf16 v[92:95], a[108:111], a[156:159], v[92:95]
    s_waitcnt lgkmcnt(8)
    v_mfma_f32_16x16x32_bf16 v[96:99], a[112:115], a[152:155], v[96:99]
    ds_read_b64_tr_b16 a[80:81], v20 offset:49152
    ds_read_b64_tr_b16 a[82:83], v20 offset:53248
    v_mfma_f32_16x16x32_bf16 v[100:103], a[112:115], a[156:159], v[100:103]
    buffer_load_dwordx4 v33, s[24:27], s82 offen offset:1024 lds
    v_mfma_f32_16x16x32_bf16 v[104:107], a[116:119], a[152:155], v[104:107]
    ds_read_b64_tr_b16 a[84:85], v21 offset:49152
    ds_read_b64_tr_b16 a[86:87], v21 offset:53248
    v_mfma_f32_16x16x32_bf16 v[108:111], a[116:119], a[156:159], v[108:111]
    s_add_u32 s82, s82, 32768
    v_mfma_f32_16x16x32_bf16 v[112:115], a[120:123], a[152:155], v[112:115]
    ds_read_b64_tr_b16 a[88:89], v22 offset:49152
    ds_read_b64_tr_b16 a[90:91], v22 offset:53248
    v_mfma_f32_16x16x32_bf16 v[116:119], a[120:123], a[156:159], v[116:119]
    buffer_load_dwordx4 a[132:135], v54, s[4:7], s83 offen offset:0 sc1
    v_mfma_f32_16x16x32_bf16 v[120:123], a[124:127], a[152:155], v[120:123]
    ds_read_b64_tr_b16 a[92:93], v23 offset:49152
    ds_read_b64_tr_b16 a[94:95], v23 offset:53248
    v_mfma_f32_16x16x32_bf16 v[124:127], a[124:127], a[156:159], v[124:127]
    s_waitcnt vmcnt(8) lgkmcnt(8)
    s_barrier
    v_mfma_f32_16x16x32_bf16 v[64:67], a[64:67], a[160:163], v[64:67]
    ds_read_b64_tr_b16 a[96:97], v16 offset:57344
    ds_read_b64_tr_b16 a[98:99], v16 offset:61440
    v_mfma_f32_16x16x32_bf16 v[68:71], a[64:67], a[164:167], v[68:71]
    buffer_load_dwordx4 a[136:139], v54, s[76:79], s83 offen offset:1024 sc1
    v_mfma_f32_16x16x32_bf16 v[72:75], a[68:71], a[160:163], v[72:75]
    ds_read_b64_tr_b16 a[100:101], v17 offset:57344
    ds_read_b64_tr_b16 a[102:103], v17 offset:61440
    v_mfma_f32_16x16x32_bf16 v[76:79], a[68:71], a[164:167], v[76:79]
    s_add_u32 m0, s99, 8192
    v_mfma_f32_16x16x32_bf16 v[80:83], a[72:75], a[160:163], v[80:83]
    ds_read_b64_tr_b16 a[104:105], v18 offset:57344
    ds_read_b64_tr_b16 a[106:107], v18 offset:61440
    v_mfma_f32_16x16x32_bf16 v[84:87], a[72:75], a[164:167], v[84:87]
    buffer_load_dwordx4 v32, s[24:27], s82 offen lds
    v_mfma_f32_16x16x32_bf16 v[88:91], a[76:79], a[160:163], v[88:91]
    ds_read_b64_tr_b16 a[108:109], v19 offset:57344
    ds_read_b64_tr_b16 a[110:111], v19 offset:61440
    v_mfma_f32_16x16x32_bf16 v[92:95], a[76:79], a[164:167], v[92:95]
    s_waitcnt lgkmcnt(8)
    v_mfma_f32_16x16x32_bf16 v[96:99], a[80:83], a[160:163], v[96:99]
    ds_read_b64_tr_b16 a[112:113], v20 offset:57344
    ds_read_b64_tr_b16 a[114:115], v20 offset:61440
    v_mfma_f32_16x16x32_bf16 v[100:103], a[80:83], a[164:167], v[100:103]
    buffer_load_dwordx4 v33, s[24:27], s82 offen offset:1024 lds
    v_mfma_f32_16x16x32_bf16 v[104:107], a[84:87], a[160:163], v[104:107]
    ds_read_b64_tr_b16 a[116:117], v21 offset:57344
    ds_read_b64_tr_b16 a[118:119], v21 offset:61440
    v_mfma_f32_16x16x32_bf16 v[108:111], a[84:87], a[164:167], v[108:111]
    s_add_u32 s82, s82, 32768
    v_mfma_f32_16x16x32_bf16 v[112:115], a[88:91], a[160:163], v[112:115]
    ds_read_b64_tr_b16 a[120:121], v22 offset:57344
    ds_read_b64_tr_b16 a[122:123], v22 offset:61440
    v_mfma_f32_16x16x32_bf16 v[116:119], a[88:91], a[164:167], v[116:119]
    buffer_load_dwordx4 a[140:143], v54, s[4:7], s83 offen offset:1024 sc1
    v_mfma_f32_16x16x32_bf16 v[120:123], a[92:95], a[160:163], v[120:123]
    ds_read_b64_tr_b16 a[124:125], v23 offset:57344
    ds_read_b64_tr_b16 a[126:127], v23 offset:61440
    v_mfma_f32_16x16x32_bf16 v[124:127], a[92:95], a[164:167], v[124:127]
    s_waitcnt lgkmcnt(8)
    v_mfma_f32_16x16x32_bf16 v[64:67], a[96:99], a[168:171], v[64:67]
    ds_read_b64_tr_b16 a[64:65], v16 offset:32768
    ds_read_b64_tr_b16 a[66:67], v16 offset:36864
    v_mfma_f32_16x16x32_bf16 v[68:71], a[96:99], a[172:175], v[68:71]
    buffer_load_dwordx4 a[144:147], v54, s[76:79], s83 offen offset:2048 sc1
    v_mfma_f32_16x16x32_bf16 v[72:75], a[100:103], a[168:171], v[72:75]
    ds_read_b64_tr_b16 a[68:69], v17 offset:32768
    ds_read_b64_tr_b16 a[70:71], v17 offset:36864
    v_mfma_f32_16x16x32_bf16 v[76:79], a[100:103], a[172:175], v[76:79]
    s_add_u32 m0, s99, 16384
    v_mfma_f32_16x16x32_bf16 v[80:83], a[104:107], a[168:171], v[80:83]
    ds_read_b64_tr_b16 a[72:73], v18 offset:32768
    ds_read_b64_tr_b16 a[74:75], v18 offset:36864
    v_mfma_f32_16x16x32_bf16 v[84:87], a[104:107], a[172:175], v[84:87]
    buffer_load_dwordx4 v32, s[24:27], s82 offen lds
    v_mfma_f32_16x16x32_bf16 v[88:91], a[108:111], a[168:171], v[88:91]
    ds_read_b64_tr_b16 a[76:77], v19 offset:32768
    ds_read_b64_tr_b16 a[78:79], v19 offset:36864
    v_mfma_f32_16x16x32_bf16 v[92:95], a[108:111], a[172:175], v[92:95]
    s_waitcnt lgkmcnt(8)
    v_mfma_f32_16x16x32_bf16 v[96:99], a[112:115], a[168:171], v[96:99]
    ds_read_b64_tr_b16 a[80:81], v20 offset:32768
    ds_read_b64_tr_b16 a[82:83], v20 offset:36864
    v_mfma_f32_16x16x32_bf16 v[100:103], a[112:115], a[172:175], v[100:103]
    buffer_load_dwordx4 v33, s[24:27], s82 offen offset:1024 lds
    v_mfma_f32_16x16x32_bf16 v[104:107], a[116:119], a[168:171], v[104:107]
    ds_read_b64_tr_b16 a[84:85], v21 offset:32768
    ds_read_b64_tr_b16 a[86:87], v21 offset:36864
    v_mfma_f32_16x16x32_bf16 v[108:111], a[116:119], a[172:175], v[108:111]
    s_add_u32 s82, s82, 32768
    v_mfma_f32_16x16x32_bf16 v[112:115], a[120:123], a[168:171], v[112:115]
    ds_read_b64_tr_b16 a[88:89], v22 offset:32768
    ds_read_b64_tr_b16 a[90:91], v22 offset:36864
    v_mfma_f32_16x16x32_bf16 v[116:119], a[120:123], a[172:175], v[116:119]
    buffer_load_dwordx4 a[148:151], v54, s[4:7], s83 offen offset:2048 sc1
    v_mfma_f32_16x16x32_bf16 v[120:123], a[124:127], a[168:171], v[120:123]
    ds_read_b64_tr_b16 a[92:93], v23 offset:32768
    ds_read_b64_tr_b16 a[94:95], v23 offset:36864
    v_mfma_f32_16x16x32_bf16 v[124:127], a[124:127], a[172:175], v[124:127]
    s_cmp_lg_u32 s28, 3
    s_cbranch_scc1 proj_oready
    s_waitcnt vmcnt(12)
    s_mov_b64 exec, 0xff
proj_owait:
    v_cmp_ne_u64 vcc, s[100:101], v[10:11]
    s_cbranch_vccz proj_oseen
    buffer_load_dwordx2 v[10:11], v1, s[92:95], s61 offen sc1
    s_waitcnt vmcnt(0)
    s_branch proj_owait
proj_oseen:
    s_mov_b64 exec, -1
proj_oready:
    s_waitcnt vmcnt(8) lgkmcnt(8)
    s_barrier
    v_mfma_f32_16x16x32_bf16 v[64:67], a[64:67], a[176:179], v[64:67]
    ds_read_b64_tr_b16 a[96:97], v16 offset:40960
    ds_read_b64_tr_b16 a[98:99], v16 offset:45056
    v_mfma_f32_16x16x32_bf16 v[68:71], a[64:67], a[180:183], v[68:71]
    buffer_load_dwordx4 a[152:155], v54, s[12:15], s22 offen offset:3072 sc1
    v_mfma_f32_16x16x32_bf16 v[72:75], a[68:71], a[176:179], v[72:75]
    ds_read_b64_tr_b16 a[100:101], v17 offset:40960
    ds_read_b64_tr_b16 a[102:103], v17 offset:45056
    v_mfma_f32_16x16x32_bf16 v[76:79], a[68:71], a[180:183], v[76:79]
    s_add_u32 m0, s99, 24576
    v_mfma_f32_16x16x32_bf16 v[80:83], a[72:75], a[176:179], v[80:83]
    ds_read_b64_tr_b16 a[104:105], v18 offset:40960
    ds_read_b64_tr_b16 a[106:107], v18 offset:45056
    v_mfma_f32_16x16x32_bf16 v[84:87], a[72:75], a[180:183], v[84:87]
    buffer_load_dwordx4 v32, s[8:11], s21 offen lds
    v_mfma_f32_16x16x32_bf16 v[88:91], a[76:79], a[176:179], v[88:91]
    ds_read_b64_tr_b16 a[108:109], v19 offset:40960
    ds_read_b64_tr_b16 a[110:111], v19 offset:45056
    v_mfma_f32_16x16x32_bf16 v[92:95], a[76:79], a[180:183], v[92:95]
    s_waitcnt lgkmcnt(8)
    v_mfma_f32_16x16x32_bf16 v[96:99], a[80:83], a[176:179], v[96:99]
    ds_read_b64_tr_b16 a[112:113], v20 offset:40960
    ds_read_b64_tr_b16 a[114:115], v20 offset:45056
    v_mfma_f32_16x16x32_bf16 v[100:103], a[80:83], a[180:183], v[100:103]
    buffer_load_dwordx4 v33, s[8:11], s21 offen offset:1024 lds
    v_mfma_f32_16x16x32_bf16 v[104:107], a[84:87], a[176:179], v[104:107]
    ds_read_b64_tr_b16 a[116:117], v21 offset:40960
    ds_read_b64_tr_b16 a[118:119], v21 offset:45056
    v_mfma_f32_16x16x32_bf16 v[108:111], a[84:87], a[180:183], v[108:111]
    s_add_u32 s21, s21, 32768
    v_mfma_f32_16x16x32_bf16 v[112:115], a[88:91], a[176:179], v[112:115]
    ds_read_b64_tr_b16 a[120:121], v22 offset:40960
    ds_read_b64_tr_b16 a[122:123], v22 offset:45056
    v_mfma_f32_16x16x32_bf16 v[116:119], a[88:91], a[180:183], v[116:119]
    buffer_load_dwordx4 a[156:159], v54, s[16:19], s22 offen offset:3072 sc1
    v_mfma_f32_16x16x32_bf16 v[120:123], a[92:95], a[176:179], v[120:123]
    ds_read_b64_tr_b16 a[124:125], v23 offset:40960
    ds_read_b64_tr_b16 a[126:127], v23 offset:45056
    v_mfma_f32_16x16x32_bf16 v[124:127], a[92:95], a[180:183], v[124:127]
    s_add_u32 s22, s22, 4096
    s_waitcnt lgkmcnt(8)
    v_mfma_f32_16x16x32_bf16 v[64:67], a[96:99], a[184:187], v[64:67]
    ds_read_b64_tr_b16 a[64:65], v16 offset:0
    ds_read_b64_tr_b16 a[66:67], v16 offset:4096
    v_mfma_f32_16x16x32_bf16 v[68:71], a[96:99], a[188:191], v[68:71]
    buffer_load_dwordx4 a[160:163], v54, s[12:15], s22 offen offset:0 sc1
    v_mfma_f32_16x16x32_bf16 v[72:75], a[100:103], a[184:187], v[72:75]
    ds_read_b64_tr_b16 a[68:69], v17 offset:0
    ds_read_b64_tr_b16 a[70:71], v17 offset:4096
    v_mfma_f32_16x16x32_bf16 v[76:79], a[100:103], a[188:191], v[76:79]
    s_add_u32 m0, s99, 49152
    v_mfma_f32_16x16x32_bf16 v[80:83], a[104:107], a[184:187], v[80:83]
    ds_read_b64_tr_b16 a[72:73], v18 offset:0
    ds_read_b64_tr_b16 a[74:75], v18 offset:4096
    v_mfma_f32_16x16x32_bf16 v[84:87], a[104:107], a[188:191], v[84:87]
    buffer_load_dwordx4 v32, s[8:11], s21 offen lds
    v_mfma_f32_16x16x32_bf16 v[88:91], a[108:111], a[184:187], v[88:91]
    ds_read_b64_tr_b16 a[76:77], v19 offset:0
    ds_read_b64_tr_b16 a[78:79], v19 offset:4096
    v_mfma_f32_16x16x32_bf16 v[92:95], a[108:111], a[188:191], v[92:95]
    s_waitcnt lgkmcnt(8)
    v_mfma_f32_16x16x32_bf16 v[96:99], a[112:115], a[184:187], v[96:99]
    ds_read_b64_tr_b16 a[80:81], v20 offset:0
    ds_read_b64_tr_b16 a[82:83], v20 offset:4096
    v_mfma_f32_16x16x32_bf16 v[100:103], a[112:115], a[188:191], v[100:103]
    buffer_load_dwordx4 v33, s[8:11], s21 offen offset:1024 lds
    v_mfma_f32_16x16x32_bf16 v[104:107], a[116:119], a[184:187], v[104:107]
    ds_read_b64_tr_b16 a[84:85], v21 offset:0
    ds_read_b64_tr_b16 a[86:87], v21 offset:4096
    v_mfma_f32_16x16x32_bf16 v[108:111], a[116:119], a[188:191], v[108:111]
    s_add_u32 s21, s21, 32768
    v_mfma_f32_16x16x32_bf16 v[112:115], a[120:123], a[184:187], v[112:115]
    ds_read_b64_tr_b16 a[88:89], v22 offset:0
    ds_read_b64_tr_b16 a[90:91], v22 offset:4096
    v_mfma_f32_16x16x32_bf16 v[116:119], a[120:123], a[188:191], v[116:119]
    buffer_load_dwordx4 a[164:167], v54, s[16:19], s22 offen offset:0 sc1
    v_mfma_f32_16x16x32_bf16 v[120:123], a[124:127], a[184:187], v[120:123]
    ds_read_b64_tr_b16 a[92:93], v23 offset:0
    ds_read_b64_tr_b16 a[94:95], v23 offset:4096
    v_mfma_f32_16x16x32_bf16 v[124:127], a[124:127], a[188:191], v[124:127]
    s_waitcnt vmcnt(8) lgkmcnt(8)
    s_barrier
    v_mfma_f32_16x16x32_bf16 v[64:67], a[64:67], a[128:131], v[64:67]
    ds_read_b64_tr_b16 a[96:97], v16 offset:8192
    ds_read_b64_tr_b16 a[98:99], v16 offset:12288
    v_mfma_f32_16x16x32_bf16 v[68:71], a[64:67], a[132:135], v[68:71]
    buffer_load_dwordx4 a[168:171], v54, s[12:15], s22 offen offset:1024 sc1
    v_mfma_f32_16x16x32_bf16 v[72:75], a[68:71], a[128:131], v[72:75]
    ds_read_b64_tr_b16 a[100:101], v17 offset:8192
    ds_read_b64_tr_b16 a[102:103], v17 offset:12288
    v_mfma_f32_16x16x32_bf16 v[76:79], a[68:71], a[132:135], v[76:79]
    s_add_u32 m0, s99, 57344
    v_mfma_f32_16x16x32_bf16 v[80:83], a[72:75], a[128:131], v[80:83]
    ds_read_b64_tr_b16 a[104:105], v18 offset:8192
    ds_read_b64_tr_b16 a[106:107], v18 offset:12288
    v_mfma_f32_16x16x32_bf16 v[84:87], a[72:75], a[132:135], v[84:87]
    buffer_load_dwordx4 v32, s[8:11], s21 offen lds
    v_mfma_f32_16x16x32_bf16 v[88:91], a[76:79], a[128:131], v[88:91]
    ds_read_b64_tr_b16 a[108:109], v19 offset:8192
    ds_read_b64_tr_b16 a[110:111], v19 offset:12288
    v_mfma_f32_16x16x32_bf16 v[92:95], a[76:79], a[132:135], v[92:95]
    s_waitcnt lgkmcnt(8)
    v_mfma_f32_16x16x32_bf16 v[96:99], a[80:83], a[128:131], v[96:99]
    ds_read_b64_tr_b16 a[112:113], v20 offset:8192
    ds_read_b64_tr_b16 a[114:115], v20 offset:12288
    v_mfma_f32_16x16x32_bf16 v[100:103], a[80:83], a[132:135], v[100:103]
    buffer_load_dwordx4 v33, s[8:11], s21 offen offset:1024 lds
    v_mfma_f32_16x16x32_bf16 v[104:107], a[84:87], a[128:131], v[104:107]
    ds_read_b64_tr_b16 a[116:117], v21 offset:8192
    ds_read_b64_tr_b16 a[118:119], v21 offset:12288
    v_mfma_f32_16x16x32_bf16 v[108:111], a[84:87], a[132:135], v[108:111]
    s_add_u32 s21, s21, 32768
    v_mfma_f32_16x16x32_bf16 v[112:115], a[88:91], a[128:131], v[112:115]
    ds_read_b64_tr_b16 a[120:121], v22 offset:8192
    ds_read_b64_tr_b16 a[122:123], v22 offset:12288
    v_mfma_f32_16x16x32_bf16 v[116:119], a[88:91], a[132:135], v[116:119]
    buffer_load_dwordx4 a[172:175], v54, s[16:19], s22 offen offset:1024 sc1
    v_mfma_f32_16x16x32_bf16 v[120:123], a[92:95], a[128:131], v[120:123]
    ds_read_b64_tr_b16 a[124:125], v23 offset:8192
    ds_read_b64_tr_b16 a[126:127], v23 offset:12288
    v_mfma_f32_16x16x32_bf16 v[124:127], a[92:95], a[132:135], v[124:127]
    s_waitcnt lgkmcnt(8)
    v_mfma_f32_16x16x32_bf16 v[64:67], a[96:99], a[136:139], v[64:67]
    ds_read_b64_tr_b16 a[64:65], v16 offset:16384
    ds_read_b64_tr_b16 a[66:67], v16 offset:20480
    v_mfma_f32_16x16x32_bf16 v[68:71], a[96:99], a[140:143], v[68:71]
    buffer_load_dwordx4 a[176:179], v54, s[12:15], s22 offen offset:2048 sc1
    v_mfma_f32_16x16x32_bf16 v[72:75], a[100:103], a[136:139], v[72:75]
    ds_read_b64_tr_b16 a[68:69], v17 offset:16384
    ds_read_b64_tr_b16 a[70:71], v17 offset:20480
    v_mfma_f32_16x16x32_bf16 v[76:79], a[100:103], a[140:143], v[76:79]
    s_add_u32 m0, s99, 32768
    v_mfma_f32_16x16x32_bf16 v[80:83], a[104:107], a[136:139], v[80:83]
    ds_read_b64_tr_b16 a[72:73], v18 offset:16384
    ds_read_b64_tr_b16 a[74:75], v18 offset:20480
    v_mfma_f32_16x16x32_bf16 v[84:87], a[104:107], a[140:143], v[84:87]
    buffer_load_dwordx4 v32, s[8:11], s21 offen lds
    v_mfma_f32_16x16x32_bf16 v[88:91], a[108:111], a[136:139], v[88:91]
    ds_read_b64_tr_b16 a[76:77], v19 offset:16384
    ds_read_b64_tr_b16 a[78:79], v19 offset:20480
    v_mfma_f32_16x16x32_bf16 v[92:95], a[108:111], a[140:143], v[92:95]
    s_waitcnt lgkmcnt(8)
    v_mfma_f32_16x16x32_bf16 v[96:99], a[112:115], a[136:139], v[96:99]
    ds_read_b64_tr_b16 a[80:81], v20 offset:16384
    ds_read_b64_tr_b16 a[82:83], v20 offset:20480
    v_mfma_f32_16x16x32_bf16 v[100:103], a[112:115], a[140:143], v[100:103]
    buffer_load_dwordx4 v33, s[8:11], s21 offen offset:1024 lds
    v_mfma_f32_16x16x32_bf16 v[104:107], a[116:119], a[136:139], v[104:107]
    ds_read_b64_tr_b16 a[84:85], v21 offset:16384
    ds_read_b64_tr_b16 a[86:87], v21 offset:20480
    v_mfma_f32_16x16x32_bf16 v[108:111], a[116:119], a[140:143], v[108:111]
    s_add_u32 s21, s21, 32768
    v_mfma_f32_16x16x32_bf16 v[112:115], a[120:123], a[136:139], v[112:115]
    ds_read_b64_tr_b16 a[88:89], v22 offset:16384
    ds_read_b64_tr_b16 a[90:91], v22 offset:20480
    v_mfma_f32_16x16x32_bf16 v[116:119], a[120:123], a[140:143], v[116:119]
    buffer_load_dwordx4 a[180:183], v54, s[16:19], s22 offen offset:2048 sc1
    v_mfma_f32_16x16x32_bf16 v[120:123], a[124:127], a[136:139], v[120:123]
    ds_read_b64_tr_b16 a[92:93], v23 offset:16384
    ds_read_b64_tr_b16 a[94:95], v23 offset:20480
    v_mfma_f32_16x16x32_bf16 v[124:127], a[124:127], a[140:143], v[124:127]
    s_waitcnt vmcnt(8) lgkmcnt(8)
    s_barrier
    v_mfma_f32_16x16x32_bf16 v[64:67], a[64:67], a[144:147], v[64:67]
    ds_read_b64_tr_b16 a[96:97], v16 offset:24576
    ds_read_b64_tr_b16 a[98:99], v16 offset:28672
    v_mfma_f32_16x16x32_bf16 v[68:71], a[64:67], a[148:151], v[68:71]
    buffer_load_dwordx4 a[184:187], v54, s[12:15], s22 offen offset:3072 sc1
    v_mfma_f32_16x16x32_bf16 v[72:75], a[68:71], a[144:147], v[72:75]
    ds_read_b64_tr_b16 a[100:101], v17 offset:24576
    ds_read_b64_tr_b16 a[102:103], v17 offset:28672
    v_mfma_f32_16x16x32_bf16 v[76:79], a[68:71], a[148:151], v[76:79]
    s_add_u32 m0, s99, 40960
    v_mfma_f32_16x16x32_bf16 v[80:83], a[72:75], a[144:147], v[80:83]
    ds_read_b64_tr_b16 a[104:105], v18 offset:24576
    ds_read_b64_tr_b16 a[106:107], v18 offset:28672
    v_mfma_f32_16x16x32_bf16 v[84:87], a[72:75], a[148:151], v[84:87]
    buffer_load_dwordx4 v32, s[8:11], s21 offen lds
    v_mfma_f32_16x16x32_bf16 v[88:91], a[76:79], a[144:147], v[88:91]
    ds_read_b64_tr_b16 a[108:109], v19 offset:24576
    ds_read_b64_tr_b16 a[110:111], v19 offset:28672
    v_mfma_f32_16x16x32_bf16 v[92:95], a[76:79], a[148:151], v[92:95]
    s_waitcnt lgkmcnt(8)
    v_mfma_f32_16x16x32_bf16 v[96:99], a[80:83], a[144:147], v[96:99]
    ds_read_b64_tr_b16 a[112:113], v20 offset:24576
    ds_read_b64_tr_b16 a[114:115], v20 offset:28672
    v_mfma_f32_16x16x32_bf16 v[100:103], a[80:83], a[148:151], v[100:103]
    buffer_load_dwordx4 v33, s[8:11], s21 offen offset:1024 lds
    v_mfma_f32_16x16x32_bf16 v[104:107], a[84:87], a[144:147], v[104:107]
    ds_read_b64_tr_b16 a[116:117], v21 offset:24576
    ds_read_b64_tr_b16 a[118:119], v21 offset:28672
    v_mfma_f32_16x16x32_bf16 v[108:111], a[84:87], a[148:151], v[108:111]
    s_add_u32 s21, s21, 32768
    v_mfma_f32_16x16x32_bf16 v[112:115], a[88:91], a[144:147], v[112:115]
    ds_read_b64_tr_b16 a[120:121], v22 offset:24576
    ds_read_b64_tr_b16 a[122:123], v22 offset:28672
    v_mfma_f32_16x16x32_bf16 v[116:119], a[88:91], a[148:151], v[116:119]
    buffer_load_dwordx4 a[188:191], v54, s[16:19], s22 offen offset:3072 sc1
    v_mfma_f32_16x16x32_bf16 v[120:123], a[92:95], a[144:147], v[120:123]
    ds_read_b64_tr_b16 a[124:125], v23 offset:24576
    ds_read_b64_tr_b16 a[126:127], v23 offset:28672
    v_mfma_f32_16x16x32_bf16 v[124:127], a[92:95], a[148:151], v[124:127]
    s_add_u32 s22, s22, 4096
    s_waitcnt lgkmcnt(8)
    v_mfma_f32_16x16x32_bf16 v[192:195], a[96:99], a[152:155], 0
    ds_read_b64_tr_b16 a[64:65], v16 offset:49152
    ds_read_b64_tr_b16 a[66:67], v16 offset:53248
    v_mfma_f32_16x16x32_bf16 v[196:199], a[96:99], a[156:159], 0
    buffer_load_dwordx4 a[128:131], v54, s[12:15], s22 offen offset:0 sc1
    v_mfma_f32_16x16x32_bf16 v[200:203], a[100:103], a[152:155], 0
    ds_read_b64_tr_b16 a[68:69], v17 offset:49152
    ds_read_b64_tr_b16 a[70:71], v17 offset:53248
    v_mfma_f32_16x16x32_bf16 v[204:207], a[100:103], a[156:159], 0
    s_add_u32 m0, s99, 0
    v_cvt_pk_bf16_f32 v128, v80, v81
    v_cvt_pk_bf16_f32 v129, v82, v83
    v_cvt_pk_bf16_f32 v130, v84, v85
    v_cvt_pk_bf16_f32 v131, v86, v87
    v_mfma_f32_16x16x32_bf16 v[208:211], a[104:107], a[152:155], 0
    ds_read_b64_tr_b16 a[72:73], v18 offset:49152
    ds_read_b64_tr_b16 a[74:75], v18 offset:53248
    v_mfma_f32_16x16x32_bf16 v[212:215], a[104:107], a[156:159], 0
    buffer_load_dwordx4 v32, s[8:11], s21 offen lds
    v_mfma_f32_16x16x32_bf16 v[216:219], a[108:111], a[152:155], 0
    ds_read_b64_tr_b16 a[76:77], v19 offset:49152
    ds_read_b64_tr_b16 a[78:79], v19 offset:53248
    v_mfma_f32_16x16x32_bf16 v[220:223], a[108:111], a[156:159], 0
    s_waitcnt lgkmcnt(8)
    v_cvt_pk_bf16_f32 v132, v88, v89
    v_cvt_pk_bf16_f32 v133, v90, v91
    v_cvt_pk_bf16_f32 v134, v92, v93
    v_cvt_pk_bf16_f32 v135, v94, v95
    v_mfma_f32_16x16x32_bf16 v[224:227], a[112:115], a[152:155], 0
    ds_read_b64_tr_b16 a[80:81], v20 offset:49152
    ds_read_b64_tr_b16 a[82:83], v20 offset:53248
    v_mfma_f32_16x16x32_bf16 v[228:231], a[112:115], a[156:159], 0
    buffer_load_dwordx4 v33, s[8:11], s21 offen offset:1024 lds
    v_mfma_f32_16x16x32_bf16 v[232:235], a[116:119], a[152:155], 0
    ds_read_b64_tr_b16 a[84:85], v21 offset:49152
    ds_read_b64_tr_b16 a[86:87], v21 offset:53248
    v_mfma_f32_16x16x32_bf16 v[236:239], a[116:119], a[156:159], 0
    s_add_u32 s21, s21, 32768
    v_min_u32 v128, -2, v128
    v_min_u32 v129, -2, v129
    v_min_u32 v130, -2, v130
    v_min_u32 v131, -2, v131
    v_mfma_f32_16x16x32_bf16 v[240:243], a[120:123], a[152:155], 0
    ds_read_b64_tr_b16 a[88:89], v22 offset:49152
    ds_read_b64_tr_b16 a[90:91], v22 offset:53248
    v_mfma_f32_16x16x32_bf16 v[244:247], a[120:123], a[156:159], 0
    buffer_load_dwordx4 a[132:135], v54, s[16:19], s22 offen offset:0 sc1
    v_mfma_f32_16x16x32_bf16 v[248:251], a[124:127], a[152:155], 0
    ds_read_b64_tr_b16 a[92:93], v23 offset:49152
    ds_read_b64_tr_b16 a[94:95], v23 offset:53248
    v_mfma_f32_16x16x32_bf16 v[252:255], a[124:127], a[156:159], 0
    v_min_u32 v132, -2, v132
    v_min_u32 v133, -2, v133
    v_min_u32 v134, -2, v134
    v_min_u32 v135, -2, v135
    s_waitcnt vmcnt(8) lgkmcnt(8)
    s_barrier
    v_mfma_f32_16x16x32_bf16 v[192:195], a[64:67], a[160:163], v[192:195]
    ds_read_b64_tr_b16 a[96:97], v16 offset:57344
    ds_read_b64_tr_b16 a[98:99], v16 offset:61440
    v_mfma_f32_16x16x32_bf16 v[196:199], a[64:67], a[164:167], v[196:199]
    buffer_load_dwordx4 a[136:139], v54, s[12:15], s22 offen offset:1024 sc1
    v_mfma_f32_16x16x32_bf16 v[200:203], a[68:71], a[160:163], v[200:203]
    ds_read_b64_tr_b16 a[100:101], v17 offset:57344
    ds_read_b64_tr_b16 a[102:103], v17 offset:61440
    v_mfma_f32_16x16x32_bf16 v[204:207], a[68:71], a[164:167], v[204:207]
    s_add_u32 m0, s99, 8192
    s_add_u32 s62, s85, 0
    buffer_store_dwordx4 v[128:131], v54, s[32:35], s62 offen offset:0 sc1
    buffer_store_dwordx4 v[132:135], v54, s[32:35], s62 offen offset:1024 sc1
    v_cvt_pk_bf16_f32 v136, v96, v97
    v_mfma_f32_16x16x32_bf16 v[208:211], a[72:75], a[160:163], v[208:211]
    ds_read_b64_tr_b16 a[104:105], v18 offset:57344
    ds_read_b64_tr_b16 a[106:107], v18 offset:61440
    v_mfma_f32_16x16x32_bf16 v[212:215], a[72:75], a[164:167], v[212:215]
    buffer_load_dwordx4 v32, s[8:11], s21 offen lds
    v_mfma_f32_16x16x32_bf16 v[216:219], a[76:79], a[160:163], v[216:219]
    ds_read_b64_tr_b16 a[108:109], v19 offset:57344
    ds_read_b64_tr_b16 a[110:111], v19 offset:61440
    v_mfma_f32_16x16x32_bf16 v[220:223], a[76:79], a[164:167], v[220:223]
    s_waitcnt lgkmcnt(8)
    v_cvt_pk_bf16_f32 v137, v98, v99
    v_cvt_pk_bf16_f32 v138, v100, v101
    v_cvt_pk_bf16_f32 v139, v102, v103
    v_cvt_pk_bf16_f32 v140, v104, v105
    v_mfma_f32_16x16x32_bf16 v[224:227], a[80:83], a[160:163], v[224:227]
    ds_read_b64_tr_b16 a[112:113], v20 offset:57344
    ds_read_b64_tr_b16 a[114:115], v20 offset:61440
    v_mfma_f32_16x16x32_bf16 v[228:231], a[80:83], a[164:167], v[228:231]
    buffer_load_dwordx4 v33, s[8:11], s21 offen offset:1024 lds
    v_mfma_f32_16x16x32_bf16 v[232:235], a[84:87], a[160:163], v[232:235]
    ds_read_b64_tr_b16 a[116:117], v21 offset:57344
    ds_read_b64_tr_b16 a[118:119], v21 offset:61440
    v_mfma_f32_16x16x32_bf16 v[236:239], a[84:87], a[164:167], v[236:239]
    s_add_u32 s21, s21, 32768
    v_cvt_pk_bf16_f32 v141, v106, v107
    v_cvt_pk_bf16_f32 v142, v108, v109
    v_cvt_pk_bf16_f32 v143, v110, v111
    v_min_u32 v136, -2, v136
    v_mfma_f32_16x16x32_bf16 v[240:243], a[88:91], a[160:163], v[240:243]
    ds_read_b64_tr_b16 a[120:121], v22 offset:57344
    ds_read_b64_tr_b16 a[122:123], v22 offset:61440
    v_mfma_f32_16x16x32_bf16 v[244:247], a[88:91], a[164:167], v[244:247]
    buffer_load_dwordx4 a[140:143], v54, s[16:19], s22 offen offset:1024 sc1
    v_mfma_f32_16x16x32_bf16 v[248:251], a[92:95], a[160:163], v[248:251]
    ds_read_b64_tr_b16 a[124:125], v23 offset:57344
    ds_read_b64_tr_b16 a[126:127], v23 offset:61440
    v_mfma_f32_16x16x32_bf16 v[252:255], a[92:95], a[164:167], v[252:255]
    v_min_u32 v137, -2, v137
    v_min_u32 v138, -2, v138
    v_min_u32 v139, -2, v139
    v_min_u32 v140, -2, v140
    s_waitcnt lgkmcnt(8)
    v_mfma_f32_16x16x32_bf16 v[192:195], a[96:99], a[168:171], v[192:195]
    ds_read_b64_tr_b16 a[64:65], v16 offset:32768
    ds_read_b64_tr_b16 a[66:67], v16 offset:36864
    v_mfma_f32_16x16x32_bf16 v[196:199], a[96:99], a[172:175], v[196:199]
    buffer_load_dwordx4 a[144:147], v54, s[12:15], s22 offen offset:2048 sc1
    v_mfma_f32_16x16x32_bf16 v[200:203], a[100:103], a[168:171], v[200:203]
    ds_read_b64_tr_b16 a[68:69], v17 offset:32768
    ds_read_b64_tr_b16 a[70:71], v17 offset:36864
    v_mfma_f32_16x16x32_bf16 v[204:207], a[100:103], a[172:175], v[204:207]
    s_add_u32 m0, s99, 16384
    v_min_u32 v141, -2, v141
    v_min_u32 v142, -2, v142
    v_min_u32 v143, -2, v143
    s_add_u32 s62, s86, 2048
    v_mfma_f32_16x16x32_bf16 v[208:211], a[104:107], a[168:171], v[208:211]
    ds_read_b64_tr_b16 a[72:73], v18 offset:32768
    ds_read_b64_tr_b16 a[74:75], v18 offset:36864
    v_mfma_f32_16x16x32_bf16 v[212:215], a[104:107], a[172:175], v[212:215]
    buffer_load_dwordx4 v32, s[8:11], s21 offen lds
    v_mfma_f32_16x16x32_bf16 v[216:219], a[108:111], a[168:171], v[216:219]
    ds_read_b64_tr_b16 a[76:77], v19 offset:32768
    ds_read_b64_tr_b16 a[78:79], v19 offset:36864
    v_mfma_f32_16x16x32_bf16 v[220:223], a[108:111], a[172:175], v[220:223]
    buffer_store_dwordx4 v[140:143], v54, s[32:35], s62 offen offset:1024 sc1
    buffer_store_dwordx4 v[136:139], v54, s[32:35], s62 offen offset:0 sc1
    s_waitcnt lgkmcnt(8)
    v_cvt_pk_bf16_f32 v144, v112, v113
    v_cvt_pk_bf16_f32 v145, v114, v115
    v_mfma_f32_16x16x32_bf16 v[224:227], a[112:115], a[168:171], v[224:227]
    ds_read_b64_tr_b16 a[80:81], v20 offset:32768
    ds_read_b64_tr_b16 a[82:83], v20 offset:36864
    v_mfma_f32_16x16x32_bf16 v[228:231], a[112:115], a[172:175], v[228:231]
    buffer_load_dwordx4 v33, s[8:11], s21 offen offset:1024 lds
    v_mfma_f32_16x16x32_bf16 v[232:235], a[116:119], a[168:171], v[232:235]
    ds_read_b64_tr_b16 a[84:85], v21 offset:32768
    ds_read_b64_tr_b16 a[86:87], v21 offset:36864
    v_mfma_f32_16x16x32_bf16 v[236:239], a[116:119], a[172:175], v[236:239]
    s_add_u32 s21, s21, 32768
    v_cvt_pk_bf16_f32 v146, v116, v117
    v_cvt_pk_bf16_f32 v147, v118, v119
    v_cvt_pk_bf16_f32 v148, v120, v121
    v_cvt_pk_bf16_f32 v149, v122, v123
    v_mfma_f32_16x16x32_bf16 v[240:243], a[120:123], a[168:171], v[240:243]
    ds_read_b64_tr_b16 a[88:89], v22 offset:32768
    ds_read_b64_tr_b16 a[90:91], v22 offset:36864
    v_mfma_f32_16x16x32_bf16 v[244:247], a[120:123], a[172:175], v[244:247]
    buffer_load_dwordx4 a[148:151], v54, s[16:19], s22 offen offset:2048 sc1
    v_mfma_f32_16x16x32_bf16 v[248:251], a[124:127], a[168:171], v[248:251]
    ds_read_b64_tr_b16 a[92:93], v23 offset:32768
    ds_read_b64_tr_b16 a[94:95], v23 offset:36864
    v_mfma_f32_16x16x32_bf16 v[252:255], a[124:127], a[172:175], v[252:255]
    v_cvt_pk_bf16_f32 v150, v124, v125
    v_cvt_pk_bf16_f32 v151, v126, v127
    v_min_u32 v144, -2, v144
    v_min_u32 v145, -2, v145
    s_waitcnt vmcnt(12) lgkmcnt(8)
    s_barrier
    v_mfma_f32_16x16x32_bf16 v[192:195], a[64:67], a[176:179], v[192:195]
    ds_read_b64_tr_b16 a[96:97], v16 offset:40960
    ds_read_b64_tr_b16 a[98:99], v16 offset:45056
    v_mfma_f32_16x16x32_bf16 v[196:199], a[64:67], a[180:183], v[196:199]
    buffer_load_dwordx4 a[152:155], v54, s[12:15], s22 offen offset:3072 sc1
    v_mfma_f32_16x16x32_bf16 v[200:203], a[68:71], a[176:179], v[200:203]
    ds_read_b64_tr_b16 a[100:101], v17 offset:40960
    ds_read_b64_tr_b16 a[102:103], v17 offset:45056
    v_mfma_f32_16x16x32_bf16 v[204:207], a[68:71], a[180:183], v[204:207]
    s_add_u32 m0, s99, 24576
    v_min_u32 v146, -2, v146
    v_min_u32 v147, -2, v147
    v_min_u32 v148, -2, v148
    v_min_u32 v149, -2, v149
    v_mfma_f32_16x16x32_bf16 v[208:211], a[72:75], a[176:179], v[208:211]
    ds_read_b64_tr_b16 a[104:105], v18 offset:40960
    ds_read_b64_tr_b16 a[106:107], v18 offset:45056
    v_mfma_f32_16x16x32_bf16 v[212:215], a[72:75], a[180:183], v[212:215]
    buffer_load_dwordx4 v32, s[8:11], s21 offen lds
    v_mfma_f32_16x16x32_bf16 v[216:219], a[76:79], a[176:179], v[216:219]
    ds_read_b64_tr_b16 a[108:109], v19 offset:40960
    ds_read_b64_tr_b16 a[110:111], v19 offset:45056
    v_mfma_f32_16x16x32_bf16 v[220:223], a[76:79], a[180:183], v[220:223]
    s_waitcnt lgkmcnt(8)
    v_min_u32 v150, -2, v150
    v_min_u32 v151, -2, v151
    s_add_u32 s62, s87, 4096
    buffer_store_dwordx4 v[144:147], v54, s[32:35], s62 offen offset:0 sc1
    v_mfma_f32_16x16x32_bf16 v[224:227], a[80:83], a[176:179], v[224:227]
    ds_read_b64_tr_b16 a[112:113], v20 offset:40960
    ds_read_b64_tr_b16 a[114:115], v20 offset:45056
    v_mfma_f32_16x16x32_bf16 v[228:231], a[80:83], a[180:183], v[228:231]
    buffer_load_dwordx4 v33, s[8:11], s21 offen offset:1024 lds
    v_mfma_f32_16x16x32_bf16 v[232:235], a[84:87], a[176:179], v[232:235]
    ds_read_b64_tr_b16 a[116:117], v21 offset:40960
    ds_read_b64_tr_b16 a[118:119], v21 offset:45056
    v_mfma_f32_16x16x32_bf16 v[236:239], a[84:87], a[180:183], v[236:239]
    buffer_store_dwordx4 v[148:151], v54, s[32:35], s62 offen offset:1024 sc1
    s_add_u32 s21, s21, 32768
    v_mfma_f32_16x16x32_bf16 v[240:243], a[88:91], a[176:179], v[240:243]
    ds_read_b64_tr_b16 a[120:121], v22 offset:40960
    ds_read_b64_tr_b16 a[122:123], v22 offset:45056
    v_mfma_f32_16x16x32_bf16 v[244:247], a[88:91], a[180:183], v[244:247]
    buffer_load_dwordx4 a[156:159], v54, s[16:19], s22 offen offset:3072 sc1
    v_mfma_f32_16x16x32_bf16 v[248:251], a[92:95], a[176:179], v[248:251]
    ds_read_b64_tr_b16 a[124:125], v23 offset:40960
    ds_read_b64_tr_b16 a[126:127], v23 offset:45056
    v_mfma_f32_16x16x32_bf16 v[252:255], a[92:95], a[180:183], v[252:255]
    s_add_u32 s22, s22, 4096
    s_waitcnt lgkmcnt(8)
    v_mfma_f32_16x16x32_bf16 v[192:195], a[96:99], a[184:187], v[192:195]
    ds_read_b64_tr_b16 a[64:65], v16 offset:0
    ds_read_b64_tr_b16 a[66:67], v16 offset:4096
    v_mfma_f32_16x16x32_bf16 v[196:199], a[96:99], a[188:191], v[196:199]
    buffer_load_dwordx4 a[160:163], v54, s[12:15], s22 offen offset:0 sc1
    v_mfma_f32_16x16x32_bf16 v[200:203], a[100:103], a[184:187], v[200:203]
    ds_read_b64_tr_b16 a[68:69], v17 offset:0
    ds_read_b64_tr_b16 a[70:71], v17 offset:4096
    v_mfma_f32_16x16x32_bf16 v[204:207], a[100:103], a[188:191], v[204:207]
    s_add_u32 m0, s99, 49152
    v_mfma_f32_16x16x32_bf16 v[208:211], a[104:107], a[184:187], v[208:211]
    ds_read_b64_tr_b16 a[72:73], v18 offset:0
    ds_read_b64_tr_b16 a[74:75], v18 offset:4096
    v_mfma_f32_16x16x32_bf16 v[212:215], a[104:107], a[188:191], v[212:215]
    buffer_load_dwordx4 v32, s[8:11], s21 offen lds
    v_mfma_f32_16x16x32_bf16 v[216:219], a[108:111], a[184:187], v[216:219]
    ds_read_b64_tr_b16 a[76:77], v19 offset:0
    ds_read_b64_tr_b16 a[78:79], v19 offset:4096
    v_mfma_f32_16x16x32_bf16 v[220:223], a[108:111], a[188:191], v[220:223]
    s_waitcnt lgkmcnt(8)
    v_mfma_f32_16x16x32_bf16 v[224:227], a[112:115], a[184:187], v[224:227]
    ds_read_b64_tr_b16 a[80:81], v20 offset:0
    ds_read_b64_tr_b16 a[82:83], v20 offset:4096
    v_mfma_f32_16x16x32_bf16 v[228:231], a[112:115], a[188:191], v[228:231]
    buffer_load_dwordx4 v33, s[8:11], s21 offen offset:1024 lds
    v_mfma_f32_16x16x32_bf16 v[232:235], a[116:119], a[184:187], v[232:235]
    ds_read_b64_tr_b16 a[84:85], v21 offset:0
    ds_read_b64_tr_b16 a[86:87], v21 offset:4096
    v_mfma_f32_16x16x32_bf16 v[236:239], a[116:119], a[188:191], v[236:239]
    s_add_u32 s21, s21, 32768
    v_mfma_f32_16x16x32_bf16 v[240:243], a[120:123], a[184:187], v[240:243]
    ds_read_b64_tr_b16 a[88:89], v22 offset:0
    ds_read_b64_tr_b16 a[90:91], v22 offset:4096
    v_mfma_f32_16x16x32_bf16 v[244:247], a[120:123], a[188:191], v[244:247]
    buffer_load_dwordx4 a[164:167], v54, s[16:19], s22 offen offset:0 sc1
    v_mfma_f32_16x16x32_bf16 v[248:251], a[124:127], a[184:187], v[248:251]
    ds_read_b64_tr_b16 a[92:93], v23 offset:0
    ds_read_b64_tr_b16 a[94:95], v23 offset:4096
    v_mfma_f32_16x16x32_bf16 v[252:255], a[124:127], a[188:191], v[252:255]
    s_waitcnt vmcnt(10) lgkmcnt(8)
    s_barrier
.p2align 6
proj_loop:
    v_mfma_f32_16x16x32_bf16 v[192:195], a[64:67], a[128:131], v[192:195]
    ds_read_b64_tr_b16 a[96:97], v16 offset:8192
    ds_read_b64_tr_b16 a[98:99], v16 offset:12288
    v_mfma_f32_16x16x32_bf16 v[196:199], a[64:67], a[132:135], v[196:199]
    buffer_load_dwordx4 a[168:171], v54, s[12:15], s22 offen offset:1024 sc1
    v_mfma_f32_16x16x32_bf16 v[200:203], a[68:71], a[128:131], v[200:203]
    ds_read_b64_tr_b16 a[100:101], v17 offset:8192
    ds_read_b64_tr_b16 a[102:103], v17 offset:12288
    v_mfma_f32_16x16x32_bf16 v[204:207], a[68:71], a[132:135], v[204:207]
    s_add_u32 m0, s99, 57344
    v_mfma_f32_16x16x32_bf16 v[208:211], a[72:75], a[128:131], v[208:211]
    ds_read_b64_tr_b16 a[104:105], v18 offset:8192
    ds_read_b64_tr_b16 a[106:107], v18 offset:12288
    v_mfma_f32_16x16x32_bf16 v[212:215], a[72:75], a[132:135], v[212:215]
    buffer_load_dwordx4 v32, s[8:11], s21 offen lds
    v_mfma_f32_16x16x32_bf16 v[216:219], a[76:79], a[128:131], v[216:219]
    ds_read_b64_tr_b16 a[108:109], v19 offset:8192
    ds_read_b64_tr_b16 a[110:111], v19 offset:12288
    v_mfma_f32_16x16x32_bf16 v[220:223], a[76:79], a[132:135], v[220:223]
    s_waitcnt lgkmcnt(8)
    v_mfma_f32_16x16x32_bf16 v[224:227], a[80:83], a[128:131], v[224:227]
    ds_read_b64_tr_b16 a[112:113], v20 offset:8192
    ds_read_b64_tr_b16 a[114:115], v20 offset:12288
    v_mfma_f32_16x16x32_bf16 v[228:231], a[80:83], a[132:135], v[228:231]
    buffer_load_dwordx4 v33, s[8:11], s21 offen offset:1024 lds
    v_mfma_f32_16x16x32_bf16 v[232:235], a[84:87], a[128:131], v[232:235]
    ds_read_b64_tr_b16 a[116:117], v21 offset:8192
    ds_read_b64_tr_b16 a[118:119], v21 offset:12288
    v_mfma_f32_16x16x32_bf16 v[236:239], a[84:87], a[132:135], v[236:239]
    s_add_u32 s21, s21, 32768
    v_mfma_f32_16x16x32_bf16 v[240:243], a[88:91], a[128:131], v[240:243]
    ds_read_b64_tr_b16 a[120:121], v22 offset:8192
    ds_read_b64_tr_b16 a[122:123], v22 offset:12288
    v_mfma_f32_16x16x32_bf16 v[244:247], a[88:91], a[132:135], v[244:247]
    buffer_load_dwordx4 a[172:175], v54, s[16:19], s22 offen offset:1024 sc1
    v_mfma_f32_16x16x32_bf16 v[248:251], a[92:95], a[128:131], v[248:251]
    ds_read_b64_tr_b16 a[124:125], v23 offset:8192
    ds_read_b64_tr_b16 a[126:127], v23 offset:12288
    v_mfma_f32_16x16x32_bf16 v[252:255], a[92:95], a[132:135], v[252:255]
    s_waitcnt lgkmcnt(8)
    v_mfma_f32_16x16x32_bf16 v[192:195], a[96:99], a[136:139], v[192:195]
    ds_read_b64_tr_b16 a[64:65], v16 offset:16384
    ds_read_b64_tr_b16 a[66:67], v16 offset:20480
    v_mfma_f32_16x16x32_bf16 v[196:199], a[96:99], a[140:143], v[196:199]
    buffer_load_dwordx4 a[176:179], v54, s[12:15], s22 offen offset:2048 sc1
    v_mfma_f32_16x16x32_bf16 v[200:203], a[100:103], a[136:139], v[200:203]
    ds_read_b64_tr_b16 a[68:69], v17 offset:16384
    ds_read_b64_tr_b16 a[70:71], v17 offset:20480
    v_mfma_f32_16x16x32_bf16 v[204:207], a[100:103], a[140:143], v[204:207]
    s_add_u32 m0, s99, 32768
    v_mfma_f32_16x16x32_bf16 v[208:211], a[104:107], a[136:139], v[208:211]
    ds_read_b64_tr_b16 a[72:73], v18 offset:16384
    ds_read_b64_tr_b16 a[74:75], v18 offset:20480
    v_mfma_f32_16x16x32_bf16 v[212:215], a[104:107], a[140:143], v[212:215]
    buffer_load_dwordx4 v32, s[8:11], s21 offen lds
    v_mfma_f32_16x16x32_bf16 v[216:219], a[108:111], a[136:139], v[216:219]
    ds_read_b64_tr_b16 a[76:77], v19 offset:16384
    ds_read_b64_tr_b16 a[78:79], v19 offset:20480
    v_mfma_f32_16x16x32_bf16 v[220:223], a[108:111], a[140:143], v[220:223]
    s_waitcnt lgkmcnt(8)
    v_mfma_f32_16x16x32_bf16 v[224:227], a[112:115], a[136:139], v[224:227]
    ds_read_b64_tr_b16 a[80:81], v20 offset:16384
    ds_read_b64_tr_b16 a[82:83], v20 offset:20480
    v_mfma_f32_16x16x32_bf16 v[228:231], a[112:115], a[140:143], v[228:231]
    buffer_load_dwordx4 v33, s[8:11], s21 offen offset:1024 lds
    v_mfma_f32_16x16x32_bf16 v[232:235], a[116:119], a[136:139], v[232:235]
    ds_read_b64_tr_b16 a[84:85], v21 offset:16384
    ds_read_b64_tr_b16 a[86:87], v21 offset:20480
    v_mfma_f32_16x16x32_bf16 v[236:239], a[116:119], a[140:143], v[236:239]
    s_add_u32 s21, s21, 32768
    v_mfma_f32_16x16x32_bf16 v[240:243], a[120:123], a[136:139], v[240:243]
    ds_read_b64_tr_b16 a[88:89], v22 offset:16384
    ds_read_b64_tr_b16 a[90:91], v22 offset:20480
    v_mfma_f32_16x16x32_bf16 v[244:247], a[120:123], a[140:143], v[244:247]
    buffer_load_dwordx4 a[180:183], v54, s[16:19], s22 offen offset:2048 sc1
    v_mfma_f32_16x16x32_bf16 v[248:251], a[124:127], a[136:139], v[248:251]
    ds_read_b64_tr_b16 a[92:93], v23 offset:16384
    ds_read_b64_tr_b16 a[94:95], v23 offset:20480
    v_mfma_f32_16x16x32_bf16 v[252:255], a[124:127], a[140:143], v[252:255]
    s_waitcnt vmcnt(8) lgkmcnt(8)
    s_barrier
    v_mfma_f32_16x16x32_bf16 v[192:195], a[64:67], a[144:147], v[192:195]
    ds_read_b64_tr_b16 a[96:97], v16 offset:24576
    ds_read_b64_tr_b16 a[98:99], v16 offset:28672
    v_mfma_f32_16x16x32_bf16 v[196:199], a[64:67], a[148:151], v[196:199]
    buffer_load_dwordx4 a[184:187], v54, s[12:15], s22 offen offset:3072 sc1
    v_mfma_f32_16x16x32_bf16 v[200:203], a[68:71], a[144:147], v[200:203]
    ds_read_b64_tr_b16 a[100:101], v17 offset:24576
    ds_read_b64_tr_b16 a[102:103], v17 offset:28672
    v_mfma_f32_16x16x32_bf16 v[204:207], a[68:71], a[148:151], v[204:207]
    s_add_u32 m0, s99, 40960
    v_mfma_f32_16x16x32_bf16 v[208:211], a[72:75], a[144:147], v[208:211]
    ds_read_b64_tr_b16 a[104:105], v18 offset:24576
    ds_read_b64_tr_b16 a[106:107], v18 offset:28672
    v_mfma_f32_16x16x32_bf16 v[212:215], a[72:75], a[148:151], v[212:215]
    buffer_load_dwordx4 v32, s[8:11], s21 offen lds
    v_mfma_f32_16x16x32_bf16 v[216:219], a[76:79], a[144:147], v[216:219]
    ds_read_b64_tr_b16 a[108:109], v19 offset:24576
    ds_read_b64_tr_b16 a[110:111], v19 offset:28672
    v_mfma_f32_16x16x32_bf16 v[220:223], a[76:79], a[148:151], v[220:223]
    s_waitcnt lgkmcnt(8)
    v_mfma_f32_16x16x32_bf16 v[224:227], a[80:83], a[144:147], v[224:227]
    ds_read_b64_tr_b16 a[112:113], v20 offset:24576
    ds_read_b64_tr_b16 a[114:115], v20 offset:28672
    v_mfma_f32_16x16x32_bf16 v[228:231], a[80:83], a[148:151], v[228:231]
    buffer_load_dwordx4 v33, s[8:11], s21 offen offset:1024 lds
    v_mfma_f32_16x16x32_bf16 v[232:235], a[84:87], a[144:147], v[232:235]
    ds_read_b64_tr_b16 a[116:117], v21 offset:24576
    ds_read_b64_tr_b16 a[118:119], v21 offset:28672
    v_mfma_f32_16x16x32_bf16 v[236:239], a[84:87], a[148:151], v[236:239]
    s_add_u32 s21, s21, 32768
    v_mfma_f32_16x16x32_bf16 v[240:243], a[88:91], a[144:147], v[240:243]
    ds_read_b64_tr_b16 a[120:121], v22 offset:24576
    ds_read_b64_tr_b16 a[122:123], v22 offset:28672
    v_mfma_f32_16x16x32_bf16 v[244:247], a[88:91], a[148:151], v[244:247]
    buffer_load_dwordx4 a[188:191], v54, s[16:19], s22 offen offset:3072 sc1
    v_mfma_f32_16x16x32_bf16 v[248:251], a[92:95], a[144:147], v[248:251]
    ds_read_b64_tr_b16 a[124:125], v23 offset:24576
    ds_read_b64_tr_b16 a[126:127], v23 offset:28672
    v_mfma_f32_16x16x32_bf16 v[252:255], a[92:95], a[148:151], v[252:255]
    s_add_u32 s22, s22, 4096
    s_waitcnt lgkmcnt(8)
    v_mfma_f32_16x16x32_bf16 v[192:195], a[96:99], a[152:155], v[192:195]
    ds_read_b64_tr_b16 a[64:65], v16 offset:49152
    ds_read_b64_tr_b16 a[66:67], v16 offset:53248
    v_mfma_f32_16x16x32_bf16 v[196:199], a[96:99], a[156:159], v[196:199]
    buffer_load_dwordx4 a[128:131], v54, s[12:15], s22 offen offset:0 sc1
    v_mfma_f32_16x16x32_bf16 v[200:203], a[100:103], a[152:155], v[200:203]
    ds_read_b64_tr_b16 a[68:69], v17 offset:49152
    ds_read_b64_tr_b16 a[70:71], v17 offset:53248
    v_mfma_f32_16x16x32_bf16 v[204:207], a[100:103], a[156:159], v[204:207]
    s_add_u32 m0, s99, 0
    v_mfma_f32_16x16x32_bf16 v[208:211], a[104:107], a[152:155], v[208:211]
    ds_read_b64_tr_b16 a[72:73], v18 offset:49152
    ds_read_b64_tr_b16 a[74:75], v18 offset:53248
    v_mfma_f32_16x16x32_bf16 v[212:215], a[104:107], a[156:159], v[212:215]
    buffer_load_dwordx4 v32, s[8:11], s21 offen lds
    v_mfma_f32_16x16x32_bf16 v[216:219], a[108:111], a[152:155], v[216:219]
    ds_read_b64_tr_b16 a[76:77], v19 offset:49152
    ds_read_b64_tr_b16 a[78:79], v19 offset:53248
    v_mfma_f32_16x16x32_bf16 v[220:223], a[108:111], a[156:159], v[220:223]
    s_waitcnt lgkmcnt(8)
    v_mfma_f32_16x16x32_bf16 v[224:227], a[112:115], a[152:155], v[224:227]
    ds_read_b64_tr_b16 a[80:81], v20 offset:49152
    ds_read_b64_tr_b16 a[82:83], v20 offset:53248
    v_mfma_f32_16x16x32_bf16 v[228:231], a[112:115], a[156:159], v[228:231]
    buffer_load_dwordx4 v33, s[8:11], s21 offen offset:1024 lds
    v_mfma_f32_16x16x32_bf16 v[232:235], a[116:119], a[152:155], v[232:235]
    ds_read_b64_tr_b16 a[84:85], v21 offset:49152
    ds_read_b64_tr_b16 a[86:87], v21 offset:53248
    v_mfma_f32_16x16x32_bf16 v[236:239], a[116:119], a[156:159], v[236:239]
    s_add_u32 s21, s21, 32768
    v_mfma_f32_16x16x32_bf16 v[240:243], a[120:123], a[152:155], v[240:243]
    ds_read_b64_tr_b16 a[88:89], v22 offset:49152
    ds_read_b64_tr_b16 a[90:91], v22 offset:53248
    v_mfma_f32_16x16x32_bf16 v[244:247], a[120:123], a[156:159], v[244:247]
    buffer_load_dwordx4 a[132:135], v54, s[16:19], s22 offen offset:0 sc1
    v_mfma_f32_16x16x32_bf16 v[248:251], a[124:127], a[152:155], v[248:251]
    ds_read_b64_tr_b16 a[92:93], v23 offset:49152
    ds_read_b64_tr_b16 a[94:95], v23 offset:53248
    v_mfma_f32_16x16x32_bf16 v[252:255], a[124:127], a[156:159], v[252:255]
    s_waitcnt vmcnt(8) lgkmcnt(8)
    s_barrier
    v_mfma_f32_16x16x32_bf16 v[192:195], a[64:67], a[160:163], v[192:195]
    ds_read_b64_tr_b16 a[96:97], v16 offset:57344
    ds_read_b64_tr_b16 a[98:99], v16 offset:61440
    v_mfma_f32_16x16x32_bf16 v[196:199], a[64:67], a[164:167], v[196:199]
    buffer_load_dwordx4 a[136:139], v54, s[12:15], s22 offen offset:1024 sc1
    v_mfma_f32_16x16x32_bf16 v[200:203], a[68:71], a[160:163], v[200:203]
    ds_read_b64_tr_b16 a[100:101], v17 offset:57344
    ds_read_b64_tr_b16 a[102:103], v17 offset:61440
    v_mfma_f32_16x16x32_bf16 v[204:207], a[68:71], a[164:167], v[204:207]
    s_add_u32 m0, s99, 8192
    v_mfma_f32_16x16x32_bf16 v[208:211], a[72:75], a[160:163], v[208:211]
    ds_read_b64_tr_b16 a[104:105], v18 offset:57344
    ds_read_b64_tr_b16 a[106:107], v18 offset:61440
    v_mfma_f32_16x16x32_bf16 v[212:215], a[72:75], a[164:167], v[212:215]
    buffer_load_dwordx4 v32, s[8:11], s21 offen lds
    v_mfma_f32_16x16x32_bf16 v[216:219], a[76:79], a[160:163], v[216:219]
    ds_read_b64_tr_b16 a[108:109], v19 offset:57344
    ds_read_b64_tr_b16 a[110:111], v19 offset:61440
    v_mfma_f32_16x16x32_bf16 v[220:223], a[76:79], a[164:167], v[220:223]
    s_waitcnt lgkmcnt(8)
    v_mfma_f32_16x16x32_bf16 v[224:227], a[80:83], a[160:163], v[224:227]
    ds_read_b64_tr_b16 a[112:113], v20 offset:57344
    ds_read_b64_tr_b16 a[114:115], v20 offset:61440
    v_mfma_f32_16x16x32_bf16 v[228:231], a[80:83], a[164:167], v[228:231]
    buffer_load_dwordx4 v33, s[8:11], s21 offen offset:1024 lds
    v_mfma_f32_16x16x32_bf16 v[232:235], a[84:87], a[160:163], v[232:235]
    ds_read_b64_tr_b16 a[116:117], v21 offset:57344
    ds_read_b64_tr_b16 a[118:119], v21 offset:61440
    v_mfma_f32_16x16x32_bf16 v[236:239], a[84:87], a[164:167], v[236:239]
    s_add_u32 s21, s21, 32768
    v_mfma_f32_16x16x32_bf16 v[240:243], a[88:91], a[160:163], v[240:243]
    ds_read_b64_tr_b16 a[120:121], v22 offset:57344
    ds_read_b64_tr_b16 a[122:123], v22 offset:61440
    v_mfma_f32_16x16x32_bf16 v[244:247], a[88:91], a[164:167], v[244:247]
    buffer_load_dwordx4 a[140:143], v54, s[16:19], s22 offen offset:1024 sc1
    v_mfma_f32_16x16x32_bf16 v[248:251], a[92:95], a[160:163], v[248:251]
    ds_read_b64_tr_b16 a[124:125], v23 offset:57344
    ds_read_b64_tr_b16 a[126:127], v23 offset:61440
    v_mfma_f32_16x16x32_bf16 v[252:255], a[92:95], a[164:167], v[252:255]
    s_waitcnt lgkmcnt(8)
    v_mfma_f32_16x16x32_bf16 v[192:195], a[96:99], a[168:171], v[192:195]
    ds_read_b64_tr_b16 a[64:65], v16 offset:32768
    ds_read_b64_tr_b16 a[66:67], v16 offset:36864
    v_mfma_f32_16x16x32_bf16 v[196:199], a[96:99], a[172:175], v[196:199]
    buffer_load_dwordx4 a[144:147], v54, s[12:15], s22 offen offset:2048 sc1
    v_mfma_f32_16x16x32_bf16 v[200:203], a[100:103], a[168:171], v[200:203]
    ds_read_b64_tr_b16 a[68:69], v17 offset:32768
    ds_read_b64_tr_b16 a[70:71], v17 offset:36864
    v_mfma_f32_16x16x32_bf16 v[204:207], a[100:103], a[172:175], v[204:207]
    s_add_u32 m0, s99, 16384
    v_mfma_f32_16x16x32_bf16 v[208:211], a[104:107], a[168:171], v[208:211]
    ds_read_b64_tr_b16 a[72:73], v18 offset:32768
    ds_read_b64_tr_b16 a[74:75], v18 offset:36864
    v_mfma_f32_16x16x32_bf16 v[212:215], a[104:107], a[172:175], v[212:215]
    buffer_load_dwordx4 v32, s[8:11], s21 offen lds
    v_mfma_f32_16x16x32_bf16 v[216:219], a[108:111], a[168:171], v[216:219]
    ds_read_b64_tr_b16 a[76:77], v19 offset:32768
    ds_read_b64_tr_b16 a[78:79], v19 offset:36864
    v_mfma_f32_16x16x32_bf16 v[220:223], a[108:111], a[172:175], v[220:223]
    s_waitcnt lgkmcnt(8)
    v_mfma_f32_16x16x32_bf16 v[224:227], a[112:115], a[168:171], v[224:227]
    ds_read_b64_tr_b16 a[80:81], v20 offset:32768
    ds_read_b64_tr_b16 a[82:83], v20 offset:36864
    v_mfma_f32_16x16x32_bf16 v[228:231], a[112:115], a[172:175], v[228:231]
    buffer_load_dwordx4 v33, s[8:11], s21 offen offset:1024 lds
    v_mfma_f32_16x16x32_bf16 v[232:235], a[116:119], a[168:171], v[232:235]
    ds_read_b64_tr_b16 a[84:85], v21 offset:32768
    ds_read_b64_tr_b16 a[86:87], v21 offset:36864
    v_mfma_f32_16x16x32_bf16 v[236:239], a[116:119], a[172:175], v[236:239]
    s_add_u32 s21, s21, 32768
    v_mfma_f32_16x16x32_bf16 v[240:243], a[120:123], a[168:171], v[240:243]
    ds_read_b64_tr_b16 a[88:89], v22 offset:32768
    ds_read_b64_tr_b16 a[90:91], v22 offset:36864
    v_mfma_f32_16x16x32_bf16 v[244:247], a[120:123], a[172:175], v[244:247]
    buffer_load_dwordx4 a[148:151], v54, s[16:19], s22 offen offset:2048 sc1
    v_mfma_f32_16x16x32_bf16 v[248:251], a[124:127], a[168:171], v[248:251]
    ds_read_b64_tr_b16 a[92:93], v23 offset:32768
    ds_read_b64_tr_b16 a[94:95], v23 offset:36864
    v_mfma_f32_16x16x32_bf16 v[252:255], a[124:127], a[172:175], v[252:255]
    s_waitcnt vmcnt(8) lgkmcnt(8)
    s_barrier
    v_mfma_f32_16x16x32_bf16 v[192:195], a[64:67], a[176:179], v[192:195]
    ds_read_b64_tr_b16 a[96:97], v16 offset:40960
    ds_read_b64_tr_b16 a[98:99], v16 offset:45056
    v_mfma_f32_16x16x32_bf16 v[196:199], a[64:67], a[180:183], v[196:199]
    buffer_load_dwordx4 a[152:155], v54, s[12:15], s22 offen offset:3072 sc1
    v_mfma_f32_16x16x32_bf16 v[200:203], a[68:71], a[176:179], v[200:203]
    ds_read_b64_tr_b16 a[100:101], v17 offset:40960
    ds_read_b64_tr_b16 a[102:103], v17 offset:45056
    v_mfma_f32_16x16x32_bf16 v[204:207], a[68:71], a[180:183], v[204:207]
    s_add_u32 m0, s99, 24576
    v_mfma_f32_16x16x32_bf16 v[208:211], a[72:75], a[176:179], v[208:211]
    ds_read_b64_tr_b16 a[104:105], v18 offset:40960
    ds_read_b64_tr_b16 a[106:107], v18 offset:45056
    v_mfma_f32_16x16x32_bf16 v[212:215], a[72:75], a[180:183], v[212:215]
    buffer_load_dwordx4 v32, s[8:11], s21 offen lds
    v_mfma_f32_16x16x32_bf16 v[216:219], a[76:79], a[176:179], v[216:219]
    ds_read_b64_tr_b16 a[108:109], v19 offset:40960
    ds_read_b64_tr_b16 a[110:111], v19 offset:45056
    v_mfma_f32_16x16x32_bf16 v[220:223], a[76:79], a[180:183], v[220:223]
    s_waitcnt lgkmcnt(8)
    v_mfma_f32_16x16x32_bf16 v[224:227], a[80:83], a[176:179], v[224:227]
    ds_read_b64_tr_b16 a[112:113], v20 offset:40960
    ds_read_b64_tr_b16 a[114:115], v20 offset:45056
    v_mfma_f32_16x16x32_bf16 v[228:231], a[80:83], a[180:183], v[228:231]
    buffer_load_dwordx4 v33, s[8:11], s21 offen offset:1024 lds
    v_mfma_f32_16x16x32_bf16 v[232:235], a[84:87], a[176:179], v[232:235]
    ds_read_b64_tr_b16 a[116:117], v21 offset:40960
    ds_read_b64_tr_b16 a[118:119], v21 offset:45056
    v_mfma_f32_16x16x32_bf16 v[236:239], a[84:87], a[180:183], v[236:239]
    s_add_u32 s21, s21, 32768
    v_mfma_f32_16x16x32_bf16 v[240:243], a[88:91], a[176:179], v[240:243]
    ds_read_b64_tr_b16 a[120:121], v22 offset:40960
    ds_read_b64_tr_b16 a[122:123], v22 offset:45056
    v_mfma_f32_16x16x32_bf16 v[244:247], a[88:91], a[180:183], v[244:247]
    buffer_load_dwordx4 a[156:159], v54, s[16:19], s22 offen offset:3072 sc1
    v_mfma_f32_16x16x32_bf16 v[248:251], a[92:95], a[176:179], v[248:251]
    ds_read_b64_tr_b16 a[124:125], v23 offset:40960
    ds_read_b64_tr_b16 a[126:127], v23 offset:45056
    v_mfma_f32_16x16x32_bf16 v[252:255], a[92:95], a[180:183], v[252:255]
    s_add_u32 s22, s22, 4096
    s_waitcnt lgkmcnt(8)
    v_mfma_f32_16x16x32_bf16 v[192:195], a[96:99], a[184:187], v[192:195]
    ds_read_b64_tr_b16 a[64:65], v16 offset:0
    ds_read_b64_tr_b16 a[66:67], v16 offset:4096
    v_mfma_f32_16x16x32_bf16 v[196:199], a[96:99], a[188:191], v[196:199]
    buffer_load_dwordx4 a[160:163], v54, s[12:15], s22 offen offset:0 sc1
    v_mfma_f32_16x16x32_bf16 v[200:203], a[100:103], a[184:187], v[200:203]
    ds_read_b64_tr_b16 a[68:69], v17 offset:0
    ds_read_b64_tr_b16 a[70:71], v17 offset:4096
    v_mfma_f32_16x16x32_bf16 v[204:207], a[100:103], a[188:191], v[204:207]
    s_add_u32 m0, s99, 49152
    v_mfma_f32_16x16x32_bf16 v[208:211], a[104:107], a[184:187], v[208:211]
    ds_read_b64_tr_b16 a[72:73], v18 offset:0
    ds_read_b64_tr_b16 a[74:75], v18 offset:4096
    v_mfma_f32_16x16x32_bf16 v[212:215], a[104:107], a[188:191], v[212:215]
    buffer_load_dwordx4 v32, s[8:11], s21 offen lds
    v_mfma_f32_16x16x32_bf16 v[216:219], a[108:111], a[184:187], v[216:219]
    ds_read_b64_tr_b16 a[76:77], v19 offset:0
    ds_read_b64_tr_b16 a[78:79], v19 offset:4096
    v_mfma_f32_16x16x32_bf16 v[220:223], a[108:111], a[188:191], v[220:223]
    s_waitcnt lgkmcnt(8)
    v_mfma_f32_16x16x32_bf16 v[224:227], a[112:115], a[184:187], v[224:227]
    ds_read_b64_tr_b16 a[80:81], v20 offset:0
    ds_read_b64_tr_b16 a[82:83], v20 offset:4096
    v_mfma_f32_16x16x32_bf16 v[228:231], a[112:115], a[188:191], v[228:231]
    buffer_load_dwordx4 v33, s[8:11], s21 offen offset:1024 lds
    v_mfma_f32_16x16x32_bf16 v[232:235], a[116:119], a[184:187], v[232:235]
    ds_read_b64_tr_b16 a[84:85], v21 offset:0
    ds_read_b64_tr_b16 a[86:87], v21 offset:4096
    v_mfma_f32_16x16x32_bf16 v[236:239], a[116:119], a[188:191], v[236:239]
    s_add_u32 s21, s21, 32768
    v_mfma_f32_16x16x32_bf16 v[240:243], a[120:123], a[184:187], v[240:243]
    ds_read_b64_tr_b16 a[88:89], v22 offset:0
    ds_read_b64_tr_b16 a[90:91], v22 offset:4096
    v_mfma_f32_16x16x32_bf16 v[244:247], a[120:123], a[188:191], v[244:247]
    buffer_load_dwordx4 a[164:167], v54, s[16:19], s22 offen offset:0 sc1
    v_mfma_f32_16x16x32_bf16 v[248:251], a[124:127], a[184:187], v[248:251]
    ds_read_b64_tr_b16 a[92:93], v23 offset:0
    ds_read_b64_tr_b16 a[94:95], v23 offset:4096
    v_mfma_f32_16x16x32_bf16 v[252:255], a[124:127], a[188:191], v[252:255]
    s_cmp_lt_u32 s21, s23
    s_waitcnt vmcnt(8) lgkmcnt(8)
    s_barrier
    s_cbranch_scc1 proj_loop
    v_mfma_f32_16x16x32_bf16 v[192:195], a[64:67], a[128:131], v[192:195]
    ds_read_b64_tr_b16 a[96:97], v16 offset:8192
    ds_read_b64_tr_b16 a[98:99], v16 offset:12288
    s_add_u32 s62, s63, 0
    v_mfma_f32_16x16x32_bf16 v[196:199], a[64:67], a[132:135], v[196:199]
    buffer_load_dwordx4 v[80:83], v54, s[32:35], s62 offen offset:0 sc1
    v_mfma_f32_16x16x32_bf16 v[200:203], a[68:71], a[128:131], v[200:203]
    ds_read_b64_tr_b16 a[100:101], v17 offset:8192
    ds_read_b64_tr_b16 a[102:103], v17 offset:12288
    v_mfma_f32_16x16x32_bf16 v[204:207], a[68:71], a[132:135], v[204:207]
    v_mfma_f32_16x16x32_bf16 v[208:211], a[72:75], a[128:131], v[208:211]
    ds_read_b64_tr_b16 a[104:105], v18 offset:8192
    ds_read_b64_tr_b16 a[106:107], v18 offset:12288
    s_add_u32 s62, s63, 0
    v_mfma_f32_16x16x32_bf16 v[212:215], a[72:75], a[132:135], v[212:215]
    buffer_load_dwordx4 v[84:87], v54, s[32:35], s62 offen offset:1024 sc1
    v_mfma_f32_16x16x32_bf16 v[216:219], a[76:79], a[128:131], v[216:219]
    ds_read_b64_tr_b16 a[108:109], v19 offset:8192
    ds_read_b64_tr_b16 a[110:111], v19 offset:12288
    v_mfma_f32_16x16x32_bf16 v[220:223], a[76:79], a[132:135], v[220:223]
    s_waitcnt lgkmcnt(8)
    v_mfma_f32_16x16x32_bf16 v[224:227], a[80:83], a[128:131], v[224:227]
    ds_read_b64_tr_b16 a[112:113], v20 offset:8192
    ds_read_b64_tr_b16 a[114:115], v20 offset:12288
    s_add_u32 s62, s63, 0
    v_mfma_f32_16x16x32_bf16 v[228:231], a[80:83], a[132:135], v[228:231]
    buffer_load_dwordx4 v[88:91], v54, s[32:35], s62 offen offset:2048 sc1
    v_mfma_f32_16x16x32_bf16 v[232:235], a[84:87], a[128:131], v[232:235]
    ds_read_b64_tr_b16 a[116:117], v21 offset:8192
    ds_read_b64_tr_b16 a[118:119], v21 offset:12288
    v_mfma_f32_16x16x32_bf16 v[236:239], a[84:87], a[132:135], v[236:239]
    v_mfma_f32_16x16x32_bf16 v[240:243], a[88:91], a[128:131], v[240:243]
    ds_read_b64_tr_b16 a[120:121], v22 offset:8192
    ds_read_b64_tr_b16 a[122:123], v22 offset:12288
    s_add_u32 s62, s63, 0
    v_mfma_f32_16x16x32_bf16 v[244:247], a[88:91], a[132:135], v[244:247]
    buffer_load_dwordx4 v[92:95], v54, s[32:35], s62 offen offset:3072 sc1
    v_mfma_f32_16x16x32_bf16 v[248:251], a[92:95], a[128:131], v[248:251]
    ds_read_b64_tr_b16 a[124:125], v23 offset:8192
    ds_read_b64_tr_b16 a[126:127], v23 offset:12288
    v_mfma_f32_16x16x32_bf16 v[252:255], a[92:95], a[132:135], v[252:255]
    s_waitcnt lgkmcnt(8)
    v_mfma_f32_16x16x32_bf16 v[192:195], a[96:99], a[136:139], v[192:195]
    ds_read_b64_tr_b16 a[64:65], v16 offset:16384
    ds_read_b64_tr_b16 a[66:67], v16 offset:20480
    s_add_u32 s62, s63, 4096
    v_mfma_f32_16x16x32_bf16 v[196:199], a[96:99], a[140:143], v[196:199]
    buffer_load_dwordx4 v[96:99], v54, s[32:35], s62 offen offset:0 sc1
    v_mfma_f32_16x16x32_bf16 v[200:203], a[100:103], a[136:139], v[200:203]
    ds_read_b64_tr_b16 a[68:69], v17 offset:16384
    ds_read_b64_tr_b16 a[70:71], v17 offset:20480
    v_mfma_f32_16x16x32_bf16 v[204:207], a[100:103], a[140:143], v[204:207]
    v_mfma_f32_16x16x32_bf16 v[208:211], a[104:107], a[136:139], v[208:211]
    ds_read_b64_tr_b16 a[72:73], v18 offset:16384
    ds_read_b64_tr_b16 a[74:75], v18 offset:20480
    s_add_u32 s62, s63, 4096
    v_mfma_f32_16x16x32_bf16 v[212:215], a[104:107], a[140:143], v[212:215]
    buffer_load_dwordx4 v[100:103], v54, s[32:35], s62 offen offset:1024 sc1
    v_mfma_f32_16x16x32_bf16 v[216:219], a[108:111], a[136:139], v[216:219]
    ds_read_b64_tr_b16 a[76:77], v19 offset:16384
    ds_read_b64_tr_b16 a[78:79], v19 offset:20480
    v_mfma_f32_16x16x32_bf16 v[220:223], a[108:111], a[140:143], v[220:223]
    s_waitcnt lgkmcnt(8)
    v_mfma_f32_16x16x32_bf16 v[224:227], a[112:115], a[136:139], v[224:227]
    ds_read_b64_tr_b16 a[80:81], v20 offset:16384
    ds_read_b64_tr_b16 a[82:83], v20 offset:20480
    s_mov_b32 s62, 0
    v_mfma_f32_16x16x32_bf16 v[228:231], a[112:115], a[140:143], v[228:231]
    buffer_load_dwordx2 v[36:37], v35, s[64:67], s62 offen offset:0
    v_mfma_f32_16x16x32_bf16 v[232:235], a[116:119], a[136:139], v[232:235]
    ds_read_b64_tr_b16 a[84:85], v21 offset:16384
    ds_read_b64_tr_b16 a[86:87], v21 offset:20480
    v_mfma_f32_16x16x32_bf16 v[236:239], a[116:119], a[140:143], v[236:239]
    v_mfma_f32_16x16x32_bf16 v[240:243], a[120:123], a[136:139], v[240:243]
    ds_read_b64_tr_b16 a[88:89], v22 offset:16384
    ds_read_b64_tr_b16 a[90:91], v22 offset:20480
    s_mov_b32 s62, 16384
    v_mfma_f32_16x16x32_bf16 v[244:247], a[120:123], a[140:143], v[244:247]
    buffer_load_dwordx2 v[38:39], v35, s[64:67], s62 offen offset:0
    v_mfma_f32_16x16x32_bf16 v[248:251], a[124:127], a[136:139], v[248:251]
    ds_read_b64_tr_b16 a[92:93], v23 offset:16384
    ds_read_b64_tr_b16 a[94:95], v23 offset:20480
    v_mfma_f32_16x16x32_bf16 v[252:255], a[124:127], a[140:143], v[252:255]
    s_waitcnt vmcnt(8) lgkmcnt(8)
    v_mfma_f32_16x16x32_bf16 v[192:195], a[64:67], a[144:147], v[192:195]
    s_mov_b32 s62, 0
    v_mfma_f32_16x16x32_bf16 v[196:199], a[64:67], a[148:151], v[196:199]
    buffer_load_dwordx2 v[40:41], v35, s[64:67], s62 offen offset:32
    v_mfma_f32_16x16x32_bf16 v[200:203], a[68:71], a[144:147], v[200:203]
    v_mfma_f32_16x16x32_bf16 v[204:207], a[68:71], a[148:151], v[204:207]
    v_mfma_f32_16x16x32_bf16 v[208:211], a[72:75], a[144:147], v[208:211]
    s_mov_b32 s62, 16384
    v_mfma_f32_16x16x32_bf16 v[212:215], a[72:75], a[148:151], v[212:215]
    buffer_load_dwordx2 v[42:43], v35, s[64:67], s62 offen offset:32
    v_mfma_f32_16x16x32_bf16 v[216:219], a[76:79], a[144:147], v[216:219]
    v_mfma_f32_16x16x32_bf16 v[220:223], a[76:79], a[148:151], v[220:223]
    s_waitcnt lgkmcnt(0)
    v_mfma_f32_16x16x32_bf16 v[224:227], a[80:83], a[144:147], v[224:227]
    s_mov_b32 s62, 0
    v_mfma_f32_16x16x32_bf16 v[228:231], a[80:83], a[148:151], v[228:231]
    buffer_load_dwordx2 v[44:45], v12, s[68:71], s62 offen offset:0
    v_mfma_f32_16x16x32_bf16 v[232:235], a[84:87], a[144:147], v[232:235]
    v_mfma_f32_16x16x32_bf16 v[236:239], a[84:87], a[148:151], v[236:239]
    v_mfma_f32_16x16x32_bf16 v[240:243], a[88:91], a[144:147], v[240:243]
    s_mov_b32 s62, 0
    v_mfma_f32_16x16x32_bf16 v[244:247], a[88:91], a[148:151], v[244:247]
    buffer_load_dwordx2 v[46:47], v12, s[68:71], s62 offen offset:32
    v_mfma_f32_16x16x32_bf16 v[248:251], a[92:95], a[144:147], v[248:251]
    v_mfma_f32_16x16x32_bf16 v[252:255], a[92:95], a[148:151], v[252:255]
    s_nop 3
    v_cvt_pk_bf16_f32 v128, v208, v209
    v_cvt_pk_bf16_f32 v129, v210, v211
    v_cvt_pk_bf16_f32 v130, v212, v213
    v_cvt_pk_bf16_f32 v131, v214, v215
    v_cvt_pk_bf16_f32 v132, v216, v217
    v_cvt_pk_bf16_f32 v133, v218, v219
    v_cvt_pk_bf16_f32 v134, v220, v221
    v_cvt_pk_bf16_f32 v135, v222, v223
    v_min_u32 v128, -2, v128
    v_min_u32 v129, -2, v129
    v_min_u32 v130, -2, v130
    v_min_u32 v131, -2, v131
    v_min_u32 v132, -2, v132
    v_min_u32 v133, -2, v133
    v_min_u32 v134, -2, v134
    v_min_u32 v135, -2, v135
    s_add_u32 s62, s85, 6144
    buffer_store_dwordx4 v[128:131], v54, s[32:35], s62 offen offset:0 sc1
    buffer_store_dwordx4 v[132:135], v54, s[32:35], s62 offen offset:1024 sc1
    v_cvt_pk_bf16_f32 v136, v224, v225
    v_cvt_pk_bf16_f32 v137, v226, v227
    v_cvt_pk_bf16_f32 v138, v228, v229
    v_cvt_pk_bf16_f32 v139, v230, v231
    v_cvt_pk_bf16_f32 v140, v232, v233
    v_cvt_pk_bf16_f32 v141, v234, v235
    v_cvt_pk_bf16_f32 v142, v236, v237
    v_cvt_pk_bf16_f32 v143, v238, v239
    v_min_u32 v136, -2, v136
    v_min_u32 v137, -2, v137
    v_min_u32 v138, -2, v138
    v_min_u32 v139, -2, v139
    v_min_u32 v140, -2, v140
    v_min_u32 v141, -2, v141
    v_min_u32 v142, -2, v142
    v_min_u32 v143, -2, v143
    s_add_u32 s62, s86, 8192
    buffer_store_dwordx4 v[136:139], v54, s[32:35], s62 offen offset:0 sc1
    buffer_store_dwordx4 v[140:143], v54, s[32:35], s62 offen offset:1024 sc1
    v_cvt_pk_bf16_f32 v144, v240, v241
    v_cvt_pk_bf16_f32 v145, v242, v243
    v_cvt_pk_bf16_f32 v146, v244, v245
    v_cvt_pk_bf16_f32 v147, v246, v247
    v_cvt_pk_bf16_f32 v148, v248, v249
    v_cvt_pk_bf16_f32 v149, v250, v251
    v_cvt_pk_bf16_f32 v150, v252, v253
    v_cvt_pk_bf16_f32 v151, v254, v255
    v_min_u32 v144, -2, v144
    v_min_u32 v145, -2, v145
    v_min_u32 v146, -2, v146
    v_min_u32 v147, -2, v147
    v_min_u32 v148, -2, v148
    v_min_u32 v149, -2, v149
    v_min_u32 v150, -2, v150
    v_min_u32 v151, -2, v151
    s_add_u32 s62, s87, 10240
    buffer_store_dwordx4 v[144:147], v54, s[32:35], s62 offen offset:0 sc1
    buffer_store_dwordx4 v[148:151], v54, s[32:35], s62 offen offset:1024 sc1
    s_waitcnt vmcnt(6)
proj_zpoll:
    v_max3_u32 v176, v80, v81, v82
    v_max3_u32 v177, v92, v93, v94
    v_max3_u32 v176, v176, v83, v84
    v_max3_u32 v177, v177, v95, v96
    v_max3_u32 v176, v176, v85, v86
    v_max3_u32 v177, v177, v97, v98
    v_max3_u32 v176, v176, v87, v88
    v_max3_u32 v177, v177, v99, v100
    v_max3_u32 v176, v176, v89, v90
    v_max3_u32 v177, v177, v101, v102
    v_max3_u32 v176, v176, v91, v103
    v_max_u32 v176, v176, v177
    v_cmp_eq_u32 vcc, -1, v176
    s_cbranch_vccnz proj_zagain
    v_lshlrev_b32 v152, 16, v36
    v_and_b32 v153, 0xffff0000, v36
    v_lshlrev_b32 v154, 16, v37
    v_and_b32 v155, 0xffff0000, v37
    v_lshlrev_b32 v156, 16, v38
    v_and_b32 v157, 0xffff0000, v38
    v_lshlrev_b32 v158, 16, v39
    v_and_b32 v159, 0xffff0000, v39
    v_lshlrev_b32 v160, 16, v40
    v_and_b32 v161, 0xffff0000, v40
    v_lshlrev_b32 v162, 16, v41
    v_and_b32 v163, 0xffff0000, v41
    v_lshlrev_b32 v164, 16, v42
    v_and_b32 v165, 0xffff0000, v42
    v_lshlrev_b32 v166, 16, v43
    v_and_b32 v167, 0xffff0000, v43
    v_lshlrev_b32 v168, 16, v44
    v_and_b32 v169, 0xffff0000, v44
    v_lshlrev_b32 v170, 16, v45
    v_and_b32 v171, 0xffff0000, v45
    v_lshlrev_b32 v172, 16, v46
    v_and_b32 v173, 0xffff0000, v46
    v_lshlrev_b32 v174, 16, v47
    v_and_b32 v175, 0xffff0000, v47
    v_lshlrev_b32 v104, 16, v80
    v_and_b32 v105, 0xffff0000, v80
    v_lshlrev_b32 v106, 16, v81
    v_and_b32 v107, 0xffff0000, v81
    v_lshlrev_b32 v108, 16, v82
    v_and_b32 v109, 0xffff0000, v82
    v_lshlrev_b32 v110, 16, v83
    v_and_b32 v111, 0xffff0000, v83
    v_lshlrev_b32 v112, 16, v84
    v_and_b32 v113, 0xffff0000, v84
    v_lshlrev_b32 v114, 16, v85
    v_and_b32 v115, 0xffff0000, v85
    v_lshlrev_b32 v116, 16, v86
    v_and_b32 v117, 0xffff0000, v86
    v_lshlrev_b32 v118, 16, v87
    v_and_b32 v119, 0xffff0000, v87
    v_pk_add_f32 v[64:65], v[64:65], v[104:105]
    v_pk_add_f32 v[66:67], v[66:67], v[106:107]
    v_pk_add_f32 v[68:69], v[68:69], v[108:109]
    v_pk_add_f32 v[70:71], v[70:71], v[110:111]
    v_pk_add_f32 v[72:73], v[72:73], v[112:113]
    v_pk_add_f32 v[74:75], v[74:75], v[114:115]
    v_pk_add_f32 v[76:77], v[76:77], v[116:117]
    v_pk_add_f32 v[78:79], v[78:79], v[118:119]
    v_lshlrev_b32 v104, 16, v88
    v_and_b32 v105, 0xffff0000, v88
    v_lshlrev_b32 v106, 16, v89
    v_and_b32 v107, 0xffff0000, v89
    v_lshlrev_b32 v108, 16, v90
    v_and_b32 v109, 0xffff0000, v90
    v_lshlrev_b32 v110, 16, v91
    v_and_b32 v111, 0xffff0000, v91
    v_lshlrev_b32 v112, 16, v92
    v_and_b32 v113, 0xffff0000, v92
    v_lshlrev_b32 v114, 16, v93
    v_and_b32 v115, 0xffff0000, v93
    v_lshlrev_b32 v116, 16, v94
    v_and_b32 v117, 0xffff0000, v94
    v_lshlrev_b32 v118, 16, v95
    v_and_b32 v119, 0xffff0000, v95
    v_pk_add_f32 v[64:65], v[64:65], v[104:105]
    v_pk_add_f32 v[66:67], v[66:67], v[106:107]
    v_pk_add_f32 v[68:69], v[68:69], v[108:109]
    v_pk_add_f32 v[70:71], v[70:71], v[110:111]
    v_pk_add_f32 v[72:73], v[72:73], v[112:113]
    v_pk_add_f32 v[74:75], v[74:75], v[114:115]
    v_pk_add_f32 v[76:77], v[76:77], v[116:117]
    v_pk_add_f32 v[78:79], v[78:79], v[118:119]
    v_lshlrev_b32 v104, 16, v96
    v_and_b32 v105, 0xffff0000, v96
    v_lshlrev_b32 v106, 16, v97
    v_and_b32 v107, 0xffff0000, v97
    v_lshlrev_b32 v108, 16, v98
    v_and_b32 v109, 0xffff0000, v98
    v_lshlrev_b32 v110, 16, v99
    v_and_b32 v111, 0xffff0000, v99
    v_lshlrev_b32 v112, 16, v100
    v_and_b32 v113, 0xffff0000, v100
    v_lshlrev_b32 v114, 16, v101
    v_and_b32 v115, 0xffff0000, v101
    v_lshlrev_b32 v116, 16, v102
    v_and_b32 v117, 0xffff0000, v102
    v_lshlrev_b32 v118, 16, v103
    v_and_b32 v119, 0xffff0000, v103
    v_pk_add_f32 v[64:65], v[64:65], v[104:105]
    v_pk_add_f32 v[66:67], v[66:67], v[106:107]
    v_pk_add_f32 v[68:69], v[68:69], v[108:109]
    v_pk_add_f32 v[70:71], v[70:71], v[110:111]
    v_pk_add_f32 v[72:73], v[72:73], v[112:113]
    v_pk_add_f32 v[74:75], v[74:75], v[114:115]
    v_pk_add_f32 v[76:77], v[76:77], v[116:117]
    v_pk_add_f32 v[78:79], v[78:79], v[118:119]
    s_mov_b32 s60, 0xbfb8aa3b
    s_mov_b32 s61, s60
    v_mov_b32 v2, 1.0
    v_mov_b32 v3, 1.0
    v_pk_add_f32 v[64:65], v[64:65], v[168:169]
    v_pk_add_f32 v[66:67], v[66:67], v[170:171]
    v_pk_add_f32 v[68:69], v[68:69], v[168:169]
    v_pk_add_f32 v[70:71], v[70:71], v[170:171]
    v_pk_add_f32 v[72:73], v[72:73], v[172:173]
    v_pk_add_f32 v[74:75], v[74:75], v[174:175]
    v_pk_add_f32 v[76:77], v[76:77], v[172:173]
    v_pk_add_f32 v[78:79], v[78:79], v[174:175]
    v_pk_mul_f32 v[176:177], v[64:65], s[60:61]
    v_pk_mul_f32 v[178:179], v[66:67], s[60:61]
    v_pk_mul_f32 v[180:181], v[68:69], s[60:61]
    v_pk_mul_f32 v[182:183], v[70:71], s[60:61]
    v_pk_mul_f32 v[184:185], v[72:73], s[60:61]
    v_pk_mul_f32 v[186:187], v[74:75], s[60:61]
    v_pk_mul_f32 v[188:189], v[76:77], s[60:61]
    v_pk_mul_f32 v[190:191], v[78:79], s[60:61]
    v_exp_f32 v176, v176
    v_exp_f32 v178, v178
    v_exp_f32 v180, v180
    v_exp_f32 v182, v182
    v_exp_f32 v184, v184
    v_exp_f32 v186, v186
    v_exp_f32 v188, v188
    v_exp_f32 v190, v190
    v_exp_f32 v177, v177
    v_exp_f32 v179, v179
    v_exp_f32 v181, v181
    v_exp_f32 v183, v183
    v_exp_f32 v185, v185
    v_exp_f32 v187, v187
    v_exp_f32 v189, v189
    v_exp_f32 v191, v191
    v_pk_add_f32 v[176:177], v[176:177], v[2:3]
    v_pk_add_f32 v[178:179], v[178:179], v[2:3]
    v_pk_add_f32 v[180:181], v[180:181], v[2:3]
    v_pk_add_f32 v[182:183], v[182:183], v[2:3]
    v_pk_add_f32 v[184:185], v[184:185], v[2:3]
    v_pk_add_f32 v[186:187], v[186:187], v[2:3]
    v_pk_add_f32 v[188:189], v[188:189], v[2:3]
    v_pk_add_f32 v[190:191], v[190:191], v[2:3]
    v_rcp_f32 v176, v176
    v_rcp_f32 v178, v178
    v_rcp_f32 v180, v180
    v_rcp_f32 v182, v182
    v_rcp_f32 v184, v184
    v_rcp_f32 v186, v186
    v_rcp_f32 v188, v188
    v_rcp_f32 v190, v190
    v_rcp_f32 v177, v177
    v_rcp_f32 v179, v179
    v_rcp_f32 v181, v181
    v_rcp_f32 v183, v183
    v_rcp_f32 v185, v185
    v_rcp_f32 v187, v187
    v_rcp_f32 v189, v189
    v_rcp_f32 v191, v191
    v_pk_mul_f32 v[64:65], v[64:65], v[176:177]
    v_pk_mul_f32 v[66:67], v[66:67], v[178:179]
    v_pk_mul_f32 v[68:69], v[68:69], v[180:181]
    v_pk_mul_f32 v[70:71], v[70:71], v[182:183]
    v_pk_mul_f32 v[72:73], v[72:73], v[184:185]
    v_pk_mul_f32 v[74:75], v[74:75], v[186:187]
    v_pk_mul_f32 v[76:77], v[76:77], v[188:189]
    v_pk_mul_f32 v[78:79], v[78:79], v[190:191]
    s_waitcnt vmcnt(0)
proj_poll:
    s_add_u32 s62, s63, 4096
    buffer_load_dwordx4 v[80:83], v54, s[32:35], s62 offen offset:2048 sc1
    buffer_load_dwordx4 v[84:87], v54, s[32:35], s62 offen offset:3072 sc1
    s_add_u32 s62, s63, 8192
    buffer_load_dwordx4 v[88:91], v54, s[32:35], s62 offen offset:0 sc1
    buffer_load_dwordx4 v[92:95], v54, s[32:35], s62 offen offset:1024 sc1
    buffer_load_dwordx4 v[96:99], v54, s[32:35], s62 offen offset:2048 sc1
    buffer_load_dwordx4 v[100:103], v54, s[32:35], s62 offen offset:3072 sc1
    s_waitcnt vmcnt(0)
    v_max3_u32 v176, v80, v81, v82
    v_max3_u32 v177, v92, v93, v94
    v_max3_u32 v176, v176, v83, v84
    v_max3_u32 v177, v177, v95, v96
    v_max3_u32 v176, v176, v85, v86
    v_max3_u32 v177, v177, v97, v98
    v_max3_u32 v176, v176, v87, v88
    v_max3_u32 v177, v177, v99, v100
    v_max3_u32 v176, v176, v89, v90
    v_max3_u32 v177, v177, v101, v102
    v_max3_u32 v176, v176, v91, v103
    v_max_u32 v176, v176, v177
    v_cmp_eq_u32 vcc, -1, v176
    s_cbranch_vccnz proj_poll
    v_lshlrev_b32 v104, 16, v80
    v_and_b32 v105, 0xffff0000, v80
    v_lshlrev_b32 v106, 16, v81
    v_and_b32 v107, 0xffff0000, v81
    v_lshlrev_b32 v108, 16, v82
    v_and_b32 v109, 0xffff0000, v82
    v_lshlrev_b32 v110, 16, v83
    v_and_b32 v111, 0xffff0000, v83
    v_lshlrev_b32 v112, 16, v84
    v_and_b32 v113, 0xffff0000, v84
    v_lshlrev_b32 v114, 16, v85
    v_and_b32 v115, 0xffff0000, v85
    v_lshlrev_b32 v116, 16, v86
    v_and_b32 v117, 0xffff0000, v86
    v_lshlrev_b32 v118, 16, v87
    v_and_b32 v119, 0xffff0000, v87
    v_pk_add_f32 v[192:193], v[192:193], v[104:105]
    v_pk_add_f32 v[194:195], v[194:195], v[106:107]
    v_pk_add_f32 v[196:197], v[196:197], v[108:109]
    v_pk_add_f32 v[198:199], v[198:199], v[110:111]
    v_pk_add_f32 v[200:201], v[200:201], v[112:113]
    v_pk_add_f32 v[202:203], v[202:203], v[114:115]
    v_pk_add_f32 v[204:205], v[204:205], v[116:117]
    v_pk_add_f32 v[206:207], v[206:207], v[118:119]
    v_lshlrev_b32 v104, 16, v88
    v_and_b32 v105, 0xffff0000, v88
    v_lshlrev_b32 v106, 16, v89
    v_and_b32 v107, 0xffff0000, v89
    v_lshlrev_b32 v108, 16, v90
    v_and_b32 v109, 0xffff0000, v90
    v_lshlrev_b32 v110, 16, v91
    v_and_b32 v111, 0xffff0000, v91
    v_lshlrev_b32 v112, 16, v92
    v_and_b32 v113, 0xffff0000, v92
    v_lshlrev_b32 v114, 16, v93
    v_and_b32 v115, 0xffff0000, v93
    v_lshlrev_b32 v116, 16, v94
    v_and_b32 v117, 0xffff0000, v94
    v_lshlrev_b32 v118, 16, v95
    v_and_b32 v119, 0xffff0000, v95
    v_pk_add_f32 v[192:193], v[192:193], v[104:105]
    v_pk_add_f32 v[194:195], v[194:195], v[106:107]
    v_pk_add_f32 v[196:197], v[196:197], v[108:109]
    v_pk_add_f32 v[198:199], v[198:199], v[110:111]
    v_pk_add_f32 v[200:201], v[200:201], v[112:113]
    v_pk_add_f32 v[202:203], v[202:203], v[114:115]
    v_pk_add_f32 v[204:205], v[204:205], v[116:117]
    v_pk_add_f32 v[206:207], v[206:207], v[118:119]
    v_lshlrev_b32 v104, 16, v96
    v_and_b32 v105, 0xffff0000, v96
    v_lshlrev_b32 v106, 16, v97
    v_and_b32 v107, 0xffff0000, v97
    v_lshlrev_b32 v108, 16, v98
    v_and_b32 v109, 0xffff0000, v98
    v_lshlrev_b32 v110, 16, v99
    v_and_b32 v111, 0xffff0000, v99
    v_lshlrev_b32 v112, 16, v100
    v_and_b32 v113, 0xffff0000, v100
    v_lshlrev_b32 v114, 16, v101
    v_and_b32 v115, 0xffff0000, v101
    v_lshlrev_b32 v116, 16, v102
    v_and_b32 v117, 0xffff0000, v102
    v_lshlrev_b32 v118, 16, v103
    v_and_b32 v119, 0xffff0000, v103
    v_pk_add_f32 v[192:193], v[192:193], v[104:105]
    v_pk_add_f32 v[194:195], v[194:195], v[106:107]
    v_pk_add_f32 v[196:197], v[196:197], v[108:109]
    v_pk_add_f32 v[198:199], v[198:199], v[110:111]
    v_pk_add_f32 v[200:201], v[200:201], v[112:113]
    v_pk_add_f32 v[202:203], v[202:203], v[114:115]
    v_pk_add_f32 v[204:205], v[204:205], v[116:117]
    v_pk_add_f32 v[206:207], v[206:207], v[118:119]
    v_pk_fma_f32 v[152:153], v[192:193], v[64:65], v[152:153]
    v_pk_fma_f32 v[154:155], v[194:195], v[66:67], v[154:155]
    v_pk_fma_f32 v[156:157], v[196:197], v[68:69], v[156:157]
    v_pk_fma_f32 v[158:159], v[198:199], v[70:71], v[158:159]
    v_pk_fma_f32 v[160:161], v[200:201], v[72:73], v[160:161]
    v_pk_fma_f32 v[162:163], v[202:203], v[74:75], v[162:163]
    v_pk_fma_f32 v[164:165], v[204:205], v[76:77], v[164:165]
    v_pk_fma_f32 v[166:167], v[206:207], v[78:79], v[166:167]
    v_cvt_pk_bf16_f32 v36, v152, v153
    v_cvt_pk_bf16_f32 v37, v154, v155
    s_mov_b32 s62, 0
    buffer_store_dwordx2 v[36:37], v35, s[72:75], s62 offen offset:0
    v_cvt_pk_bf16_f32 v38, v156, v157
    v_cvt_pk_bf16_f32 v39, v158, v159
    s_mov_b32 s62, 16384
    buffer_store_dwordx2 v[38:39], v35, s[72:75], s62 offen offset:0
    v_cvt_pk_bf16_f32 v40, v160, v161
    v_cvt_pk_bf16_f32 v41, v162, v163
    s_mov_b32 s62, 0
    buffer_store_dwordx2 v[40:41], v35, s[72:75], s62 offen offset:32
    v_cvt_pk_bf16_f32 v42, v164, v165
    v_cvt_pk_bf16_f32 v43, v166, v167
    s_mov_b32 s62, 16384
    buffer_store_dwordx2 v[42:43], v35, s[72:75], s62 offen offset:32
    s_endpgm
proj_zagain:
    s_add_u32 s62, s63, 0
    buffer_load_dwordx4 v[80:83], v54, s[32:35], s62 offen offset:0 sc1
    buffer_load_dwordx4 v[84:87], v54, s[32:35], s62 offen offset:1024 sc1
    buffer_load_dwordx4 v[88:91], v54, s[32:35], s62 offen offset:2048 sc1
    buffer_load_dwordx4 v[92:95], v54, s[32:35], s62 offen offset:3072 sc1
    s_add_u32 s62, s63, 4096
    buffer_load_dwordx4 v[96:99], v54, s[32:35], s62 offen offset:0 sc1
    buffer_load_dwordx4 v[100:103], v54, s[32:35], s62 offen offset:1024 sc1
    s_waitcnt vmcnt(0)
    s_branch proj_zpoll
attn_done:
    s_endpgm
attn_warm:
    s_load_dwordx2 s[44:45], s[0:1], 32
    s_load_dwordx2 s[46:47], s[0:1], 64
    v_lshlrev_b32 v1, 3, v54
    s_lshl_b32 s48, s30, 5
    s_add_u32 s48, s48, s29
    s_lshl_b32 s87, s48, 7
    s_cmp_lg_u32 s28, 0
    s_cbranch_scc1 attn_noflag
    v_mov_b32 v2, s100
    v_mov_b32 v3, s101
    v_mov_b32 v38, 0x8000
    s_mov_b64 exec, 1
    buffer_store_dwordx2 v[2:3], v38, s[92:95], s87 offen sc1
    s_mov_b64 exec, -1
attn_noflag:
    s_lshl_b32 s49, s30, 2
    s_add_u32 s49, s49, s43
    s_lshl_b32 s49, s49, 2
    s_add_u32 s49, s49, s28
    s_lshl_b32 s50, s39, 20
    s_lshl_b32 s51, s49, 13
    s_add_u32 s50, s50, s51
    s_mul_i32 s51, s39, 360448
    s_mul_i32 s49, s49, 2816
    s_add_u32 s51, s51, s49
    s_waitcnt lgkmcnt(0)
    s_add_u32 s56, s44, 0
    s_addc_u32 s57, s45, 0
    s_mov_b32 s58, 4194304
    s_mov_b32 s59, 0x20000
    buffer_load_dword v38, v1, s[56:59], s50 offen
    s_add_u32 s56, s46, 0
    s_addc_u32 s57, s47, 0
    s_mov_b32 s58, 1409024
    s_mov_b32 s59, 0x20000
    buffer_load_dword v39, v1, s[56:59], s51 offen
    s_getpc_b64 s[96:97]
pc_attn:
    s_sub_u32 s96, s96, pc_attn-attn_proj
    s_subb_u32 s97, s97, 0
    s_mul_i32 s98, s28, 4096
    v_add_u32 v2, s98, v1
    v_min_u32 v2, attn_done-attn_proj, v2
    v_mov_b32 v3, s97
    v_add_co_u32 v2, vcc, s96, v2
    s_nop 1
    v_addc_co_u32 v3, vcc, 0, v3, vcc
    global_load_dword v48, v[2:3], off
    s_branch attn_loop
slow_0:
    s_call_b64 s[40:41], rescale_0
    s_branch resume_0
slow_1:
    s_call_b64 s[40:41], rescale_1
    s_branch resume_1
slow_2:
    s_call_b64 s[40:41], rescale_0
    s_branch resume_2
slow_3:
    s_call_b64 s[40:41], rescale_1
    s_branch resume_3
slow_4:
    s_call_b64 s[40:41], rescale_0
    s_branch resume_4
slow_5:
    s_call_b64 s[40:41], rescale_1
    s_branch resume_5
slow_6:
    s_call_b64 s[40:41], rescale_0
    s_branch resume_6
slow_7:
    s_call_b64 s[40:41], rescale_1
    s_branch resume_7
slow_8:
    s_call_b64 s[40:41], rescale_end
    s_branch resume_8
rescale_0:
    s_nop 15
    v_max3_f32 v50, v160, v161, v162
    v_max3_f32 v50, v50, v163, v164
    v_max3_f32 v50, v50, v165, v166
    v_max_f32 v50, v50, v167
    v_mov_b32 v51, v50
    s_nop 1
    v_permlane16_swap_b32 v50, v51
    v_max_f32 v50, v50, v51
    v_mov_b32 v51, v50
    s_nop 1
    v_permlane32_swap_b32 v50, v51
    v_max_f32 v50, v50, v51
    v_log_f32 v51, v40
    s_nop 0
    v_max3_f32 v50, v50, v51, 0
    v_exp_f32 v51, -v50
    v_sub_f32 v160, v160, v50
    v_sub_f32 v128, v128, v50
    v_sub_f32 v161, v161, v50
    v_sub_f32 v129, v129, v50
    v_sub_f32 v162, v162, v50
    v_sub_f32 v130, v130, v50
    v_sub_f32 v163, v163, v50
    v_sub_f32 v131, v131, v50
    v_sub_f32 v164, v164, v50
    v_sub_f32 v132, v132, v50
    v_sub_f32 v165, v165, v50
    v_sub_f32 v133, v133, v50
    v_sub_f32 v166, v166, v50
    v_sub_f32 v134, v134, v50
    v_sub_f32 v167, v167, v50
    v_sub_f32 v135, v135, v50
    v_sub_f32 v224, v224, v50
    v_sub_f32 v225, v225, v50
    v_sub_f32 v226, v226, v50
    v_sub_f32 v227, v227, v50
    v_mul_f32 v40, v40, v51
    v_accvgpr_read_b32 v52, a0
    v_mul_f32 v52, v52, v51
    v_accvgpr_write_b32 a0, v52
    v_accvgpr_read_b32 v52, a1
    v_mul_f32 v52, v52, v51
    v_accvgpr_write_b32 a1, v52
    v_accvgpr_read_b32 v52, a2
    v_mul_f32 v52, v52, v51
    v_accvgpr_write_b32 a2, v52
    v_accvgpr_read_b32 v52, a3
    v_mul_f32 v52, v52, v51
    v_accvgpr_write_b32 a3, v52
    v_accvgpr_read_b32 v52, a4
    v_mul_f32 v52, v52, v51
    v_accvgpr_write_b32 a4, v52
    v_accvgpr_read_b32 v52, a5
    v_mul_f32 v52, v52, v51
    v_accvgpr_write_b32 a5, v52
    v_accvgpr_read_b32 v52, a6
    v_mul_f32 v52, v52, v51
    v_accvgpr_write_b32 a6, v52
    v_accvgpr_read_b32 v52, a7
    v_mul_f32 v52, v52, v51
    v_accvgpr_write_b32 a7, v52
    v_accvgpr_read_b32 v52, a8
    v_mul_f32 v52, v52, v51
    v_accvgpr_write_b32 a8, v52
    v_accvgpr_read_b32 v52, a9
    v_mul_f32 v52, v52, v51
    v_accvgpr_write_b32 a9, v52
    v_accvgpr_read_b32 v52, a10
    v_mul_f32 v52, v52, v51
    v_accvgpr_write_b32 a10, v52
    v_accvgpr_read_b32 v52, a11
    v_mul_f32 v52, v52, v51
    v_accvgpr_write_b32 a11, v52
    v_accvgpr_read_b32 v52, a12
    v_mul_f32 v52, v52, v51
    v_accvgpr_write_b32 a12, v52
    v_accvgpr_read_b32 v52, a13
    v_mul_f32 v52, v52, v51
    v_accvgpr_write_b32 a13, v52
    v_accvgpr_read_b32 v52, a14
    v_mul_f32 v52, v52, v51
    v_accvgpr_write_b32 a14, v52
    v_accvgpr_read_b32 v52, a15
    v_mul_f32 v52, v52, v51
    v_accvgpr_write_b32 a15, v52
    v_accvgpr_read_b32 v52, a16
    v_mul_f32 v52, v52, v51
    v_accvgpr_write_b32 a16, v52
    v_accvgpr_read_b32 v52, a17
    v_mul_f32 v52, v52, v51
    v_accvgpr_write_b32 a17, v52
    v_accvgpr_read_b32 v52, a18
    v_mul_f32 v52, v52, v51
    v_accvgpr_write_b32 a18, v52
    v_accvgpr_read_b32 v52, a19
    v_mul_f32 v52, v52, v51
    v_accvgpr_write_b32 a19, v52
    v_accvgpr_read_b32 v52, a20
    v_mul_f32 v52, v52, v51
    v_accvgpr_write_b32 a20, v52
    v_accvgpr_read_b32 v52, a21
    v_mul_f32 v52, v52, v51
    v_accvgpr_write_b32 a21, v52
    v_accvgpr_read_b32 v52, a22
    v_mul_f32 v52, v52, v51
    v_accvgpr_write_b32 a22, v52
    v_accvgpr_read_b32 v52, a23
    v_mul_f32 v52, v52, v51
    v_accvgpr_write_b32 a23, v52
    v_accvgpr_read_b32 v52, a24
    v_mul_f32 v52, v52, v51
    v_accvgpr_write_b32 a24, v52
    v_accvgpr_read_b32 v52, a25
    v_mul_f32 v52, v52, v51
    v_accvgpr_write_b32 a25, v52
    v_accvgpr_read_b32 v52, a26
    v_mul_f32 v52, v52, v51
    v_accvgpr_write_b32 a26, v52
    v_accvgpr_read_b32 v52, a27
    v_mul_f32 v52, v52, v51
    v_accvgpr_write_b32 a27, v52
    v_accvgpr_read_b32 v52, a28
    v_mul_f32 v52, v52, v51
    v_accvgpr_write_b32 a28, v52
    v_accvgpr_read_b32 v52, a29
    v_mul_f32 v52, v52, v51
    v_accvgpr_write_b32 a29, v52
    v_accvgpr_read_b32 v52, a30
    v_mul_f32 v52, v52, v51
    v_accvgpr_write_b32 a30, v52
    v_accvgpr_read_b32 v52, a31
    v_mul_f32 v52, v52, v51
    v_accvgpr_write_b32 a31, v52
    v_exp_f32 v34, v160
    s_nop 0
    v_exp_f32 v35, v161
    s_nop 0
    v_cvt_pk_bf16_f32 v208, v34, v35
    v_exp_f32 v36, v162
    s_nop 0
    v_exp_f32 v37, v163
    s_nop 0
    v_cvt_pk_bf16_f32 v209, v36, v37
    v_exp_f32 v34, v164
    s_nop 0
    v_exp_f32 v35, v165
    s_nop 0
    v_cvt_pk_bf16_f32 v210, v34, v35
    v_exp_f32 v36, v166
    s_nop 0
    v_exp_f32 v37, v167
    s_nop 0
    v_cvt_pk_bf16_f32 v211, v36, v37
    s_nop 1
    v_mfma_f32_16x16x32_bf16 v[240:243], v[244:247], v[208:211], v[40:43]
    v_max3_f32 v50, v168, v169, v170
    v_max3_f32 v50, v50, v171, v172
    v_max3_f32 v50, v50, v173, v174
    v_max_f32 v50, v50, v175
    v_mov_b32 v51, v50
    s_nop 1
    v_permlane16_swap_b32 v50, v51
    v_max_f32 v50, v50, v51
    v_mov_b32 v51, v50
    s_nop 1
    v_permlane32_swap_b32 v50, v51
    v_max_f32 v50, v50, v51
    v_log_f32 v51, v44
    s_nop 0
    v_max3_f32 v50, v50, v51, 0
    v_exp_f32 v51, -v50
    v_sub_f32 v168, v168, v50
    v_sub_f32 v136, v136, v50
    v_sub_f32 v169, v169, v50
    v_sub_f32 v137, v137, v50
    v_sub_f32 v170, v170, v50
    v_sub_f32 v138, v138, v50
    v_sub_f32 v171, v171, v50
    v_sub_f32 v139, v139, v50
    v_sub_f32 v172, v172, v50
    v_sub_f32 v140, v140, v50
    v_sub_f32 v173, v173, v50
    v_sub_f32 v141, v141, v50
    v_sub_f32 v174, v174, v50
    v_sub_f32 v142, v142, v50
    v_sub_f32 v175, v175, v50
    v_sub_f32 v143, v143, v50
    v_sub_f32 v228, v228, v50
    v_sub_f32 v229, v229, v50
    v_sub_f32 v230, v230, v50
    v_sub_f32 v231, v231, v50
    v_mul_f32 v44, v44, v51
    v_accvgpr_read_b32 v52, a32
    v_mul_f32 v52, v52, v51
    v_accvgpr_write_b32 a32, v52
    v_accvgpr_read_b32 v52, a33
    v_mul_f32 v52, v52, v51
    v_accvgpr_write_b32 a33, v52
    v_accvgpr_read_b32 v52, a34
    v_mul_f32 v52, v52, v51
    v_accvgpr_write_b32 a34, v52
    v_accvgpr_read_b32 v52, a35
    v_mul_f32 v52, v52, v51
    v_accvgpr_write_b32 a35, v52
    v_accvgpr_read_b32 v52, a36
    v_mul_f32 v52, v52, v51
    v_accvgpr_write_b32 a36, v52
    v_accvgpr_read_b32 v52, a37
    v_mul_f32 v52, v52, v51
    v_accvgpr_write_b32 a37, v52
    v_accvgpr_read_b32 v52, a38
    v_mul_f32 v52, v52, v51
    v_accvgpr_write_b32 a38, v52
    v_accvgpr_read_b32 v52, a39
    v_mul_f32 v52, v52, v51
    v_accvgpr_write_b32 a39, v52
    v_accvgpr_read_b32 v52, a40
    v_mul_f32 v52, v52, v51
    v_accvgpr_write_b32 a40, v52
    v_accvgpr_read_b32 v52, a41
    v_mul_f32 v52, v52, v51
    v_accvgpr_write_b32 a41, v52
    v_accvgpr_read_b32 v52, a42
    v_mul_f32 v52, v52, v51
    v_accvgpr_write_b32 a42, v52
    v_accvgpr_read_b32 v52, a43
    v_mul_f32 v52, v52, v51
    v_accvgpr_write_b32 a43, v52
    v_accvgpr_read_b32 v52, a44
    v_mul_f32 v52, v52, v51
    v_accvgpr_write_b32 a44, v52
    v_accvgpr_read_b32 v52, a45
    v_mul_f32 v52, v52, v51
    v_accvgpr_write_b32 a45, v52
    v_accvgpr_read_b32 v52, a46
    v_mul_f32 v52, v52, v51
    v_accvgpr_write_b32 a46, v52
    v_accvgpr_read_b32 v52, a47
    v_mul_f32 v52, v52, v51
    v_accvgpr_write_b32 a47, v52
    v_accvgpr_read_b32 v52, a48
    v_mul_f32 v52, v52, v51
    v_accvgpr_write_b32 a48, v52
    v_accvgpr_read_b32 v52, a49
    v_mul_f32 v52, v52, v51
    v_accvgpr_write_b32 a49, v52
    v_accvgpr_read_b32 v52, a50
    v_mul_f32 v52, v52, v51
    v_accvgpr_write_b32 a50, v52
    v_accvgpr_read_b32 v52, a51
    v_mul_f32 v52, v52, v51
    v_accvgpr_write_b32 a51, v52
    v_accvgpr_read_b32 v52, a52
    v_mul_f32 v52, v52, v51
    v_accvgpr_write_b32 a52, v52
    v_accvgpr_read_b32 v52, a53
    v_mul_f32 v52, v52, v51
    v_accvgpr_write_b32 a53, v52
    v_accvgpr_read_b32 v52, a54
    v_mul_f32 v52, v52, v51
    v_accvgpr_write_b32 a54, v52
    v_accvgpr_read_b32 v52, a55
    v_mul_f32 v52, v52, v51
    v_accvgpr_write_b32 a55, v52
    v_accvgpr_read_b32 v52, a56
    v_mul_f32 v52, v52, v51
    v_accvgpr_write_b32 a56, v52
    v_accvgpr_read_b32 v52, a57
    v_mul_f32 v52, v52, v51
    v_accvgpr_write_b32 a57, v52
    v_accvgpr_read_b32 v52, a58
    v_mul_f32 v52, v52, v51
    v_accvgpr_write_b32 a58, v52
    v_accvgpr_read_b32 v52, a59
    v_mul_f32 v52, v52, v51
    v_accvgpr_write_b32 a59, v52
    v_accvgpr_read_b32 v52, a60
    v_mul_f32 v52, v52, v51
    v_accvgpr_write_b32 a60, v52
    v_accvgpr_read_b32 v52, a61
    v_mul_f32 v52, v52, v51
    v_accvgpr_write_b32 a61, v52
    v_accvgpr_read_b32 v52, a62
    v_mul_f32 v52, v52, v51
    v_accvgpr_write_b32 a62, v52
    v_accvgpr_read_b32 v52, a63
    v_mul_f32 v52, v52, v51
    v_accvgpr_write_b32 a63, v52
    v_exp_f32 v34, v168
    s_nop 0
    v_exp_f32 v35, v169
    s_nop 0
    v_cvt_pk_bf16_f32 v212, v34, v35
    v_exp_f32 v36, v170
    s_nop 0
    v_exp_f32 v37, v171
    s_nop 0
    v_cvt_pk_bf16_f32 v213, v36, v37
    v_exp_f32 v34, v172
    s_nop 0
    v_exp_f32 v35, v173
    s_nop 0
    v_cvt_pk_bf16_f32 v214, v34, v35
    v_exp_f32 v36, v174
    s_nop 0
    v_exp_f32 v37, v175
    s_nop 0
    v_cvt_pk_bf16_f32 v215, v36, v37
    s_nop 1
    v_mfma_f32_16x16x32_bf16 v[252:255], v[244:247], v[212:215], v[44:47]
    v_max3_f32 v50, v176, v177, v178
    v_max3_f32 v50, v50, v179, v180
    v_max3_f32 v50, v50, v181, v182
    v_max_f32 v50, v50, v183
    v_mov_b32 v51, v50
    s_nop 1
    v_permlane16_swap_b32 v50, v51
    v_max_f32 v50, v50, v51
    v_mov_b32 v51, v50
    s_nop 1
    v_permlane32_swap_b32 v50, v51
    v_max_f32 v50, v50, v51
    v_log_f32 v51, v56
    s_nop 0
    v_max3_f32 v50, v50, v51, 0
    v_exp_f32 v51, -v50
    v_sub_f32 v176, v176, v50
    v_sub_f32 v144, v144, v50
    v_sub_f32 v177, v177, v50
    v_sub_f32 v145, v145, v50
    v_sub_f32 v178, v178, v50
    v_sub_f32 v146, v146, v50
    v_sub_f32 v179, v179, v50
    v_sub_f32 v147, v147, v50
    v_sub_f32 v180, v180, v50
    v_sub_f32 v148, v148, v50
    v_sub_f32 v181, v181, v50
    v_sub_f32 v149, v149, v50
    v_sub_f32 v182, v182, v50
    v_sub_f32 v150, v150, v50
    v_sub_f32 v183, v183, v50
    v_sub_f32 v151, v151, v50
    v_sub_f32 v232, v232, v50
    v_sub_f32 v233, v233, v50
    v_sub_f32 v234, v234, v50
    v_sub_f32 v235, v235, v50
    v_mul_f32 v56, v56, v51
    v_accvgpr_read_b32 v52, a64
    v_mul_f32 v52, v52, v51
    v_accvgpr_write_b32 a64, v52
    v_accvgpr_read_b32 v52, a65
    v_mul_f32 v52, v52, v51
    v_accvgpr_write_b32 a65, v52
    v_accvgpr_read_b32 v52, a66
    v_mul_f32 v52, v52, v51
    v_accvgpr_write_b32 a66, v52
    v_accvgpr_read_b32 v52, a67
    v_mul_f32 v52, v52, v51
    v_accvgpr_write_b32 a67, v52
    v_accvgpr_read_b32 v52, a68
    v_mul_f32 v52, v52, v51
    v_accvgpr_write_b32 a68, v52
    v_accvgpr_read_b32 v52, a69
    v_mul_f32 v52, v52, v51
    v_accvgpr_write_b32 a69, v52
    v_accvgpr_read_b32 v52, a70
    v_mul_f32 v52, v52, v51
    v_accvgpr_write_b32 a70, v52
    v_accvgpr_read_b32 v52, a71
    v_mul_f32 v52, v52, v51
    v_accvgpr_write_b32 a71, v52
    v_accvgpr_read_b32 v52, a72
    v_mul_f32 v52, v52, v51
    v_accvgpr_write_b32 a72, v52
    v_accvgpr_read_b32 v52, a73
    v_mul_f32 v52, v52, v51
    v_accvgpr_write_b32 a73, v52
    v_accvgpr_read_b32 v52, a74
    v_mul_f32 v52, v52, v51
    v_accvgpr_write_b32 a74, v52
    v_accvgpr_read_b32 v52, a75
    v_mul_f32 v52, v52, v51
    v_accvgpr_write_b32 a75, v52
    v_accvgpr_read_b32 v52, a76
    v_mul_f32 v52, v52, v51
    v_accvgpr_write_b32 a76, v52
    v_accvgpr_read_b32 v52, a77
    v_mul_f32 v52, v52, v51
    v_accvgpr_write_b32 a77, v52
    v_accvgpr_read_b32 v52, a78
    v_mul_f32 v52, v52, v51
    v_accvgpr_write_b32 a78, v52
    v_accvgpr_read_b32 v52, a79
    v_mul_f32 v52, v52, v51
    v_accvgpr_write_b32 a79, v52
    v_accvgpr_read_b32 v52, a80
    v_mul_f32 v52, v52, v51
    v_accvgpr_write_b32 a80, v52
    v_accvgpr_read_b32 v52, a81
    v_mul_f32 v52, v52, v51
    v_accvgpr_write_b32 a81, v52
    v_accvgpr_read_b32 v52, a82
    v_mul_f32 v52, v52, v51
    v_accvgpr_write_b32 a82, v52
    v_accvgpr_read_b32 v52, a83
    v_mul_f32 v52, v52, v51
    v_accvgpr_write_b32 a83, v52
    v_accvgpr_read_b32 v52, a84
    v_mul_f32 v52, v52, v51
    v_accvgpr_write_b32 a84, v52
    v_accvgpr_read_b32 v52, a85
    v_mul_f32 v52, v52, v51
    v_accvgpr_write_b32 a85, v52
    v_accvgpr_read_b32 v52, a86
    v_mul_f32 v52, v52, v51
    v_accvgpr_write_b32 a86, v52
    v_accvgpr_read_b32 v52, a87
    v_mul_f32 v52, v52, v51
    v_accvgpr_write_b32 a87, v52
    v_accvgpr_read_b32 v52, a88
    v_mul_f32 v52, v52, v51
    v_accvgpr_write_b32 a88, v52
    v_accvgpr_read_b32 v52, a89
    v_mul_f32 v52, v52, v51
    v_accvgpr_write_b32 a89, v52
    v_accvgpr_read_b32 v52, a90
    v_mul_f32 v52, v52, v51
    v_accvgpr_write_b32 a90, v52
    v_accvgpr_read_b32 v52, a91
    v_mul_f32 v52, v52, v51
    v_accvgpr_write_b32 a91, v52
    v_accvgpr_read_b32 v52, a92
    v_mul_f32 v52, v52, v51
    v_accvgpr_write_b32 a92, v52
    v_accvgpr_read_b32 v52, a93
    v_mul_f32 v52, v52, v51
    v_accvgpr_write_b32 a93, v52
    v_accvgpr_read_b32 v52, a94
    v_mul_f32 v52, v52, v51
    v_accvgpr_write_b32 a94, v52
    v_accvgpr_read_b32 v52, a95
    v_mul_f32 v52, v52, v51
    v_accvgpr_write_b32 a95, v52
    v_exp_f32 v34, v176
    s_nop 0
    v_exp_f32 v35, v177
    s_nop 0
    v_cvt_pk_bf16_f32 v216, v34, v35
    v_exp_f32 v36, v178
    s_nop 0
    v_exp_f32 v37, v179
    s_nop 0
    v_cvt_pk_bf16_f32 v217, v36, v37
    v_exp_f32 v34, v180
    s_nop 0
    v_exp_f32 v35, v181
    s_nop 0
    v_cvt_pk_bf16_f32 v218, v34, v35
    v_exp_f32 v36, v182
    s_nop 0
    v_exp_f32 v37, v183
    s_nop 0
    v_cvt_pk_bf16_f32 v219, v36, v37
    s_nop 1
    v_mfma_f32_16x16x32_bf16 v[4:7], v[244:247], v[216:219], v[56:59]
    v_max3_f32 v50, v184, v185, v186
    v_max3_f32 v50, v50, v187, v188
    v_max3_f32 v50, v50, v189, v190
    v_max_f32 v50, v50, v191
    v_mov_b32 v51, v50
    s_nop 1
    v_permlane16_swap_b32 v50, v51
    v_max_f32 v50, v50, v51
    v_mov_b32 v51, v50
    s_nop 1
    v_permlane32_swap_b32 v50, v51
    v_max_f32 v50, v50, v51
    v_log_f32 v51, v60
    s_nop 0
    v_max3_f32 v50, v50, v51, 0
    v_exp_f32 v51, -v50
    v_sub_f32 v184, v184, v50
    v_sub_f32 v152, v152, v50
    v_sub_f32 v185, v185, v50
    v_sub_f32 v153, v153, v50
    v_sub_f32 v186, v186, v50
    v_sub_f32 v154, v154, v50
    v_sub_f32 v187, v187, v50
    v_sub_f32 v155, v155, v50
    v_sub_f32 v188, v188, v50
    v_sub_f32 v156, v156, v50
    v_sub_f32 v189, v189, v50
    v_sub_f32 v157, v157, v50
    v_sub_f32 v190, v190, v50
    v_sub_f32 v158, v158, v50
    v_sub_f32 v191, v191, v50
    v_sub_f32 v159, v159, v50
    v_sub_f32 v236, v236, v50
    v_sub_f32 v237, v237, v50
    v_sub_f32 v238, v238, v50
    v_sub_f32 v239, v239, v50
    v_mul_f32 v60, v60, v51
    v_accvgpr_read_b32 v52, a96
    v_mul_f32 v52, v52, v51
    v_accvgpr_write_b32 a96, v52
    v_accvgpr_read_b32 v52, a97
    v_mul_f32 v52, v52, v51
    v_accvgpr_write_b32 a97, v52
    v_accvgpr_read_b32 v52, a98
    v_mul_f32 v52, v52, v51
    v_accvgpr_write_b32 a98, v52
    v_accvgpr_read_b32 v52, a99
    v_mul_f32 v52, v52, v51
    v_accvgpr_write_b32 a99, v52
    v_accvgpr_read_b32 v52, a100
    v_mul_f32 v52, v52, v51
    v_accvgpr_write_b32 a100, v52
    v_accvgpr_read_b32 v52, a101
    v_mul_f32 v52, v52, v51
    v_accvgpr_write_b32 a101, v52
    v_accvgpr_read_b32 v52, a102
    v_mul_f32 v52, v52, v51
    v_accvgpr_write_b32 a102, v52
    v_accvgpr_read_b32 v52, a103
    v_mul_f32 v52, v52, v51
    v_accvgpr_write_b32 a103, v52
    v_accvgpr_read_b32 v52, a104
    v_mul_f32 v52, v52, v51
    v_accvgpr_write_b32 a104, v52
    v_accvgpr_read_b32 v52, a105
    v_mul_f32 v52, v52, v51
    v_accvgpr_write_b32 a105, v52
    v_accvgpr_read_b32 v52, a106
    v_mul_f32 v52, v52, v51
    v_accvgpr_write_b32 a106, v52
    v_accvgpr_read_b32 v52, a107
    v_mul_f32 v52, v52, v51
    v_accvgpr_write_b32 a107, v52
    v_accvgpr_read_b32 v52, a108
    v_mul_f32 v52, v52, v51
    v_accvgpr_write_b32 a108, v52
    v_accvgpr_read_b32 v52, a109
    v_mul_f32 v52, v52, v51
    v_accvgpr_write_b32 a109, v52
    v_accvgpr_read_b32 v52, a110
    v_mul_f32 v52, v52, v51
    v_accvgpr_write_b32 a110, v52
    v_accvgpr_read_b32 v52, a111
    v_mul_f32 v52, v52, v51
    v_accvgpr_write_b32 a111, v52
    v_accvgpr_read_b32 v52, a112
    v_mul_f32 v52, v52, v51
    v_accvgpr_write_b32 a112, v52
    v_accvgpr_read_b32 v52, a113
    v_mul_f32 v52, v52, v51
    v_accvgpr_write_b32 a113, v52
    v_accvgpr_read_b32 v52, a114
    v_mul_f32 v52, v52, v51
    v_accvgpr_write_b32 a114, v52
    v_accvgpr_read_b32 v52, a115
    v_mul_f32 v52, v52, v51
    v_accvgpr_write_b32 a115, v52
    v_accvgpr_read_b32 v52, a116
    v_mul_f32 v52, v52, v51
    v_accvgpr_write_b32 a116, v52
    v_accvgpr_read_b32 v52, a117
    v_mul_f32 v52, v52, v51
    v_accvgpr_write_b32 a117, v52
    v_accvgpr_read_b32 v52, a118
    v_mul_f32 v52, v52, v51
    v_accvgpr_write_b32 a118, v52
    v_accvgpr_read_b32 v52, a119
    v_mul_f32 v52, v52, v51
    v_accvgpr_write_b32 a119, v52
    v_accvgpr_read_b32 v52, a120
    v_mul_f32 v52, v52, v51
    v_accvgpr_write_b32 a120, v52
    v_accvgpr_read_b32 v52, a121
    v_mul_f32 v52, v52, v51
    v_accvgpr_write_b32 a121, v52
    v_accvgpr_read_b32 v52, a122
    v_mul_f32 v52, v52, v51
    v_accvgpr_write_b32 a122, v52
    v_accvgpr_read_b32 v52, a123
    v_mul_f32 v52, v52, v51
    v_accvgpr_write_b32 a123, v52
    v_accvgpr_read_b32 v52, a124
    v_mul_f32 v52, v52, v51
    v_accvgpr_write_b32 a124, v52
    v_accvgpr_read_b32 v52, a125
    v_mul_f32 v52, v52, v51
    v_accvgpr_write_b32 a125, v52
    v_accvgpr_read_b32 v52, a126
    v_mul_f32 v52, v52, v51
    v_accvgpr_write_b32 a126, v52
    v_accvgpr_read_b32 v52, a127
    v_mul_f32 v52, v52, v51
    v_accvgpr_write_b32 a127, v52
    v_exp_f32 v34, v184
    s_nop 0
    v_exp_f32 v35, v185
    s_nop 0
    v_cvt_pk_bf16_f32 v220, v34, v35
    v_exp_f32 v36, v186
    s_nop 0
    v_exp_f32 v37, v187
    s_nop 0
    v_cvt_pk_bf16_f32 v221, v36, v37
    v_exp_f32 v34, v188
    s_nop 0
    v_exp_f32 v35, v189
    s_nop 0
    v_cvt_pk_bf16_f32 v222, v34, v35
    v_exp_f32 v36, v190
    s_nop 0
    v_exp_f32 v37, v191
    s_nop 0
    v_cvt_pk_bf16_f32 v223, v36, v37
    s_nop 1
    v_mfma_f32_16x16x32_bf16 v[8:11], v[244:247], v[220:223], v[60:63]
    v_exp_f32 v34, v128
    s_nop 0
    v_exp_f32 v35, v129
    s_nop 0
    v_cvt_pk_bf16_f32 v192, v34, v35
    s_nop 0
    v_exp_f32 v36, v130
    s_nop 0
    v_exp_f32 v37, v131
    s_nop 0
    v_cvt_pk_bf16_f32 v193, v36, v37
    s_nop 0
    s_nop 7
    s_setpc_b64 s[40:41]
rescale_1:
    s_nop 15
    v_max3_f32 v50, v128, v129, v130
    v_max3_f32 v50, v50, v131, v132
    v_max3_f32 v50, v50, v133, v134
    v_max_f32 v50, v50, v135
    v_mov_b32 v51, v50
    s_nop 1
    v_permlane16_swap_b32 v50, v51
    v_max_f32 v50, v50, v51
    v_mov_b32 v51, v50
    s_nop 1
    v_permlane32_swap_b32 v50, v51
    v_max_f32 v50, v50, v51
    v_log_f32 v51, v240
    s_nop 0
    v_max3_f32 v50, v50, v51, 0
    v_exp_f32 v51, -v50
    v_sub_f32 v128, v128, v50
    v_sub_f32 v160, v160, v50
    v_sub_f32 v129, v129, v50
    v_sub_f32 v161, v161, v50
    v_sub_f32 v130, v130, v50
    v_sub_f32 v162, v162, v50
    v_sub_f32 v131, v131, v50
    v_sub_f32 v163, v163, v50
    v_sub_f32 v132, v132, v50
    v_sub_f32 v164, v164, v50
    v_sub_f32 v133, v133, v50
    v_sub_f32 v165, v165, v50
    v_sub_f32 v134, v134, v50
    v_sub_f32 v166, v166, v50
    v_sub_f32 v135, v135, v50
    v_sub_f32 v167, v167, v50
    v_sub_f32 v224, v224, v50
    v_sub_f32 v225, v225, v50
    v_sub_f32 v226, v226, v50
    v_sub_f32 v227, v227, v50
    v_mul_f32 v240, v240, v51
    v_accvgpr_read_b32 v52, a0
    v_mul_f32 v52, v52, v51
    v_accvgpr_write_b32 a0, v52
    v_accvgpr_read_b32 v52, a1
    v_mul_f32 v52, v52, v51
    v_accvgpr_write_b32 a1, v52
    v_accvgpr_read_b32 v52, a2
    v_mul_f32 v52, v52, v51
    v_accvgpr_write_b32 a2, v52
    v_accvgpr_read_b32 v52, a3
    v_mul_f32 v52, v52, v51
    v_accvgpr_write_b32 a3, v52
    v_accvgpr_read_b32 v52, a4
    v_mul_f32 v52, v52, v51
    v_accvgpr_write_b32 a4, v52
    v_accvgpr_read_b32 v52, a5
    v_mul_f32 v52, v52, v51
    v_accvgpr_write_b32 a5, v52
    v_accvgpr_read_b32 v52, a6
    v_mul_f32 v52, v52, v51
    v_accvgpr_write_b32 a6, v52
    v_accvgpr_read_b32 v52, a7
    v_mul_f32 v52, v52, v51
    v_accvgpr_write_b32 a7, v52
    v_accvgpr_read_b32 v52, a8
    v_mul_f32 v52, v52, v51
    v_accvgpr_write_b32 a8, v52
    v_accvgpr_read_b32 v52, a9
    v_mul_f32 v52, v52, v51
    v_accvgpr_write_b32 a9, v52
    v_accvgpr_read_b32 v52, a10
    v_mul_f32 v52, v52, v51
    v_accvgpr_write_b32 a10, v52
    v_accvgpr_read_b32 v52, a11
    v_mul_f32 v52, v52, v51
    v_accvgpr_write_b32 a11, v52
    v_accvgpr_read_b32 v52, a12
    v_mul_f32 v52, v52, v51
    v_accvgpr_write_b32 a12, v52
    v_accvgpr_read_b32 v52, a13
    v_mul_f32 v52, v52, v51
    v_accvgpr_write_b32 a13, v52
    v_accvgpr_read_b32 v52, a14
    v_mul_f32 v52, v52, v51
    v_accvgpr_write_b32 a14, v52
    v_accvgpr_read_b32 v52, a15
    v_mul_f32 v52, v52, v51
    v_accvgpr_write_b32 a15, v52
    v_accvgpr_read_b32 v52, a16
    v_mul_f32 v52, v52, v51
    v_accvgpr_write_b32 a16, v52
    v_accvgpr_read_b32 v52, a17
    v_mul_f32 v52, v52, v51
    v_accvgpr_write_b32 a17, v52
    v_accvgpr_read_b32 v52, a18
    v_mul_f32 v52, v52, v51
    v_accvgpr_write_b32 a18, v52
    v_accvgpr_read_b32 v52, a19
    v_mul_f32 v52, v52, v51
    v_accvgpr_write_b32 a19, v52
    v_accvgpr_read_b32 v52, a20
    v_mul_f32 v52, v52, v51
    v_accvgpr_write_b32 a20, v52
    v_accvgpr_read_b32 v52, a21
    v_mul_f32 v52, v52, v51
    v_accvgpr_write_b32 a21, v52
    v_accvgpr_read_b32 v52, a22
    v_mul_f32 v52, v52, v51
    v_accvgpr_write_b32 a22, v52
    v_accvgpr_read_b32 v52, a23
    v_mul_f32 v52, v52, v51
    v_accvgpr_write_b32 a23, v52
    v_accvgpr_read_b32 v52, a24
    v_mul_f32 v52, v52, v51
    v_accvgpr_write_b32 a24, v52
    v_accvgpr_read_b32 v52, a25
    v_mul_f32 v52, v52, v51
    v_accvgpr_write_b32 a25, v52
    v_accvgpr_read_b32 v52, a26
    v_mul_f32 v52, v52, v51
    v_accvgpr_write_b32 a26, v52
    v_accvgpr_read_b32 v52, a27
    v_mul_f32 v52, v52, v51
    v_accvgpr_write_b32 a27, v52
    v_accvgpr_read_b32 v52, a28
    v_mul_f32 v52, v52, v51
    v_accvgpr_write_b32 a28, v52
    v_accvgpr_read_b32 v52, a29
    v_mul_f32 v52, v52, v51
    v_accvgpr_write_b32 a29, v52
    v_accvgpr_read_b32 v52, a30
    v_mul_f32 v52, v52, v51
    v_accvgpr_write_b32 a30, v52
    v_accvgpr_read_b32 v52, a31
    v_mul_f32 v52, v52, v51
    v_accvgpr_write_b32 a31, v52
    v_exp_f32 v34, v128
    s_nop 0
    v_exp_f32 v35, v129
    s_nop 0
    v_cvt_pk_bf16_f32 v192, v34, v35
    v_exp_f32 v36, v130
    s_nop 0
    v_exp_f32 v37, v131
    s_nop 0
    v_cvt_pk_bf16_f32 v193, v36, v37
    v_exp_f32 v34, v132
    s_nop 0
    v_exp_f32 v35, v133
    s_nop 0
    v_cvt_pk_bf16_f32 v194, v34, v35
    v_exp_f32 v36, v134
    s_nop 0
    v_exp_f32 v37, v135
    s_nop 0
    v_cvt_pk_bf16_f32 v195, v36, v37
    s_nop 1
    v_mfma_f32_16x16x32_bf16 v[40:43], v[244:247], v[192:195], v[240:243]
    v_max3_f32 v50, v136, v137, v138
    v_max3_f32 v50, v50, v139, v140
    v_max3_f32 v50, v50, v141, v142
    v_max_f32 v50, v50, v143
    v_mov_b32 v51, v50
    s_nop 1
    v_permlane16_swap_b32 v50, v51
    v_max_f32 v50, v50, v51
    v_mov_b32 v51, v50
    s_nop 1
    v_permlane32_swap_b32 v50, v51
    v_max_f32 v50, v50, v51
    v_log_f32 v51, v252
    s_nop 0
    v_max3_f32 v50, v50, v51, 0
    v_exp_f32 v51, -v50
    v_sub_f32 v136, v136, v50
    v_sub_f32 v168, v168, v50
    v_sub_f32 v137, v137, v50
    v_sub_f32 v169, v169, v50
    v_sub_f32 v138, v138, v50
    v_sub_f32 v170, v170, v50
    v_sub_f32 v139, v139, v50
    v_sub_f32 v171, v171, v50
    v_sub_f32 v140, v140, v50
    v_sub_f32 v172, v172, v50
    v_sub_f32 v141, v141, v50
    v_sub_f32 v173, v173, v50
    v_sub_f32 v142, v142, v50
    v_sub_f32 v174, v174, v50
    v_sub_f32 v143, v143, v50
    v_sub_f32 v175, v175, v50
    v_sub_f32 v228, v228, v50
    v_sub_f32 v229, v229, v50
    v_sub_f32 v230, v230, v50
    v_sub_f32 v231, v231, v50
    v_mul_f32 v252, v252, v51
    v_accvgpr_read_b32 v52, a32
    v_mul_f32 v52, v52, v51
    v_accvgpr_write_b32 a32, v52
    v_accvgpr_read_b32 v52, a33
    v_mul_f32 v52, v52, v51
    v_accvgpr_write_b32 a33, v52
    v_accvgpr_read_b32 v52, a34
    v_mul_f32 v52, v52, v51
    v_accvgpr_write_b32 a34, v52
    v_accvgpr_read_b32 v52, a35
    v_mul_f32 v52, v52, v51
    v_accvgpr_write_b32 a35, v52
    v_accvgpr_read_b32 v52, a36
    v_mul_f32 v52, v52, v51
    v_accvgpr_write_b32 a36, v52
    v_accvgpr_read_b32 v52, a37
    v_mul_f32 v52, v52, v51
    v_accvgpr_write_b32 a37, v52
    v_accvgpr_read_b32 v52, a38
    v_mul_f32 v52, v52, v51
    v_accvgpr_write_b32 a38, v52
    v_accvgpr_read_b32 v52, a39
    v_mul_f32 v52, v52, v51
    v_accvgpr_write_b32 a39, v52
    v_accvgpr_read_b32 v52, a40
    v_mul_f32 v52, v52, v51
    v_accvgpr_write_b32 a40, v52
    v_accvgpr_read_b32 v52, a41
    v_mul_f32 v52, v52, v51
    v_accvgpr_write_b32 a41, v52
    v_accvgpr_read_b32 v52, a42
    v_mul_f32 v52, v52, v51
    v_accvgpr_write_b32 a42, v52
    v_accvgpr_read_b32 v52, a43
    v_mul_f32 v52, v52, v51
    v_accvgpr_write_b32 a43, v52
    v_accvgpr_read_b32 v52, a44
    v_mul_f32 v52, v52, v51
    v_accvgpr_write_b32 a44, v52
    v_accvgpr_read_b32 v52, a45
    v_mul_f32 v52, v52, v51
    v_accvgpr_write_b32 a45, v52
    v_accvgpr_read_b32 v52, a46
    v_mul_f32 v52, v52, v51
    v_accvgpr_write_b32 a46, v52
    v_accvgpr_read_b32 v52, a47
    v_mul_f32 v52, v52, v51
    v_accvgpr_write_b32 a47, v52
    v_accvgpr_read_b32 v52, a48
    v_mul_f32 v52, v52, v51
    v_accvgpr_write_b32 a48, v52
    v_accvgpr_read_b32 v52, a49
    v_mul_f32 v52, v52, v51
    v_accvgpr_write_b32 a49, v52
    v_accvgpr_read_b32 v52, a50
    v_mul_f32 v52, v52, v51
    v_accvgpr_write_b32 a50, v52
    v_accvgpr_read_b32 v52, a51
    v_mul_f32 v52, v52, v51
    v_accvgpr_write_b32 a51, v52
    v_accvgpr_read_b32 v52, a52
    v_mul_f32 v52, v52, v51
    v_accvgpr_write_b32 a52, v52
    v_accvgpr_read_b32 v52, a53
    v_mul_f32 v52, v52, v51
    v_accvgpr_write_b32 a53, v52
    v_accvgpr_read_b32 v52, a54
    v_mul_f32 v52, v52, v51
    v_accvgpr_write_b32 a54, v52
    v_accvgpr_read_b32 v52, a55
    v_mul_f32 v52, v52, v51
    v_accvgpr_write_b32 a55, v52
    v_accvgpr_read_b32 v52, a56
    v_mul_f32 v52, v52, v51
    v_accvgpr_write_b32 a56, v52
    v_accvgpr_read_b32 v52, a57
    v_mul_f32 v52, v52, v51
    v_accvgpr_write_b32 a57, v52
    v_accvgpr_read_b32 v52, a58
    v_mul_f32 v52, v52, v51
    v_accvgpr_write_b32 a58, v52
    v_accvgpr_read_b32 v52, a59
    v_mul_f32 v52, v52, v51
    v_accvgpr_write_b32 a59, v52
    v_accvgpr_read_b32 v52, a60
    v_mul_f32 v52, v52, v51
    v_accvgpr_write_b32 a60, v52
    v_accvgpr_read_b32 v52, a61
    v_mul_f32 v52, v52, v51
    v_accvgpr_write_b32 a61, v52
    v_accvgpr_read_b32 v52, a62
    v_mul_f32 v52, v52, v51
    v_accvgpr_write_b32 a62, v52
    v_accvgpr_read_b32 v52, a63
    v_mul_f32 v52, v52, v51
    v_accvgpr_write_b32 a63, v52
    v_exp_f32 v34, v136
    s_nop 0
    v_exp_f32 v35, v137
    s_nop 0
    v_cvt_pk_bf16_f32 v196, v34, v35
    v_exp_f32 v36, v138
    s_nop 0
    v_exp_f32 v37, v139
    s_nop 0
    v_cvt_pk_bf16_f32 v197, v36, v37
    v_exp_f32 v34, v140
    s_nop 0
    v_exp_f32 v35, v141
    s_nop 0
    v_cvt_pk_bf16_f32 v198, v34, v35
    v_exp_f32 v36, v142
    s_nop 0
    v_exp_f32 v37, v143
    s_nop 0
    v_cvt_pk_bf16_f32 v199, v36, v37
    s_nop 1
    v_mfma_f32_16x16x32_bf16 v[44:47], v[244:247], v[196:199], v[252:255]
    v_max3_f32 v50, v144, v145, v146
    v_max3_f32 v50, v50, v147, v148
    v_max3_f32 v50, v50, v149, v150
    v_max_f32 v50, v50, v151
    v_mov_b32 v51, v50
    s_nop 1
    v_permlane16_swap_b32 v50, v51
    v_max_f32 v50, v50, v51
    v_mov_b32 v51, v50
    s_nop 1
    v_permlane32_swap_b32 v50, v51
    v_max_f32 v50, v50, v51
    v_log_f32 v51, v4
    s_nop 0
    v_max3_f32 v50, v50, v51, 0
    v_exp_f32 v51, -v50
    v_sub_f32 v144, v144, v50
    v_sub_f32 v176, v176, v50
    v_sub_f32 v145, v145, v50
    v_sub_f32 v177, v177, v50
    v_sub_f32 v146, v146, v50
    v_sub_f32 v178, v178, v50
    v_sub_f32 v147, v147, v50
    v_sub_f32 v179, v179, v50
    v_sub_f32 v148, v148, v50
    v_sub_f32 v180, v180, v50
    v_sub_f32 v149, v149, v50
    v_sub_f32 v181, v181, v50
    v_sub_f32 v150, v150, v50
    v_sub_f32 v182, v182, v50
    v_sub_f32 v151, v151, v50
    v_sub_f32 v183, v183, v50
    v_sub_f32 v232, v232, v50
    v_sub_f32 v233, v233, v50
    v_sub_f32 v234, v234, v50
    v_sub_f32 v235, v235, v50
    v_mul_f32 v4, v4, v51
    v_accvgpr_read_b32 v52, a64
    v_mul_f32 v52, v52, v51
    v_accvgpr_write_b32 a64, v52
    v_accvgpr_read_b32 v52, a65
    v_mul_f32 v52, v52, v51
    v_accvgpr_write_b32 a65, v52
    v_accvgpr_read_b32 v52, a66
    v_mul_f32 v52, v52, v51
    v_accvgpr_write_b32 a66, v52
    v_accvgpr_read_b32 v52, a67
    v_mul_f32 v52, v52, v51
    v_accvgpr_write_b32 a67, v52
    v_accvgpr_read_b32 v52, a68
    v_mul_f32 v52, v52, v51
    v_accvgpr_write_b32 a68, v52
    v_accvgpr_read_b32 v52, a69
    v_mul_f32 v52, v52, v51
    v_accvgpr_write_b32 a69, v52
    v_accvgpr_read_b32 v52, a70
    v_mul_f32 v52, v52, v51
    v_accvgpr_write_b32 a70, v52
    v_accvgpr_read_b32 v52, a71
    v_mul_f32 v52, v52, v51
    v_accvgpr_write_b32 a71, v52
    v_accvgpr_read_b32 v52, a72
    v_mul_f32 v52, v52, v51
    v_accvgpr_write_b32 a72, v52
    v_accvgpr_read_b32 v52, a73
    v_mul_f32 v52, v52, v51
    v_accvgpr_write_b32 a73, v52
    v_accvgpr_read_b32 v52, a74
    v_mul_f32 v52, v52, v51
    v_accvgpr_write_b32 a74, v52
    v_accvgpr_read_b32 v52, a75
    v_mul_f32 v52, v52, v51
    v_accvgpr_write_b32 a75, v52
    v_accvgpr_read_b32 v52, a76
    v_mul_f32 v52, v52, v51
    v_accvgpr_write_b32 a76, v52
    v_accvgpr_read_b32 v52, a77
    v_mul_f32 v52, v52, v51
    v_accvgpr_write_b32 a77, v52
    v_accvgpr_read_b32 v52, a78
    v_mul_f32 v52, v52, v51
    v_accvgpr_write_b32 a78, v52
    v_accvgpr_read_b32 v52, a79
    v_mul_f32 v52, v52, v51
    v_accvgpr_write_b32 a79, v52
    v_accvgpr_read_b32 v52, a80
    v_mul_f32 v52, v52, v51
    v_accvgpr_write_b32 a80, v52
    v_accvgpr_read_b32 v52, a81
    v_mul_f32 v52, v52, v51
    v_accvgpr_write_b32 a81, v52
    v_accvgpr_read_b32 v52, a82
    v_mul_f32 v52, v52, v51
    v_accvgpr_write_b32 a82, v52
    v_accvgpr_read_b32 v52, a83
    v_mul_f32 v52, v52, v51
    v_accvgpr_write_b32 a83, v52
    v_accvgpr_read_b32 v52, a84
    v_mul_f32 v52, v52, v51
    v_accvgpr_write_b32 a84, v52
    v_accvgpr_read_b32 v52, a85
    v_mul_f32 v52, v52, v51
    v_accvgpr_write_b32 a85, v52
    v_accvgpr_read_b32 v52, a86
    v_mul_f32 v52, v52, v51
    v_accvgpr_write_b32 a86, v52
    v_accvgpr_read_b32 v52, a87
    v_mul_f32 v52, v52, v51
    v_accvgpr_write_b32 a87, v52
    v_accvgpr_read_b32 v52, a88
    v_mul_f32 v52, v52, v51
    v_accvgpr_write_b32 a88, v52
    v_accvgpr_read_b32 v52, a89
    v_mul_f32 v52, v52, v51
    v_accvgpr_write_b32 a89, v52
    v_accvgpr_read_b32 v52, a90
    v_mul_f32 v52, v52, v51
    v_accvgpr_write_b32 a90, v52
    v_accvgpr_read_b32 v52, a91
    v_mul_f32 v52, v52, v51
    v_accvgpr_write_b32 a91, v52
    v_accvgpr_read_b32 v52, a92
    v_mul_f32 v52, v52, v51
    v_accvgpr_write_b32 a92, v52
    v_accvgpr_read_b32 v52, a93
    v_mul_f32 v52, v52, v51
    v_accvgpr_write_b32 a93, v52
    v_accvgpr_read_b32 v52, a94
    v_mul_f32 v52, v52, v51
    v_accvgpr_write_b32 a94, v52
    v_accvgpr_read_b32 v52, a95
    v_mul_f32 v52, v52, v51
    v_accvgpr_write_b32 a95, v52
    v_exp_f32 v34, v144
    s_nop 0
    v_exp_f32 v35, v145
    s_nop 0
    v_cvt_pk_bf16_f32 v200, v34, v35
    v_exp_f32 v36, v146
    s_nop 0
    v_exp_f32 v37, v147
    s_nop 0
    v_cvt_pk_bf16_f32 v201, v36, v37
    v_exp_f32 v34, v148
    s_nop 0
    v_exp_f32 v35, v149
    s_nop 0
    v_cvt_pk_bf16_f32 v202, v34, v35
    v_exp_f32 v36, v150
    s_nop 0
    v_exp_f32 v37, v151
    s_nop 0
    v_cvt_pk_bf16_f32 v203, v36, v37
    s_nop 1
    v_mfma_f32_16x16x32_bf16 v[56:59], v[244:247], v[200:203], v[4:7]
    v_max3_f32 v50, v152, v153, v154
    v_max3_f32 v50, v50, v155, v156
    v_max3_f32 v50, v50, v157, v158
    v_max_f32 v50, v50, v159
    v_mov_b32 v51, v50
    s_nop 1
    v_permlane16_swap_b32 v50, v51
    v_max_f32 v50, v50, v51
    v_mov_b32 v51, v50
    s_nop 1
    v_permlane32_swap_b32 v50, v51
    v_max_f32 v50, v50, v51
    v_log_f32 v51, v8
    s_nop 0
    v_max3_f32 v50, v50, v51, 0
    v_exp_f32 v51, -v50
    v_sub_f32 v152, v152, v50
    v_sub_f32 v184, v184, v50
    v_sub_f32 v153, v153, v50
    v_sub_f32 v185, v185, v50
    v_sub_f32 v154, v154, v50
    v_sub_f32 v186, v186, v50
    v_sub_f32 v155, v155, v50
    v_sub_f32 v187, v187, v50
    v_sub_f32 v156, v156, v50
    v_sub_f32 v188, v188, v50
    v_sub_f32 v157, v157, v50
    v_sub_f32 v189, v189, v50
    v_sub_f32 v158, v158, v50
    v_sub_f32 v190, v190, v50
    v_sub_f32 v159, v159, v50
    v_sub_f32 v191, v191, v50
    v_sub_f32 v236, v236, v50
    v_sub_f32 v237, v237, v50
    v_sub_f32 v238, v238, v50
    v_sub_f32 v239, v239, v50
    v_mul_f32 v8, v8, v51
    v_accvgpr_read_b32 v52, a96
    v_mul_f32 v52, v52, v51
    v_accvgpr_write_b32 a96, v52
    v_accvgpr_read_b32 v52, a97
    v_mul_f32 v52, v52, v51
    v_accvgpr_write_b32 a97, v52
    v_accvgpr_read_b32 v52, a98
    v_mul_f32 v52, v52, v51
    v_accvgpr_write_b32 a98, v52
    v_accvgpr_read_b32 v52, a99
    v_mul_f32 v52, v52, v51
    v_accvgpr_write_b32 a99, v52
    v_accvgpr_read_b32 v52, a100
    v_mul_f32 v52, v52, v51
    v_accvgpr_write_b32 a100, v52
    v_accvgpr_read_b32 v52, a101
    v_mul_f32 v52, v52, v51
    v_accvgpr_write_b32 a101, v52
    v_accvgpr_read_b32 v52, a102
    v_mul_f32 v52, v52, v51
    v_accvgpr_write_b32 a102, v52
    v_accvgpr_read_b32 v52, a103
    v_mul_f32 v52, v52, v51
    v_accvgpr_write_b32 a103, v52
    v_accvgpr_read_b32 v52, a104
    v_mul_f32 v52, v52, v51
    v_accvgpr_write_b32 a104, v52
    v_accvgpr_read_b32 v52, a105
    v_mul_f32 v52, v52, v51
    v_accvgpr_write_b32 a105, v52
    v_accvgpr_read_b32 v52, a106
    v_mul_f32 v52, v52, v51
    v_accvgpr_write_b32 a106, v52
    v_accvgpr_read_b32 v52, a107
    v_mul_f32 v52, v52, v51
    v_accvgpr_write_b32 a107, v52
    v_accvgpr_read_b32 v52, a108
    v_mul_f32 v52, v52, v51
    v_accvgpr_write_b32 a108, v52
    v_accvgpr_read_b32 v52, a109
    v_mul_f32 v52, v52, v51
    v_accvgpr_write_b32 a109, v52
    v_accvgpr_read_b32 v52, a110
    v_mul_f32 v52, v52, v51
    v_accvgpr_write_b32 a110, v52
    v_accvgpr_read_b32 v52, a111
    v_mul_f32 v52, v52, v51
    v_accvgpr_write_b32 a111, v52
    v_accvgpr_read_b32 v52, a112
    v_mul_f32 v52, v52, v51
    v_accvgpr_write_b32 a112, v52
    v_accvgpr_read_b32 v52, a113
    v_mul_f32 v52, v52, v51
    v_accvgpr_write_b32 a113, v52
    v_accvgpr_read_b32 v52, a114
    v_mul_f32 v52, v52, v51
    v_accvgpr_write_b32 a114, v52
    v_accvgpr_read_b32 v52, a115
    v_mul_f32 v52, v52, v51
    v_accvgpr_write_b32 a115, v52
    v_accvgpr_read_b32 v52, a116
    v_mul_f32 v52, v52, v51
    v_accvgpr_write_b32 a116, v52
    v_accvgpr_read_b32 v52, a117
    v_mul_f32 v52, v52, v51
    v_accvgpr_write_b32 a117, v52
    v_accvgpr_read_b32 v52, a118
    v_mul_f32 v52, v52, v51
    v_accvgpr_write_b32 a118, v52
    v_accvgpr_read_b32 v52, a119
    v_mul_f32 v52, v52, v51
    v_accvgpr_write_b32 a119, v52
    v_accvgpr_read_b32 v52, a120
    v_mul_f32 v52, v52, v51
    v_accvgpr_write_b32 a120, v52
    v_accvgpr_read_b32 v52, a121
    v_mul_f32 v52, v52, v51
    v_accvgpr_write_b32 a121, v52
    v_accvgpr_read_b32 v52, a122
    v_mul_f32 v52, v52, v51
    v_accvgpr_write_b32 a122, v52
    v_accvgpr_read_b32 v52, a123
    v_mul_f32 v52, v52, v51
    v_accvgpr_write_b32 a123, v52
    v_accvgpr_read_b32 v52, a124
    v_mul_f32 v52, v52, v51
    v_accvgpr_write_b32 a124, v52
    v_accvgpr_read_b32 v52, a125
    v_mul_f32 v52, v52, v51
    v_accvgpr_write_b32 a125, v52
    v_accvgpr_read_b32 v52, a126
    v_mul_f32 v52, v52, v51
    v_accvgpr_write_b32 a126, v52
    v_accvgpr_read_b32 v52, a127
    v_mul_f32 v52, v52, v51
    v_accvgpr_write_b32 a127, v52
    v_exp_f32 v34, v152
    s_nop 0
    v_exp_f32 v35, v153
    s_nop 0
    v_cvt_pk_bf16_f32 v204, v34, v35
    v_exp_f32 v36, v154
    s_nop 0
    v_exp_f32 v37, v155
    s_nop 0
    v_cvt_pk_bf16_f32 v205, v36, v37
    v_exp_f32 v34, v156
    s_nop 0
    v_exp_f32 v35, v157
    s_nop 0
    v_cvt_pk_bf16_f32 v206, v34, v35
    v_exp_f32 v36, v158
    s_nop 0
    v_exp_f32 v37, v159
    s_nop 0
    v_cvt_pk_bf16_f32 v207, v36, v37
    s_nop 1
    v_mfma_f32_16x16x32_bf16 v[60:63], v[244:247], v[204:207], v[8:11]
    v_exp_f32 v34, v160
    s_nop 0
    v_exp_f32 v35, v161
    s_nop 0
    v_cvt_pk_bf16_f32 v208, v34, v35
    s_nop 0
    v_exp_f32 v36, v162
    s_nop 0
    v_exp_f32 v37, v163
    s_nop 0
    v_cvt_pk_bf16_f32 v209, v36, v37
    s_nop 0
    s_nop 7
    s_setpc_b64 s[40:41]
rescale_end:
    s_nop 15
    v_max3_f32 v50, v160, v161, v162
    v_max3_f32 v50, v50, v163, v164
    v_max3_f32 v50, v50, v165, v166
    v_max_f32 v50, v50, v167
    v_mov_b32 v51, v50
    s_nop 1
    v_permlane16_swap_b32 v50, v51
    v_max_f32 v50, v50, v51
    v_mov_b32 v51, v50
    s_nop 1
    v_permlane32_swap_b32 v50, v51
    v_max_f32 v50, v50, v51
    v_log_f32 v51, v40
    s_nop 0
    v_max3_f32 v50, v50, v51, 0
    v_exp_f32 v51, -v50
    v_sub_f32 v160, v160, v50
    v_sub_f32 v128, v128, v50
    v_sub_f32 v161, v161, v50
    v_sub_f32 v129, v129, v50
    v_sub_f32 v162, v162, v50
    v_sub_f32 v130, v130, v50
    v_sub_f32 v163, v163, v50
    v_sub_f32 v131, v131, v50
    v_sub_f32 v164, v164, v50
    v_sub_f32 v132, v132, v50
    v_sub_f32 v165, v165, v50
    v_sub_f32 v133, v133, v50
    v_sub_f32 v166, v166, v50
    v_sub_f32 v134, v134, v50
    v_sub_f32 v167, v167, v50
    v_sub_f32 v135, v135, v50
    v_sub_f32 v224, v224, v50
    v_sub_f32 v225, v225, v50
    v_sub_f32 v226, v226, v50
    v_sub_f32 v227, v227, v50
    v_mul_f32 v40, v40, v51
    v_accvgpr_read_b32 v52, a0
    v_mul_f32 v52, v52, v51
    v_accvgpr_write_b32 a0, v52
    v_accvgpr_read_b32 v52, a1
    v_mul_f32 v52, v52, v51
    v_accvgpr_write_b32 a1, v52
    v_accvgpr_read_b32 v52, a2
    v_mul_f32 v52, v52, v51
    v_accvgpr_write_b32 a2, v52
    v_accvgpr_read_b32 v52, a3
    v_mul_f32 v52, v52, v51
    v_accvgpr_write_b32 a3, v52
    v_accvgpr_read_b32 v52, a4
    v_mul_f32 v52, v52, v51
    v_accvgpr_write_b32 a4, v52
    v_accvgpr_read_b32 v52, a5
    v_mul_f32 v52, v52, v51
    v_accvgpr_write_b32 a5, v52
    v_accvgpr_read_b32 v52, a6
    v_mul_f32 v52, v52, v51
    v_accvgpr_write_b32 a6, v52
    v_accvgpr_read_b32 v52, a7
    v_mul_f32 v52, v52, v51
    v_accvgpr_write_b32 a7, v52
    v_accvgpr_read_b32 v52, a8
    v_mul_f32 v52, v52, v51
    v_accvgpr_write_b32 a8, v52
    v_accvgpr_read_b32 v52, a9
    v_mul_f32 v52, v52, v51
    v_accvgpr_write_b32 a9, v52
    v_accvgpr_read_b32 v52, a10
    v_mul_f32 v52, v52, v51
    v_accvgpr_write_b32 a10, v52
    v_accvgpr_read_b32 v52, a11
    v_mul_f32 v52, v52, v51
    v_accvgpr_write_b32 a11, v52
    v_accvgpr_read_b32 v52, a12
    v_mul_f32 v52, v52, v51
    v_accvgpr_write_b32 a12, v52
    v_accvgpr_read_b32 v52, a13
    v_mul_f32 v52, v52, v51
    v_accvgpr_write_b32 a13, v52
    v_accvgpr_read_b32 v52, a14
    v_mul_f32 v52, v52, v51
    v_accvgpr_write_b32 a14, v52
    v_accvgpr_read_b32 v52, a15
    v_mul_f32 v52, v52, v51
    v_accvgpr_write_b32 a15, v52
    v_accvgpr_read_b32 v52, a16
    v_mul_f32 v52, v52, v51
    v_accvgpr_write_b32 a16, v52
    v_accvgpr_read_b32 v52, a17
    v_mul_f32 v52, v52, v51
    v_accvgpr_write_b32 a17, v52
    v_accvgpr_read_b32 v52, a18
    v_mul_f32 v52, v52, v51
    v_accvgpr_write_b32 a18, v52
    v_accvgpr_read_b32 v52, a19
    v_mul_f32 v52, v52, v51
    v_accvgpr_write_b32 a19, v52
    v_accvgpr_read_b32 v52, a20
    v_mul_f32 v52, v52, v51
    v_accvgpr_write_b32 a20, v52
    v_accvgpr_read_b32 v52, a21
    v_mul_f32 v52, v52, v51
    v_accvgpr_write_b32 a21, v52
    v_accvgpr_read_b32 v52, a22
    v_mul_f32 v52, v52, v51
    v_accvgpr_write_b32 a22, v52
    v_accvgpr_read_b32 v52, a23
    v_mul_f32 v52, v52, v51
    v_accvgpr_write_b32 a23, v52
    v_accvgpr_read_b32 v52, a24
    v_mul_f32 v52, v52, v51
    v_accvgpr_write_b32 a24, v52
    v_accvgpr_read_b32 v52, a25
    v_mul_f32 v52, v52, v51
    v_accvgpr_write_b32 a25, v52
    v_accvgpr_read_b32 v52, a26
    v_mul_f32 v52, v52, v51
    v_accvgpr_write_b32 a26, v52
    v_accvgpr_read_b32 v52, a27
    v_mul_f32 v52, v52, v51
    v_accvgpr_write_b32 a27, v52
    v_accvgpr_read_b32 v52, a28
    v_mul_f32 v52, v52, v51
    v_accvgpr_write_b32 a28, v52
    v_accvgpr_read_b32 v52, a29
    v_mul_f32 v52, v52, v51
    v_accvgpr_write_b32 a29, v52
    v_accvgpr_read_b32 v52, a30
    v_mul_f32 v52, v52, v51
    v_accvgpr_write_b32 a30, v52
    v_accvgpr_read_b32 v52, a31
    v_mul_f32 v52, v52, v51
    v_accvgpr_write_b32 a31, v52
    v_exp_f32 v34, v160
    s_nop 0
    v_exp_f32 v35, v161
    s_nop 0
    v_cvt_pk_bf16_f32 v208, v34, v35
    v_exp_f32 v36, v162
    s_nop 0
    v_exp_f32 v37, v163
    s_nop 0
    v_cvt_pk_bf16_f32 v209, v36, v37
    v_exp_f32 v34, v164
    s_nop 0
    v_exp_f32 v35, v165
    s_nop 0
    v_cvt_pk_bf16_f32 v210, v34, v35
    v_exp_f32 v36, v166
    s_nop 0
    v_exp_f32 v37, v167
    s_nop 0
    v_cvt_pk_bf16_f32 v211, v36, v37
    s_nop 1
    v_mfma_f32_16x16x32_bf16 v[240:243], v[244:247], v[208:211], v[40:43]
    v_max3_f32 v50, v168, v169, v170
    v_max3_f32 v50, v50, v171, v172
    v_max3_f32 v50, v50, v173, v174
    v_max_f32 v50, v50, v175
    v_mov_b32 v51, v50
    s_nop 1
    v_permlane16_swap_b32 v50, v51
    v_max_f32 v50, v50, v51
    v_mov_b32 v51, v50
    s_nop 1
    v_permlane32_swap_b32 v50, v51
    v_max_f32 v50, v50, v51
    v_log_f32 v51, v44
    s_nop 0
    v_max3_f32 v50, v50, v51, 0
    v_exp_f32 v51, -v50
    v_sub_f32 v168, v168, v50
    v_sub_f32 v136, v136, v50
    v_sub_f32 v169, v169, v50
    v_sub_f32 v137, v137, v50
    v_sub_f32 v170, v170, v50
    v_sub_f32 v138, v138, v50
    v_sub_f32 v171, v171, v50
    v_sub_f32 v139, v139, v50
    v_sub_f32 v172, v172, v50
    v_sub_f32 v140, v140, v50
    v_sub_f32 v173, v173, v50
    v_sub_f32 v141, v141, v50
    v_sub_f32 v174, v174, v50
    v_sub_f32 v142, v142, v50
    v_sub_f32 v175, v175, v50
    v_sub_f32 v143, v143, v50
    v_sub_f32 v228, v228, v50
    v_sub_f32 v229, v229, v50
    v_sub_f32 v230, v230, v50
    v_sub_f32 v231, v231, v50
    v_mul_f32 v44, v44, v51
    v_accvgpr_read_b32 v52, a32
    v_mul_f32 v52, v52, v51
    v_accvgpr_write_b32 a32, v52
    v_accvgpr_read_b32 v52, a33
    v_mul_f32 v52, v52, v51
    v_accvgpr_write_b32 a33, v52
    v_accvgpr_read_b32 v52, a34
    v_mul_f32 v52, v52, v51
    v_accvgpr_write_b32 a34, v52
    v_accvgpr_read_b32 v52, a35
    v_mul_f32 v52, v52, v51
    v_accvgpr_write_b32 a35, v52
    v_accvgpr_read_b32 v52, a36
    v_mul_f32 v52, v52, v51
    v_accvgpr_write_b32 a36, v52
    v_accvgpr_read_b32 v52, a37
    v_mul_f32 v52, v52, v51
    v_accvgpr_write_b32 a37, v52
    v_accvgpr_read_b32 v52, a38
    v_mul_f32 v52, v52, v51
    v_accvgpr_write_b32 a38, v52
    v_accvgpr_read_b32 v52, a39
    v_mul_f32 v52, v52, v51
    v_accvgpr_write_b32 a39, v52
    v_accvgpr_read_b32 v52, a40
    v_mul_f32 v52, v52, v51
    v_accvgpr_write_b32 a40, v52
    v_accvgpr_read_b32 v52, a41
    v_mul_f32 v52, v52, v51
    v_accvgpr_write_b32 a41, v52
    v_accvgpr_read_b32 v52, a42
    v_mul_f32 v52, v52, v51
    v_accvgpr_write_b32 a42, v52
    v_accvgpr_read_b32 v52, a43
    v_mul_f32 v52, v52, v51
    v_accvgpr_write_b32 a43, v52
    v_accvgpr_read_b32 v52, a44
    v_mul_f32 v52, v52, v51
    v_accvgpr_write_b32 a44, v52
    v_accvgpr_read_b32 v52, a45
    v_mul_f32 v52, v52, v51
    v_accvgpr_write_b32 a45, v52
    v_accvgpr_read_b32 v52, a46
    v_mul_f32 v52, v52, v51
    v_accvgpr_write_b32 a46, v52
    v_accvgpr_read_b32 v52, a47
    v_mul_f32 v52, v52, v51
    v_accvgpr_write_b32 a47, v52
    v_accvgpr_read_b32 v52, a48
    v_mul_f32 v52, v52, v51
    v_accvgpr_write_b32 a48, v52
    v_accvgpr_read_b32 v52, a49
    v_mul_f32 v52, v52, v51
    v_accvgpr_write_b32 a49, v52
    v_accvgpr_read_b32 v52, a50
    v_mul_f32 v52, v52, v51
    v_accvgpr_write_b32 a50, v52
    v_accvgpr_read_b32 v52, a51
    v_mul_f32 v52, v52, v51
    v_accvgpr_write_b32 a51, v52
    v_accvgpr_read_b32 v52, a52
    v_mul_f32 v52, v52, v51
    v_accvgpr_write_b32 a52, v52
    v_accvgpr_read_b32 v52, a53
    v_mul_f32 v52, v52, v51
    v_accvgpr_write_b32 a53, v52
    v_accvgpr_read_b32 v52, a54
    v_mul_f32 v52, v52, v51
    v_accvgpr_write_b32 a54, v52
    v_accvgpr_read_b32 v52, a55
    v_mul_f32 v52, v52, v51
    v_accvgpr_write_b32 a55, v52
    v_accvgpr_read_b32 v52, a56
    v_mul_f32 v52, v52, v51
    v_accvgpr_write_b32 a56, v52
    v_accvgpr_read_b32 v52, a57
    v_mul_f32 v52, v52, v51
    v_accvgpr_write_b32 a57, v52
    v_accvgpr_read_b32 v52, a58
    v_mul_f32 v52, v52, v51
    v_accvgpr_write_b32 a58, v52
    v_accvgpr_read_b32 v52, a59
    v_mul_f32 v52, v52, v51
    v_accvgpr_write_b32 a59, v52
    v_accvgpr_read_b32 v52, a60
    v_mul_f32 v52, v52, v51
    v_accvgpr_write_b32 a60, v52
    v_accvgpr_read_b32 v52, a61
    v_mul_f32 v52, v52, v51
    v_accvgpr_write_b32 a61, v52
    v_accvgpr_read_b32 v52, a62
    v_mul_f32 v52, v52, v51
    v_accvgpr_write_b32 a62, v52
    v_accvgpr_read_b32 v52, a63
    v_mul_f32 v52, v52, v51
    v_accvgpr_write_b32 a63, v52
    v_exp_f32 v34, v168
    s_nop 0
    v_exp_f32 v35, v169
    s_nop 0
    v_cvt_pk_bf16_f32 v212, v34, v35
    v_exp_f32 v36, v170
    s_nop 0
    v_exp_f32 v37, v171
    s_nop 0
    v_cvt_pk_bf16_f32 v213, v36, v37
    v_exp_f32 v34, v172
    s_nop 0
    v_exp_f32 v35, v173
    s_nop 0
    v_cvt_pk_bf16_f32 v214, v34, v35
    v_exp_f32 v36, v174
    s_nop 0
    v_exp_f32 v37, v175
    s_nop 0
    v_cvt_pk_bf16_f32 v215, v36, v37
    s_nop 1
    v_mfma_f32_16x16x32_bf16 v[252:255], v[244:247], v[212:215], v[44:47]
    v_max3_f32 v50, v176, v177, v178
    v_max3_f32 v50, v50, v179, v180
    v_max3_f32 v50, v50, v181, v182
    v_max_f32 v50, v50, v183
    v_mov_b32 v51, v50
    s_nop 1
    v_permlane16_swap_b32 v50, v51
    v_max_f32 v50, v50, v51
    v_mov_b32 v51, v50
    s_nop 1
    v_permlane32_swap_b32 v50, v51
    v_max_f32 v50, v50, v51
    v_log_f32 v51, v56
    s_nop 0
    v_max3_f32 v50, v50, v51, 0
    v_exp_f32 v51, -v50
    v_sub_f32 v176, v176, v50
    v_sub_f32 v144, v144, v50
    v_sub_f32 v177, v177, v50
    v_sub_f32 v145, v145, v50
    v_sub_f32 v178, v178, v50
    v_sub_f32 v146, v146, v50
    v_sub_f32 v179, v179, v50
    v_sub_f32 v147, v147, v50
    v_sub_f32 v180, v180, v50
    v_sub_f32 v148, v148, v50
    v_sub_f32 v181, v181, v50
    v_sub_f32 v149, v149, v50
    v_sub_f32 v182, v182, v50
    v_sub_f32 v150, v150, v50
    v_sub_f32 v183, v183, v50
    v_sub_f32 v151, v151, v50
    v_sub_f32 v232, v232, v50
    v_sub_f32 v233, v233, v50
    v_sub_f32 v234, v234, v50
    v_sub_f32 v235, v235, v50
    v_mul_f32 v56, v56, v51
    v_accvgpr_read_b32 v52, a64
    v_mul_f32 v52, v52, v51
    v_accvgpr_write_b32 a64, v52
    v_accvgpr_read_b32 v52, a65
    v_mul_f32 v52, v52, v51
    v_accvgpr_write_b32 a65, v52
    v_accvgpr_read_b32 v52, a66
    v_mul_f32 v52, v52, v51
    v_accvgpr_write_b32 a66, v52
    v_accvgpr_read_b32 v52, a67
    v_mul_f32 v52, v52, v51
    v_accvgpr_write_b32 a67, v52
    v_accvgpr_read_b32 v52, a68
    v_mul_f32 v52, v52, v51
    v_accvgpr_write_b32 a68, v52
    v_accvgpr_read_b32 v52, a69
    v_mul_f32 v52, v52, v51
    v_accvgpr_write_b32 a69, v52
    v_accvgpr_read_b32 v52, a70
    v_mul_f32 v52, v52, v51
    v_accvgpr_write_b32 a70, v52
    v_accvgpr_read_b32 v52, a71
    v_mul_f32 v52, v52, v51
    v_accvgpr_write_b32 a71, v52
    v_accvgpr_read_b32 v52, a72
    v_mul_f32 v52, v52, v51
    v_accvgpr_write_b32 a72, v52
    v_accvgpr_read_b32 v52, a73
    v_mul_f32 v52, v52, v51
    v_accvgpr_write_b32 a73, v52
    v_accvgpr_read_b32 v52, a74
    v_mul_f32 v52, v52, v51
    v_accvgpr_write_b32 a74, v52
    v_accvgpr_read_b32 v52, a75
    v_mul_f32 v52, v52, v51
    v_accvgpr_write_b32 a75, v52
    v_accvgpr_read_b32 v52, a76
    v_mul_f32 v52, v52, v51
    v_accvgpr_write_b32 a76, v52
    v_accvgpr_read_b32 v52, a77
    v_mul_f32 v52, v52, v51
    v_accvgpr_write_b32 a77, v52
    v_accvgpr_read_b32 v52, a78
    v_mul_f32 v52, v52, v51
    v_accvgpr_write_b32 a78, v52
    v_accvgpr_read_b32 v52, a79
    v_mul_f32 v52, v52, v51
    v_accvgpr_write_b32 a79, v52
    v_accvgpr_read_b32 v52, a80
    v_mul_f32 v52, v52, v51
    v_accvgpr_write_b32 a80, v52
    v_accvgpr_read_b32 v52, a81
    v_mul_f32 v52, v52, v51
    v_accvgpr_write_b32 a81, v52
    v_accvgpr_read_b32 v52, a82
    v_mul_f32 v52, v52, v51
    v_accvgpr_write_b32 a82, v52
    v_accvgpr_read_b32 v52, a83
    v_mul_f32 v52, v52, v51
    v_accvgpr_write_b32 a83, v52
    v_accvgpr_read_b32 v52, a84
    v_mul_f32 v52, v52, v51
    v_accvgpr_write_b32 a84, v52
    v_accvgpr_read_b32 v52, a85
    v_mul_f32 v52, v52, v51
    v_accvgpr_write_b32 a85, v52
    v_accvgpr_read_b32 v52, a86
    v_mul_f32 v52, v52, v51
    v_accvgpr_write_b32 a86, v52
    v_accvgpr_read_b32 v52, a87
    v_mul_f32 v52, v52, v51
    v_accvgpr_write_b32 a87, v52
    v_accvgpr_read_b32 v52, a88
    v_mul_f32 v52, v52, v51
    v_accvgpr_write_b32 a88, v52
    v_accvgpr_read_b32 v52, a89
    v_mul_f32 v52, v52, v51
    v_accvgpr_write_b32 a89, v52
    v_accvgpr_read_b32 v52, a90
    v_mul_f32 v52, v52, v51
    v_accvgpr_write_b32 a90, v52
    v_accvgpr_read_b32 v52, a91
    v_mul_f32 v52, v52, v51
    v_accvgpr_write_b32 a91, v52
    v_accvgpr_read_b32 v52, a92
    v_mul_f32 v52, v52, v51
    v_accvgpr_write_b32 a92, v52
    v_accvgpr_read_b32 v52, a93
    v_mul_f32 v52, v52, v51
    v_accvgpr_write_b32 a93, v52
    v_accvgpr_read_b32 v52, a94
    v_mul_f32 v52, v52, v51
    v_accvgpr_write_b32 a94, v52
    v_accvgpr_read_b32 v52, a95
    v_mul_f32 v52, v52, v51
    v_accvgpr_write_b32 a95, v52
    v_exp_f32 v34, v176
    s_nop 0
    v_exp_f32 v35, v177
    s_nop 0
    v_cvt_pk_bf16_f32 v216, v34, v35
    v_exp_f32 v36, v178
    s_nop 0
    v_exp_f32 v37, v179
    s_nop 0
    v_cvt_pk_bf16_f32 v217, v36, v37
    v_exp_f32 v34, v180
    s_nop 0
    v_exp_f32 v35, v181
    s_nop 0
    v_cvt_pk_bf16_f32 v218, v34, v35
    v_exp_f32 v36, v182
    s_nop 0
    v_exp_f32 v37, v183
    s_nop 0
    v_cvt_pk_bf16_f32 v219, v36, v37
    s_nop 1
    v_mfma_f32_16x16x32_bf16 v[4:7], v[244:247], v[216:219], v[56:59]
    v_max3_f32 v50, v184, v185, v186
    v_max3_f32 v50, v50, v187, v188
    v_max3_f32 v50, v50, v189, v190
    v_max_f32 v50, v50, v191
    v_mov_b32 v51, v50
    s_nop 1
    v_permlane16_swap_b32 v50, v51
    v_max_f32 v50, v50, v51
    v_mov_b32 v51, v50
    s_nop 1
    v_permlane32_swap_b32 v50, v51
    v_max_f32 v50, v50, v51
    v_log_f32 v51, v60
    s_nop 0
    v_max3_f32 v50, v50, v51, 0
    v_exp_f32 v51, -v50
    v_sub_f32 v184, v184, v50
    v_sub_f32 v152, v152, v50
    v_sub_f32 v185, v185, v50
    v_sub_f32 v153, v153, v50
    v_sub_f32 v186, v186, v50
    v_sub_f32 v154, v154, v50
    v_sub_f32 v187, v187, v50
    v_sub_f32 v155, v155, v50
    v_sub_f32 v188, v188, v50
    v_sub_f32 v156, v156, v50
    v_sub_f32 v189, v189, v50
    v_sub_f32 v157, v157, v50
    v_sub_f32 v190, v190, v50
    v_sub_f32 v158, v158, v50
    v_sub_f32 v191, v191, v50
    v_sub_f32 v159, v159, v50
    v_sub_f32 v236, v236, v50
    v_sub_f32 v237, v237, v50
    v_sub_f32 v238, v238, v50
    v_sub_f32 v239, v239, v50
    v_mul_f32 v60, v60, v51
    v_accvgpr_read_b32 v52, a96
    v_mul_f32 v52, v52, v51
    v_accvgpr_write_b32 a96, v52
    v_accvgpr_read_b32 v52, a97
    v_mul_f32 v52, v52, v51
    v_accvgpr_write_b32 a97, v52
    v_accvgpr_read_b32 v52, a98
    v_mul_f32 v52, v52, v51
    v_accvgpr_write_b32 a98, v52
    v_accvgpr_read_b32 v52, a99
    v_mul_f32 v52, v52, v51
    v_accvgpr_write_b32 a99, v52
    v_accvgpr_read_b32 v52, a100
    v_mul_f32 v52, v52, v51
    v_accvgpr_write_b32 a100, v52
    v_accvgpr_read_b32 v52, a101
    v_mul_f32 v52, v52, v51
    v_accvgpr_write_b32 a101, v52
    v_accvgpr_read_b32 v52, a102
    v_mul_f32 v52, v52, v51
    v_accvgpr_write_b32 a102, v52
    v_accvgpr_read_b32 v52, a103
    v_mul_f32 v52, v52, v51
    v_accvgpr_write_b32 a103, v52
    v_accvgpr_read_b32 v52, a104
    v_mul_f32 v52, v52, v51
    v_accvgpr_write_b32 a104, v52
    v_accvgpr_read_b32 v52, a105
    v_mul_f32 v52, v52, v51
    v_accvgpr_write_b32 a105, v52
    v_accvgpr_read_b32 v52, a106
    v_mul_f32 v52, v52, v51
    v_accvgpr_write_b32 a106, v52
    v_accvgpr_read_b32 v52, a107
    v_mul_f32 v52, v52, v51
    v_accvgpr_write_b32 a107, v52
    v_accvgpr_read_b32 v52, a108
    v_mul_f32 v52, v52, v51
    v_accvgpr_write_b32 a108, v52
    v_accvgpr_read_b32 v52, a109
    v_mul_f32 v52, v52, v51
    v_accvgpr_write_b32 a109, v52
    v_accvgpr_read_b32 v52, a110
    v_mul_f32 v52, v52, v51
    v_accvgpr_write_b32 a110, v52
    v_accvgpr_read_b32 v52, a111
    v_mul_f32 v52, v52, v51
    v_accvgpr_write_b32 a111, v52
    v_accvgpr_read_b32 v52, a112
    v_mul_f32 v52, v52, v51
    v_accvgpr_write_b32 a112, v52
    v_accvgpr_read_b32 v52, a113
    v_mul_f32 v52, v52, v51
    v_accvgpr_write_b32 a113, v52
    v_accvgpr_read_b32 v52, a114
    v_mul_f32 v52, v52, v51
    v_accvgpr_write_b32 a114, v52
    v_accvgpr_read_b32 v52, a115
    v_mul_f32 v52, v52, v51
    v_accvgpr_write_b32 a115, v52
    v_accvgpr_read_b32 v52, a116
    v_mul_f32 v52, v52, v51
    v_accvgpr_write_b32 a116, v52
    v_accvgpr_read_b32 v52, a117
    v_mul_f32 v52, v52, v51
    v_accvgpr_write_b32 a117, v52
    v_accvgpr_read_b32 v52, a118
    v_mul_f32 v52, v52, v51
    v_accvgpr_write_b32 a118, v52
    v_accvgpr_read_b32 v52, a119
    v_mul_f32 v52, v52, v51
    v_accvgpr_write_b32 a119, v52
    v_accvgpr_read_b32 v52, a120
    v_mul_f32 v52, v52, v51
    v_accvgpr_write_b32 a120, v52
    v_accvgpr_read_b32 v52, a121
    v_mul_f32 v52, v52, v51
    v_accvgpr_write_b32 a121, v52
    v_accvgpr_read_b32 v52, a122
    v_mul_f32 v52, v52, v51
    v_accvgpr_write_b32 a122, v52
    v_accvgpr_read_b32 v52, a123
    v_mul_f32 v52, v52, v51
    v_accvgpr_write_b32 a123, v52
    v_accvgpr_read_b32 v52, a124
    v_mul_f32 v52, v52, v51
    v_accvgpr_write_b32 a124, v52
    v_accvgpr_read_b32 v52, a125
    v_mul_f32 v52, v52, v51
    v_accvgpr_write_b32 a125, v52
    v_accvgpr_read_b32 v52, a126
    v_mul_f32 v52, v52, v51
    v_accvgpr_write_b32 a126, v52
    v_accvgpr_read_b32 v52, a127
    v_mul_f32 v52, v52, v51
    v_accvgpr_write_b32 a127, v52
    v_exp_f32 v34, v184
    s_nop 0
    v_exp_f32 v35, v185
    s_nop 0
    v_cvt_pk_bf16_f32 v220, v34, v35
    v_exp_f32 v36, v186
    s_nop 0
    v_exp_f32 v37, v187
    s_nop 0
    v_cvt_pk_bf16_f32 v221, v36, v37
    v_exp_f32 v34, v188
    s_nop 0
    v_exp_f32 v35, v189
    s_nop 0
    v_cvt_pk_bf16_f32 v222, v34, v35
    v_exp_f32 v36, v190
    s_nop 0
    v_exp_f32 v37, v191
    s_nop 0
    v_cvt_pk_bf16_f32 v223, v36, v37
    s_nop 1
    v_mfma_f32_16x16x32_bf16 v[8:11], v[244:247], v[220:223], v[60:63]
    s_nop 7
    s_setpc_b64 s[40:41]
.section .rodata,"a"
.p2align 6
.amdhsa_kernel recurrent_scan__mha_block_cached__mixer_channel_mlp__prompt_kernel
  .amdhsa_next_free_vgpr 512
  .amdhsa_next_free_sgpr 102
  .amdhsa_accum_offset 256
  .amdhsa_group_segment_fixed_size 0
  .amdhsa_kernarg_size 104
  .amdhsa_user_sgpr_count 2
  .amdhsa_user_sgpr_kernarg_segment_ptr 1
  .amdhsa_system_sgpr_workgroup_id_x 1
.end_amdhsa_kernel
```
